```python
import torch

def _softmax(x, axis=-1):
    return torch.softmax(x, dim=axis)
def _gelu(x):
    return torch.nn.functional.gelu(x, approximate="tanh")
def _silu(x):
    return torch.nn.functional.silu(x)
def _sigmoid(x):
    return torch.sigmoid(x)
def _layernorm(x, axis=-1, eps=1e-5):
    m = x.mean(dim=axis, keepdim=True)
    v = x.var(dim=axis, keepdim=True, unbiased=False)
    return (x - m) / torch.sqrt(v + eps)
def _scatter_add(tgt, idx, src, axis=0):
    return tgt.clone().index_add_(axis, idx, src)
def _segment_sum(src, seg, n):
    out = torch.zeros((n,) + src.shape[1:], dtype=src.dtype)
    return out.index_add_(0, seg, src)
def _pad(x, pw):
    flat = tuple(v for pair in reversed(pw) for v in pair)
    return torch.nn.functional.pad(x, flat)

kernel_name = 'interleave_layers__ssm_conv_s4__dense_activation_relu__prompt'

def setup_inputs():

    _w = (lambda a: (lambda t: t.to(torch.bfloat16) if t.is_floating_point() else t)(torch.as_tensor(a)))
    def _A_setup():
        B, L, D, N = 1, 2048, 448, 256
        A_re = -(lambda _x: torch.exp(torch.as_tensor(_x)))((lambda *s: torch.randn(*s, dtype=torch.bfloat16) * 1.6)(D, N))
        A_im = torch.pi * (lambda *s: torch.randn(*s, dtype=torch.bfloat16) * 0.2)(D, N)
        B_re = (lambda *s: torch.randn(*s, dtype=torch.bfloat16) * 0.2)(D, N)
        B_im = (lambda *s: torch.randn(*s, dtype=torch.bfloat16) * 0.2)(D, N)
        C_re = (lambda *s: torch.randn(*s, dtype=torch.bfloat16) * 0.2)(D, N)
        C_im = (lambda *s: torch.randn(*s, dtype=torch.bfloat16) * 0.2)(D, N)
        log_dt = (lambda *s: torch.randn(*s, dtype=torch.bfloat16) * 0.2)(D) * 0.5 - 4.0
        Dskip = (lambda *s: torch.randn(*s, dtype=torch.bfloat16) * 0.2)(D)
        return {
            "u": _w((lambda *s: torch.randn(*s, dtype=torch.bfloat16) * 0.05)(B, L, D)),
            "A_re": _w(A_re),
            "A_im": _w(A_im),
            "B_re": _w(B_re),
            "B_im": _w(B_im),
            "C_re": _w(C_re),
            "C_im": _w(C_im),
            "log_dt": _w(log_dt),
            "Dskip": _w(Dskip),
        }
    _A_in = _A_setup()

    def _B_setup():
        B, S, D, Dff = 1, 2048, 448, 1792
        return {
            "x": _w((lambda *s: torch.randn(*s, dtype=torch.bfloat16) * 0.05)(B, S, D)),
            "w1": _w((lambda *s: torch.randn(*s, dtype=torch.bfloat16) * 0.05)(D, Dff)),
            "w2": _w((lambda *s: torch.randn(*s, dtype=torch.bfloat16) * 0.05)(Dff, D)),
        }
    _B_in = _B_setup()

    return {
        "A_u": _A_in["u"],
        "A_A_re": _A_in["A_re"],
        "A_A_im": _A_in["A_im"],
        "A_B_re": _A_in["B_re"],
        "A_B_im": _A_in["B_im"],
        "A_C_re": _A_in["C_re"],
        "A_C_im": _A_in["C_im"],
        "A_log_dt": _A_in["log_dt"],
        "A_Dskip": _A_in["Dskip"],
        "B_x": _B_in["x"],
        "B_w1": _B_in["w1"],
        "B_w2": _B_in["w2"],
    }

def reference(A_u, A_A_re, A_A_im, A_B_re, A_B_im, A_C_re, A_C_im, A_log_dt, A_Dskip, B_x, B_w1, B_w2):
    def _A_ref(u, A_re, A_im, B_re, B_im, C_re, C_im, log_dt, Dskip):
        Bsz, L, D = u.shape
        dt = torch.exp(log_dt)[:, None]
        A = A_re + 1j * A_im
        Bc = B_re + 1j * B_im
        Cc = C_re + 1j * C_im
        logdA = dt * A
        dB = dt * Bc
        l = (lambda x, dt: x.to(dt))(torch.arange(L), A_re.dtype)
        P = torch.exp(logdA[:, :, None] * l[None, None, :])
        K = torch.einsum("dn,dnl,dn->dl", Cc, P, dB).real
        L2 = 2 * L
        Kp = _pad(K, ((0, 0), (0, L)))
        up = (lambda x, *d: x.permute(*d))(u, 0, 2, 1)
        up = _pad(up, ((0, 0), (0, 0), (0, L)))
        Kf = (lambda x, axes=(-2,-1): torch.fft.rfft2(x.float(), dim=axes))(Kp[:, None, :], axes=(-2, -1))
        Uf = (lambda x, axes=(-2,-1): torch.fft.rfft2(x.float(), dim=axes))(up[:, :, None, :], axes=(-2, -1))
        Yf = Uf * Kf[None, :, :, :]
        y = (lambda x, s, axes=(-2,-1): torch.fft.irfft2(x, s=s, dim=axes).to(torch.bfloat16))(Yf, (1, L2), axes=(-2, -1))[:, :, 0, :L]
        y = (lambda x, *d: x.permute(*d))(y, 0, 2, 1) + u * Dskip[None, None, :]
        return y

    def _B_ref(x, w1, w2):
        h = torch.einsum("bsd,df->bsf", x, w1)
        zero = torch.zeros_like(h)
        h = torch.maximum(h, zero)
        return torch.einsum("bsf,fd->bsd", h, w2)

    x = A_u
    x = x + _A_ref(_layernorm(x, axis=-1), A_A_re, A_A_im, A_B_re, A_B_im, A_C_re, A_C_im, A_log_dt, A_Dskip)
    x = x + _B_ref(_layernorm(x, axis=-1), B_w1, B_w2)
    x = x + _A_ref(_layernorm(x, axis=-1), A_A_re, A_A_im, A_B_re, A_B_im, A_C_re, A_C_im, A_log_dt, A_Dskip)
    x = x + _B_ref(_layernorm(x, axis=-1), B_w1, B_w2)
    return x
```

```asm
; @launch grid=(256,1,1) block=(256,1,1) lds=163840
.amdgcn_target "amdgcn-amd-amdhsa--gfx950"
.text
.globl interleave_layers__ssm_conv_s4__dense_activation_relu__prompt_kernel
.p2align 8
.type interleave_layers__ssm_conv_s4__dense_activation_relu__prompt_kernel,@function
interleave_layers__ssm_conv_s4__dense_activation_relu__prompt_kernel:
    s_getpc_b64 s[84:85]
L_pc:
    s_cmp_ge_u32 s2, 256
    s_cbranch_scc1 L_end
    s_load_dwordx16 s[28:43], s[0:1], 0
    s_load_dwordx8 s[44:51], s[0:1], 64
    s_load_dwordx4 s[52:55], s[0:1], 96
    s_load_dwordx2 s[56:57], s[0:1], 112
    s_sub_u32 s66, s2, 8
    s_cmp_ge_u32 s66, 24
    s_cbranch_scc1 L_nopf
    v_cmp_gt_u32 vcc, 64, v0
    s_lshr_b32 s66, s66, 3
    s_lshl_b32 s66, s66, 7
    v_mul_u32_u24 v2, 384, v0
    v_add_u32 v2, s66, v2
    s_cbranch_vccz L_nopf
    v_min_u32 v2, L_table_end-L_pc-4, v2
    global_load_dword v26, v2, s[84:85]
    v_add_u32 v2, 24576, v2
    v_min_u32 v2, L_table_end-L_pc-4, v2
    global_load_dword v26, v2, s[84:85]
L_nopf:
    v_lshrrev_b32 v17, 6, v0
    v_and_b32 v1, 63, v0
    v_readfirstlane_b32 s3, v17
    v_lshlrev_b32 v2, 4, v1
    s_sub_u32 s66, s2, 32
    s_and_b32 s74, s66, 7
    s_lshr_b32 s60, s66, 3
    s_mul_i32 s58, s74, 28
    s_add_u32 s58, s58, s60
    s_lshl_b32 s67, s58, 10
    v_lshl_add_u32 v150, v0, 2, s67
    s_lshl2_add_u32 s66, s66, s3
    s_mul_i32 s67, s66, 9363
    s_lshr_b32 s67, s67, 16
    s_mul_i32 s68, s67, 7
    s_sub_u32 s66, s66, s68
    s_lshr_b32 s68, s67, 2
    s_lshl_b32 s68, s68, 6
    s_and_b32 s69, s67, 3
    s_lshl1_add_u32 s68, s69, s68
    v_and_b32_e64 v49, 0x30, v2
    v_bfe_u32 v48, v1, 2, 1
    v_add3_u32 v51, v49, v48, s68
    v_mul_u32_u24 v51, 896, v51
    v_lshrrev_b32_e64 v50, 3, v1
    v_lshl_add_u32 v51, v50, 4, v51
    s_lshl_b32 s68, s66, 7
    v_add_u32 v51, s68, v51
    s_mov_b32 s22, 0x1c0000
    s_mov_b32 s23, 0x20000
    s_mov_b32 s6, 0x1ba0000
    s_mov_b32 s7, 0x20000
    s_mov_b32 s26, 0x100
    s_mov_b32 s27, 0x20000
    s_movk_i32 s70, 7168
    s_waitcnt lgkmcnt(0)
    s_mov_b32 s20, s28
    s_and_b32 s21, s29, 0xffff
    s_cmp_lt_u32 s2, 32
    s_cbranch_scc1 L_clear
    s_nop 0
    buffer_load_dwordx4 v[32:35], v51, s[20:23], 0 offen
    buffer_load_dwordx4 v[36:39], v51, s[20:23], s70 offen
    global_load_dword v144, v150, s[30:31]
    global_load_dword v145, v150, s[32:33]
    global_load_dword v146, v150, s[34:35]
    global_load_dword v147, v150, s[36:37]
    global_load_dword v148, v150, s[38:39]
    global_load_dword v149, v150, s[40:41]
    s_branch L_main
L_clear:
    s_mov_b32 s4, s56
    s_and_b32 s5, s57, 0xffff
    s_mov_b32 s24, s54
    s_and_b32 s25, s55, 0xffff
    v_mov_b32 v17, 1
    s_mov_b32 s64, 0x3f803f80
    s_mov_b32 s65, 0xffff0000
    s_and_b32 s93, s3, 1
    s_lshr_b32 s94, s3, 1
    v_and_b32 v61, 12, v1
    v_mov_b32 v96, 0
    v_mov_b32 v97, 0
    v_mov_b32 v98, 0
    v_mov_b32 v99, 0
    s_lshl_b32 s71, s2, 7
    s_add_u32 s71, s71, 0x4c000
    s_cmp_lt_u32 s2, 28
    s_cbranch_scc1 L_h1_1
    s_sub_u32 s68, s2, 28
    s_lshl2_add_u32 s66, s68, s3
    s_mul_i32 s66, s66, 18432
    s_add_u32 s66, s66, 0x8000
    s_add_u32 s67, s66, 18432
L_z_3:
    buffer_store_dwordx4 v[96:99], v2, s[4:7], s66 offen offset:0 sc1
    buffer_store_dwordx4 v[96:99], v2, s[4:7], s66 offen offset:1024 sc1
    s_add_u32 s66, s66, 2048
    s_cmp_lt_u32 s66, s67
    s_cbranch_scc1 L_z_3
    s_lshl_b32 s66, s68, 2
    s_waitcnt vmcnt(0)
    s_barrier
    s_cmp_lg_u32 s3, 1
    s_cbranch_scc1 L_end2
    s_mov_b64 exec, 1
    buffer_store_dword v17, v96, s[24:27], s66 offen offset:192 sc1
    s_mov_b64 exec, -1
    s_branch L_end2
L_h1_1:
    s_cmp_gt_u32 s2, 2
    s_cbranch_scc1 L_helper
    s_lshl2_add_u32 s66, s2, s3
    s_lshl_b32 s66, s66, 12
    s_cmp_eq_u32 s2, 0
    s_cselect_b32 s67, 0x1808000, 0
    s_cselect_b32 s68, 0, 124
    s_add_u32 s66, s66, s67
    s_sub_u32 s66, s66, 0x4000
    buffer_store_dwordx4 v[96:99], v2, s[4:7], s66 offen offset:0 sc1
    buffer_store_dwordx4 v[96:99], v2, s[4:7], s66 offen offset:1024 sc1
    buffer_store_dwordx4 v[96:99], v2, s[4:7], s66 offen offset:2048 sc1
    buffer_store_dwordx4 v[96:99], v2, s[4:7], s66 offen offset:3072 sc1
    s_lshl2_add_u32 s66, s2, s68
    s_waitcnt vmcnt(0)
    s_barrier
    s_cmp_lg_u32 s3, 2
    s_cbranch_scc1 L_helper
    s_mov_b64 exec, 1
    buffer_store_dword v17, v96, s[24:27], s66 offen sc1
    s_mov_b64 exec, -1
    s_branch L_helper
L_main:
    s_lshl_b32 s71, s58, 2
    s_load_dword s72, s[42:43], s71
    s_load_dword s73, s[44:45], s71
    v_lshl_add_u32 v48, v48, 2, v49
    v_lshrrev_b32 v50, 5, v1
    v_lshl_add_u32 v48, v50, 3, v48
    v_and_b32_e64 v50, 16, v1
    v_lshl_add_u32 v48, v50, 2, v48
    s_lshl_b32 s68, s67, 7
    v_add_u32 v48, s68, v48
    v_lshrrev_b32_e64 v50, 2, v1
    v_lshl_add_u32 v49, v50, 14, v49
    s_lshl_b32 s66, s66, 18
    s_lshl_b32 s67, s67, 7
    s_add_u32 s66, s66, s67
    v_add_u32 v49, s66, v49
    v_mov_b32_e64 v17, 1
    s_mov_b32 s64, 0x3f803f80
    s_mov_b32 s65, 0xffff0000
    s_and_b32 s93, s3, 1
    s_lshr_b32 s94, s3, 1
    v_and_b32 v61, 12, v1
    s_cmp_ge_u32 s60, 14
    s_cselect_b32 s68, 1, 0
    s_cselect_b32 s69, 14, 0
    s_lshl1_add_u32 s59, s74, s68
    s_sub_u32 s60, s60, s69
    s_and_b32 s61, s60, 1
    s_lshr_b32 s62, s60, 1
    s_lshl_b32 s74, s74, 12
    s_lshl_b32 s66, s3, 13
    s_lshl4_add_u32 s66, s2, s66
    v_lshl_add_u32 v15, v1, 12, s66
    v_and_b32 v62, 4, v1
    v_mov_b32 v63, 0
    s_mov_b32 s4, s56
    s_and_b32 s5, s57, 0xffff
    s_mov_b32 s24, s54
    s_and_b32 s25, s55, 0xffff
    s_mov_b32 s16, s50
    s_and_b32 s17, s51, 0xffff
    s_mov_b32 s18, 0x188000
    s_mov_b32 s19, 0x20000
    v_lshrrev_b32_e64 v244, 3, v1
    v_mul_u32_u24 v20, 896, v244
    v_and_b32_e64 v244, 7, v1
    v_bfe_u32 v245, v1, 4, 1
    v_lshlrev_b32 v245, 2, v245
    v_xor_b32 v244, v244, v245
    v_lshl_add_u32 v20, v244, 4, v20
    s_mul_i32 s76, s3, 401408
    s_lshl_b32 s68, s62, 7
    s_add_u32 s76, s76, s68
    s_and_b32 s63, s2, 7
    s_min_u32 s63, s63, 6
    s_mul_i32 s100, s3, 28672
    s_lshl_b32 s70, s63, 12
    s_add_u32 m0, s70, s100
    s_mul_i32 s89, s70, 7
    s_add_u32 s89, s89, s76
    buffer_load_dwordx4 v20, s[16:19], s89 offen offset:0 lds
    v_and_b32 v248, 15, v1
    v_lshrrev_b32 v249, 4, v1
    v_and_b32_e64 v250, 3, v1
    s_mul_i32 s90, s3, 8960
    s_add_u32 s90, s90, 114816
    s_mul_i32 s95, s94, 17920
    s_add_u32 s95, s95, 114816
    v_lshl_add_u32 v186, v1, 3, s90
    v_mul_u32_u24 v187, 544, v248
    v_lshl_add_u32 v187, v249, 4, v187
    v_add_u32_e64 v187, s90, v187
    v_mul_u32_u24 v244, 132, v249
    v_add_u32 v244, v244, v248
    s_lshl2_add_u32 s68, s93, s95
    v_lshl_add_u32 v181, v244, 3, s68
    v_add_u32 v182, 8960, v181
    v_and_b32 v244, 127, v0
    s_add_u32 s68, s95, 4608
    v_lshl_add_u32 v188, v244, 5, s68
    v_lshrrev_b32_e64 v244, 5, v1
    v_bfe_u32 v245, v1, 2, 2
    v_lshlrev_b32_e64 v247, 9, v244
    v_lshl_add_u32 v247, v245, 7, v247
    v_bfe_u32 v245, v1, 3, 1
    v_lshl_add_u32 v247, v245, 6, v247
    v_bfe_u32 v245, v1, 4, 1
    v_lshl_add_u32 v247, v245, 5, v247
    v_lshl_add_u32 v247, v250, 3, v247
    s_mul_i32 s68, s3, 28672
    v_add_u32_e64 v21, s68, v247
    s_add_u32 s89, s89, 6144
    buffer_load_dwordx4 v20, s[16:19], s89 offen offset:1024 lds
    v_xor_b32 v22, 64, v21
    v_lshrrev_b32 v244, 3, v0
    v_and_b32 v245, 0x70, v2
    v_lshl_add_u32 v3, v244, 8, v245
    v_lshrrev_b32 v244, 4, v0
    v_and_b32 v246, 8, v1
    v_lshl_add_u32 v246, v244, 7, v246
    v_lshl_add_u32 v246, v250, 5, v246
    v_bfe_u32 v245, v1, 2, 1
    v_lshl_add_u32 v246, v245, 4, v246
    v_add_u32 v4, 151136, v246
    s_mul_i32 s68, s94, 7936
    s_add_u32 s68, s68, 114816
    v_add_u32 v5, s68, v246
    v_and_b32 v244, 1, v1
    v_xor_b32_e64 v244, 1, v244
    v_mul_u32_u24 v245, 9022, v244
    v_lshlrev_b32 v246, 1, v248
    v_sub_u32 v245, v245, v246
    v_lshl_add_u32 v245, v249, 4, v245
    s_lshl_b32 s69, s93, 8
    s_sub_u32 s68, s95, s69
    s_add_u32 s68, s68, 7966
    v_add_u32_e64 v6, s68, v245
    v_subrev_u32 v7, 1024, v6
    v_subrev_u32 v8, 2048, v6
    v_subrev_u32 v9, 3072, v6
    v_lshlrev_b32_e64 v245, 5, v248
    v_lshl_add_u32 v245, v249, 4, v245
    s_mul_i32 s68, s94, 4576
    s_add_u32 s89, s89, 6144
    buffer_load_dwordx4 v20, s[16:19], s89 offen offset:2048 lds
    s_sub_u32 s68, s68, s69
    s_add_u32 s68, s68, 150912
    v_add_u32 v10, s68, v245
    v_mov_b32 v11, v186
    v_add_u32 v13, s90, v2
    s_xor_b32 s68, s3, 1
    s_mul_i32 s68, s68, 8960
    s_add_u32 s68, s68, 114816
    v_add_u32 v14, s68, v2
    v_lshrrev_b32_e64 v244, 3, v1
    v_mul_u32_u24 v12, 114688, v244
    v_and_b32 v244, 7, v1
    s_and_b32 s68, s58, 1
    s_lshl_b32 s69, s68, 2
    v_xor_b32 v244, s69, v244
    v_lshl_add_u32 v12, v244, 4, v12
    s_lshl_b32 s68, s68, 3
    s_lshr_b32 s75, s58, 1
    s_lshl_b32 s75, s75, 14
    s_add_u32 s75, s75, s68
    s_add_u32 s75, s75, 0x1820000
    s_lshl_b32 s68, s58, 1
    s_add_u32 s68, s68, s94
    s_lshl_b32 s68, s68, 7
    s_mul_i32 s69, s93, 917504
    s_add_u32 s68, s68, s69
    v_add_u32 v12, s68, v12
    v_lshlrev_b32 v16, 4, v0
    v_max_u32 v16, 512, v16
    s_mov_b32 s91, 0x05040100
    s_add_u32 s89, s89, 6144
    buffer_load_dwordx4 v20, s[16:19], s89 offen offset:3072 lds
    s_mov_b32 s92, 0x07060302
    s_lshl_b32 s68, s60, 2
    s_add_u32 s68, s68, s3
    s_mul_i32 s88, s68, 28672
    s_add_u32 s88, s88, 0x1560000
    s_lshr_b32 s68, s68, 1
    s_lshl_b32 s68, s68, 7
    s_add_u32 s68, s68, 0x4c000
    v_mov_b32 v24, s68
    s_lshl2_add_u32 s68, s62, s3
    s_mul_i32 s96, s68, 28672
    s_add_u32 s96, s96, 0x1740000
    s_lshl_b32 s68, s68, 7
    s_add_u32 s68, s68, 0x4c040
    v_mov_b32 v25, s68
    s_mov_b32 s99, s68
    s_mul_i32 s77, s59, 114688
    s_add_u32 s77, s77, 0x3e0000
    v_mov_b32 v252, 0
    v_mov_b32 v253, 0
    v_mov_b32 v254, 0
    v_mov_b32 v255, 0
    v_min_u32 v244, 29, v1
    v_lshlrev_b32_e64 v244, 4, v244
    v_add_u32 v244, 150656, v244
    ds_write_b128 v244, v[252:255]
    ds_write_b128 v244, v[252:255] offset:4576
    v_and_b32 v244, 0x70, v2
    v_add_u32_e64 v244, s90, v244
    ds_write_b128 v244, v[252:255] offset:8704
    s_mov_b64 exec, 0
    s_cmp_eq_u32 s3, 0
    s_cbranch_scc1 L_pg0
    s_cmp_eq_u32 s3, 1
    s_cbranch_scc1 L_pg1
    s_cmp_eq_u32 s3, 2
    s_cbranch_scc1 L_pg2
    s_cmp_eq_u32 s3, 3
    s_cbranch_scc1 L_pg3
L_ret0:
    s_mov_b64 exec, -1
    s_waitcnt lgkmcnt(0)
    s_lshl_b32 s66, s94, 4
    s_lshr_b32 s72, s72, s66
    s_lshl_b32 s72, s72, 16
    s_lshr_b32 s73, s73, s66
    s_lshl_b32 s73, s73, 16
    v_mov_b32 v202, 0x3fb8aa3b
    v_mul_f32 v202, s72, v202
    v_exp_f32 v202, v202
    s_cmp_eq_u32 s93, 0
    s_cselect_b32 s73, s73, 0
    v_cvt_pk_bf16_f32 v202, v202, v202
    v_mov_b32 v189, 0
    v_lshlrev_b32 v202, 16, v202
    v_writelane_b32 v189, s73, 0
    s_mov_b32 vcc_lo, 0x0f0f0f0f
    s_mov_b32 vcc_hi, 0x0f0f0f0f
    s_waitcnt vmcnt(11)
    v_cndmask_b32_dpp v40, v34, v32, vcc row_ror:4 row_mask:0xf bank_mask:0xf
    v_cndmask_b32_dpp v42, v35, v33, vcc row_ror:4 row_mask:0xf bank_mask:0xf
    s_waitcnt vmcnt(10)
    v_cndmask_b32_dpp v44, v38, v36, vcc row_ror:4 row_mask:0xf bank_mask:0xf
    v_cndmask_b32_dpp v46, v39, v37, vcc row_ror:4 row_mask:0xf bank_mask:0xf
    s_not_b64 vcc, vcc
    s_nop 0
    v_cndmask_b32_dpp v41, v32, v34, vcc row_ror:12 row_mask:0xf bank_mask:0xf
    v_cndmask_b32_dpp v43, v33, v35, vcc row_ror:12 row_mask:0xf bank_mask:0xf
    v_cndmask_b32_dpp v45, v36, v38, vcc row_ror:12 row_mask:0xf bank_mask:0xf
    v_cndmask_b32_dpp v47, v37, v39, vcc row_ror:12 row_mask:0xf bank_mask:0xf
    s_mov_b32 s66, 0x1820000
    buffer_store_dwordx4 v[40:43], v49, s[4:7], s66 offen offset:0 sc1
    buffer_store_dwordx4 v[44:47], v49, s[4:7], s66 offen offset:64 sc1
    v_mov_b32 v52, 0
    v_mov_b32 v54, 0
    v_mov_b32 v53, 0
    v_mov_b32 v55, 0
    v_dot2c_f32_bf16 v52, s64, v32
    v_dot2c_f32_bf16 v54, s64, v36
    v_dot2c_f32_bf16 v53, v32, v32
    v_dot2c_f32_bf16 v55, v36, v36
    v_dot2c_f32_bf16 v52, s64, v33
    v_dot2c_f32_bf16 v54, s64, v37
    v_dot2c_f32_bf16 v53, v33, v33
    v_dot2c_f32_bf16 v55, v37, v37
    v_dot2c_f32_bf16 v52, s64, v34
    v_dot2c_f32_bf16 v54, s64, v38
    v_dot2c_f32_bf16 v53, v34, v34
    v_dot2c_f32_bf16 v55, v38, v38
    v_dot2c_f32_bf16 v52, s64, v35
    v_dot2c_f32_bf16 v54, s64, v39
    v_dot2c_f32_bf16 v53, v35, v35
    v_dot2c_f32_bf16 v55, v39, v39
    s_nop 1
    v_permlane32_swap_b32 v52, v53
    v_permlane32_swap_b32 v54, v55
    v_add_f32 v52, v52, v53
    v_add_f32 v54, v54, v55
    s_nop 1
    v_permlane16_swap_b32 v52, v54
    v_add_f32 v52, v52, v54
    s_nop 1
    v_add_f32_dpp v52, v52, v52 row_ror:8 row_mask:0xf bank_mask:0xf
    v_lshrrev_b32 v54, 1, v52
    v_add_u32 v53, 0x3000000, v52
    v_add_u32 v54, 0x24400000, v54
    s_nop 1
    v_permlane32_swap_b32 v54, v53
    v_and_b32 v53, 0x7f800000, v53
    v_mul_f32 v53, 0x3fc00000, v53
    v_add_f32 v52, v52, v53
    v_sub_f32 v52, v52, v53
    buffer_load_dword v60, v63, s[24:27], 0 offen offset:0 sc1
    s_sub_u32 s66, s2, 32
    s_lshl2_add_u32 s66, s66, s3
    s_mul_i32 s66, s66, 1792
    v_min_u32_e64 v27, 13, v1
    v_lshl_add_u32 v27, v27, 7, s66
    global_load_dword v26, v27, s[48:49]
    s_branch L_body
.p2align 12
L_pg0:
    s_branch L_ret0
    s_nop 0
L_body:
    s_waitcnt vmcnt(13)
    v_lshlrev_b32 v190, 16, v144
    v_and_b32 v191, s65, v144
    s_waitcnt vmcnt(12)
    v_lshlrev_b32 v192, 16, v145
    v_and_b32 v193, s65, v145
    s_waitcnt vmcnt(11)
    v_lshlrev_b32 v194, 16, v146
    v_and_b32 v195, s65, v146
    s_waitcnt vmcnt(10)
    v_lshlrev_b32 v196, 16, v147
    v_and_b32 v197, s65, v147
    s_waitcnt vmcnt(9)
    v_lshlrev_b32 v198, 16, v148
    v_and_b32 v199, s65, v148
    s_waitcnt vmcnt(8)
    v_lshlrev_b32 v200, 16, v149
    v_and_b32 v201, s65, v149
    v_pk_mul_f32 v[190:191], v[190:191], v[202:203] op_sel_hi:[1,0]
    v_pk_mul_f32 v[192:193], v[192:193], v[202:203] op_sel_hi:[1,0]
    v_pk_mul_f32 v[194:195], v[194:195], v[202:203] op_sel_hi:[1,0]
    v_pk_mul_f32 v[196:197], v[196:197], v[202:203] op_sel_hi:[1,0]
    s_mov_b32 s82, 0x3fb8aa3b
    v_pk_mul_f32 v[190:191], v[190:191], s[82:83] op_sel_hi:[1,0]
    s_mov_b32 s82, 0x3e22f983
    s_nop 0
    v_pk_mul_f32 v[192:193], v[192:193], s[82:83] op_sel_hi:[1,0]
    v_pk_mul_f32 v[216:217], v[198:199], v[194:195]
    v_pk_mul_f32 v[218:219], v[198:199], v[196:197]
    v_pk_fma_f32 v[220:221], v[200:201], v[196:197], v[216:217] neg_lo:[1,0,0] neg_hi:[1,0,0]
    v_pk_fma_f32 v[222:223], v[200:201], v[194:195], v[218:219]
    v_fract_f32 v196, v192
    v_fract_f32 v197, v193
    v_exp_f32 v194, v190
    v_exp_f32 v195, v191
    v_cos_f32 v204, v196
    v_cos_f32 v205, v197
    v_sin_f32 v206, v196
    v_sin_f32 v207, v197
    v_pk_mul_f32 v[204:205], v[204:205], v[194:195]
    v_pk_mul_f32 v[206:207], v[206:207], v[194:195]
    s_mov_b32 s82, 0x43800000
    v_pk_mul_f32 v[194:195], v[190:191], s[82:83] op_sel_hi:[1,0]
    v_pk_mul_f32 v[196:197], v[192:193], s[82:83] op_sel_hi:[1,0]
    v_fract_f32 v196, v196
    v_fract_f32 v197, v197
    v_exp_f32 v194, v194
    v_exp_f32 v195, v195
    v_cos_f32 v212, v196
    v_cos_f32 v213, v197
    v_sin_f32 v214, v196
    v_sin_f32 v215, v197
    v_pk_mul_f32 v[212:213], v[212:213], v[194:195]
    v_pk_mul_f32 v[214:215], v[214:215], v[194:195]
    s_mov_b32 s82, 0x41000000
    v_pk_mul_f32 v[194:195], v[190:191], s[82:83] op_sel_hi:[1,0]
    v_pk_mul_f32 v[196:197], v[192:193], s[82:83] op_sel_hi:[1,0]
    v_fract_f32 v196, v196
    v_fract_f32 v197, v197
    v_exp_f32 v194, v194
    v_exp_f32 v195, v195
    v_cos_f32 v208, v196
    v_cos_f32 v209, v197
    v_sin_f32 v210, v196
    v_sin_f32 v211, v197
    v_pk_mul_f32 v[208:209], v[208:209], v[194:195]
    v_pk_mul_f32 v[210:211], v[210:211], v[194:195]
    v_cvt_pk_bf16_f32 v240, v220, v221
    v_cvt_pk_bf16_f32 v241, -v222, -v223
    ds_write_b64 v186, v[240:241] offset:0
    v_pk_mul_f32 v[216:217], v[220:221], v[212:213]
    v_pk_mul_f32 v[218:219], v[220:221], v[214:215]
    v_pk_fma_f32 v[232:233], v[222:223], v[214:215], v[216:217] neg_lo:[1,0,0] neg_hi:[1,0,0]
    v_pk_fma_f32 v[234:235], v[222:223], v[212:213], v[218:219]
    v_cvt_pk_bf16_f32 v242, v232, v233
    v_cvt_pk_bf16_f32 v243, -v234, -v235
    ds_write_b64 v186, v[242:243] offset:4352
    v_pk_mul_f32 v[216:217], v[220:221], v[204:205]
    v_pk_mul_f32 v[218:219], v[220:221], v[206:207]
    v_pk_fma_f32 v[224:225], v[222:223], v[206:207], v[216:217] neg_lo:[1,0,0] neg_hi:[1,0,0]
    v_pk_fma_f32 v[226:227], v[222:223], v[204:205], v[218:219]
    v_cvt_pk_bf16_f32 v240, v224, v225
    v_cvt_pk_bf16_f32 v241, -v226, -v227
    ds_write_b64 v186, v[240:241] offset:544
    v_pk_mul_f32 v[216:217], v[224:225], v[204:205]
    v_pk_mul_f32 v[218:219], v[224:225], v[206:207]
    v_pk_fma_f32 v[220:221], v[226:227], v[206:207], v[216:217] neg_lo:[1,0,0] neg_hi:[1,0,0]
    v_pk_fma_f32 v[222:223], v[226:227], v[204:205], v[218:219]
    v_cvt_pk_bf16_f32 v242, v220, v221
    v_cvt_pk_bf16_f32 v243, -v222, -v223
    ds_write_b64 v186, v[242:243] offset:1088
    v_pk_mul_f32 v[216:217], v[220:221], v[212:213]
    v_pk_mul_f32 v[218:219], v[220:221], v[214:215]
    v_pk_fma_f32 v[228:229], v[222:223], v[214:215], v[216:217] neg_lo:[1,0,0] neg_hi:[1,0,0]
    v_pk_fma_f32 v[230:231], v[222:223], v[212:213], v[218:219]
    v_cvt_pk_bf16_f32 v240, v228, v229
    v_cvt_pk_bf16_f32 v241, -v230, -v231
    ds_write_b64 v186, v[240:241] offset:4896
    v_pk_mul_f32 v[216:217], v[220:221], v[204:205]
    v_pk_mul_f32 v[218:219], v[220:221], v[206:207]
    v_pk_fma_f32 v[224:225], v[222:223], v[206:207], v[216:217] neg_lo:[1,0,0] neg_hi:[1,0,0]
    v_pk_fma_f32 v[226:227], v[222:223], v[204:205], v[218:219]
    v_cvt_pk_bf16_f32 v242, v224, v225
    v_cvt_pk_bf16_f32 v243, -v226, -v227
    ds_write_b64 v186, v[242:243] offset:1632
    v_pk_mul_f32 v[216:217], v[224:225], v[204:205]
    v_pk_mul_f32 v[218:219], v[224:225], v[206:207]
    v_pk_fma_f32 v[220:221], v[226:227], v[206:207], v[216:217] neg_lo:[1,0,0] neg_hi:[1,0,0]
    v_pk_fma_f32 v[222:223], v[226:227], v[204:205], v[218:219]
    v_cvt_pk_bf16_f32 v240, v220, v221
    v_cvt_pk_bf16_f32 v241, -v222, -v223
    ds_write_b64 v186, v[240:241] offset:2176
    v_pk_mul_f32 v[216:217], v[220:221], v[212:213]
    v_pk_mul_f32 v[218:219], v[220:221], v[214:215]
    v_pk_fma_f32 v[236:237], v[222:223], v[214:215], v[216:217] neg_lo:[1,0,0] neg_hi:[1,0,0]
    v_pk_fma_f32 v[238:239], v[222:223], v[212:213], v[218:219]
    v_cvt_pk_bf16_f32 v242, v236, v237
    v_cvt_pk_bf16_f32 v243, -v238, -v239
    ds_write_b64 v186, v[242:243] offset:5440
    v_pk_mul_f32 v[216:217], v[220:221], v[204:205]
    v_pk_mul_f32 v[218:219], v[220:221], v[206:207]
    v_pk_fma_f32 v[224:225], v[222:223], v[206:207], v[216:217] neg_lo:[1,0,0] neg_hi:[1,0,0]
    v_pk_fma_f32 v[226:227], v[222:223], v[204:205], v[218:219]
    v_cvt_pk_bf16_f32 v240, v224, v225
    v_cvt_pk_bf16_f32 v241, -v226, -v227
    ds_write_b64 v186, v[240:241] offset:2720
    v_pk_mul_f32 v[216:217], v[224:225], v[204:205]
    v_pk_mul_f32 v[218:219], v[224:225], v[206:207]
    v_pk_fma_f32 v[220:221], v[226:227], v[206:207], v[216:217] neg_lo:[1,0,0] neg_hi:[1,0,0]
    v_pk_fma_f32 v[222:223], v[226:227], v[204:205], v[218:219]
    v_cvt_pk_bf16_f32 v242, v220, v221
    v_cvt_pk_bf16_f32 v243, -v222, -v223
    ds_write_b64 v186, v[242:243] offset:3264
    v_pk_mul_f32 v[216:217], v[220:221], v[212:213]
    v_pk_mul_f32 v[218:219], v[220:221], v[214:215]
    v_pk_fma_f32 v[228:229], v[222:223], v[214:215], v[216:217] neg_lo:[1,0,0] neg_hi:[1,0,0]
    v_pk_fma_f32 v[230:231], v[222:223], v[212:213], v[218:219]
    v_cvt_pk_bf16_f32 v240, v228, v229
    v_cvt_pk_bf16_f32 v241, -v230, -v231
    ds_write_b64 v186, v[240:241] offset:5984
    v_pk_mul_f32 v[216:217], v[220:221], v[204:205]
    v_pk_mul_f32 v[218:219], v[220:221], v[206:207]
    v_pk_fma_f32 v[224:225], v[222:223], v[206:207], v[216:217] neg_lo:[1,0,0] neg_hi:[1,0,0]
    v_pk_fma_f32 v[226:227], v[222:223], v[204:205], v[218:219]
    v_cvt_pk_bf16_f32 v242, v224, v225
    v_cvt_pk_bf16_f32 v243, -v226, -v227
    ds_write_b64 v186, v[242:243] offset:3808
    v_pk_mul_f32 v[216:217], v[232:233], v[212:213]
    v_pk_mul_f32 v[218:219], v[232:233], v[214:215]
    v_pk_fma_f32 v[220:221], v[234:235], v[214:215], v[216:217] neg_lo:[1,0,0] neg_hi:[1,0,0]
    v_pk_fma_f32 v[222:223], v[234:235], v[212:213], v[218:219]
    v_cvt_pk_bf16_f32 v240, v220, v221
    v_cvt_pk_bf16_f32 v241, -v222, -v223
    ds_write_b64 v186, v[240:241] offset:6528
    v_pk_mul_f32 v[216:217], v[236:237], v[212:213]
    v_pk_mul_f32 v[218:219], v[236:237], v[214:215]
    v_pk_fma_f32 v[224:225], v[238:239], v[214:215], v[216:217] neg_lo:[1,0,0] neg_hi:[1,0,0]
    v_pk_fma_f32 v[226:227], v[238:239], v[212:213], v[218:219]
    v_cvt_pk_bf16_f32 v242, v224, v225
    v_cvt_pk_bf16_f32 v243, -v226, -v227
    ds_write_b64 v186, v[242:243] offset:7072
    v_pk_mul_f32 v[216:217], v[220:221], v[212:213]
    v_pk_mul_f32 v[218:219], v[220:221], v[214:215]
    v_pk_fma_f32 v[232:233], v[222:223], v[214:215], v[216:217] neg_lo:[1,0,0] neg_hi:[1,0,0]
    v_pk_fma_f32 v[234:235], v[222:223], v[212:213], v[218:219]
    v_cvt_pk_bf16_f32 v240, v232, v233
    v_cvt_pk_bf16_f32 v241, -v234, -v235
    ds_write_b64 v186, v[240:241] offset:7616
    v_pk_mul_f32 v[216:217], v[224:225], v[212:213]
    v_pk_mul_f32 v[218:219], v[224:225], v[214:215]
    v_pk_fma_f32 v[236:237], v[226:227], v[214:215], v[216:217] neg_lo:[1,0,0] neg_hi:[1,0,0]
    v_pk_fma_f32 v[238:239], v[226:227], v[212:213], v[218:219]
    v_cvt_pk_bf16_f32 v242, v236, v237
    v_cvt_pk_bf16_f32 v243, -v238, -v239
    ds_write_b64 v186, v[242:243] offset:8160
    s_waitcnt vmcnt(1)
    v_cmp_eq_u32 vcc, 0, v60
    s_cbranch_vccnz L_slow_4
    s_nop 0
L_ok_6:
    s_mov_b32 s66, 0x1804000
    s_mov_b32 exec_lo, 0x00ff00ff
    s_mov_b32 exec_hi, 0x00ff00ff
    buffer_atomic_add_f32 v52, v48, s[4:7], s66 offen sc1
    s_mov_b64 exec, -1
    s_nop 0
    buffer_load_dword v60, v62, s[24:27], 0 offen offset:128 sc1
    ds_read_b128 a[112:115], v187 offset:0
    ds_read_b128 a[116:119], v187 offset:64
    ds_read_b128 a[120:123], v187 offset:128
    ds_read_b128 a[124:127], v187 offset:192
    ds_read_b128 a[128:131], v187 offset:256
    ds_read_b128 a[132:135], v187 offset:320
    ds_read_b128 a[136:139], v187 offset:384
    ds_read_b128 a[140:143], v187 offset:448
    v_pk_mul_f32 v[216:217], v[232:233], v[212:213]
    v_pk_mul_f32 v[218:219], v[232:233], v[214:215]
    v_pk_fma_f32 v[220:221], v[234:235], v[214:215], v[216:217] neg_lo:[1,0,0] neg_hi:[1,0,0]
    v_pk_fma_f32 v[222:223], v[234:235], v[212:213], v[218:219]
    v_cvt_pk_bf16_f32 v240, v220, v221
    v_cvt_pk_bf16_f32 v241, -v222, -v223
    ds_write_b64 v186, v[240:241] offset:0
    v_pk_mul_f32 v[216:217], v[220:221], v[212:213]
    v_pk_mul_f32 v[218:219], v[220:221], v[214:215]
    v_pk_fma_f32 v[224:225], v[222:223], v[214:215], v[216:217] neg_lo:[1,0,0] neg_hi:[1,0,0]
    v_pk_fma_f32 v[226:227], v[222:223], v[212:213], v[218:219]
    v_cvt_pk_bf16_f32 v242, v224, v225
    v_cvt_pk_bf16_f32 v243, -v226, -v227
    ds_write_b64 v186, v[242:243] offset:544
    v_pk_mul_f32 v[216:217], v[224:225], v[212:213]
    v_pk_mul_f32 v[218:219], v[224:225], v[214:215]
    v_pk_fma_f32 v[220:221], v[226:227], v[214:215], v[216:217] neg_lo:[1,0,0] neg_hi:[1,0,0]
    v_pk_fma_f32 v[222:223], v[226:227], v[212:213], v[218:219]
    v_cvt_pk_bf16_f32 v240, v220, v221
    v_cvt_pk_bf16_f32 v241, -v222, -v223
    ds_write_b64 v186, v[240:241] offset:1088
    v_pk_mul_f32 v[216:217], v[220:221], v[212:213]
    v_pk_mul_f32 v[218:219], v[220:221], v[214:215]
    v_pk_fma_f32 v[224:225], v[222:223], v[214:215], v[216:217] neg_lo:[1,0,0] neg_hi:[1,0,0]
    v_pk_fma_f32 v[226:227], v[222:223], v[212:213], v[218:219]
    v_cvt_pk_bf16_f32 v242, v224, v225
    v_cvt_pk_bf16_f32 v243, -v226, -v227
    ds_write_b64 v186, v[242:243] offset:1632
    v_pk_mul_f32 v[216:217], v[224:225], v[212:213]
    v_pk_mul_f32 v[218:219], v[224:225], v[214:215]
    v_pk_fma_f32 v[220:221], v[226:227], v[214:215], v[216:217] neg_lo:[1,0,0] neg_hi:[1,0,0]
    v_pk_fma_f32 v[222:223], v[226:227], v[212:213], v[218:219]
    v_cvt_pk_bf16_f32 v240, v220, v221
    v_cvt_pk_bf16_f32 v241, -v222, -v223
    ds_write_b64 v186, v[240:241] offset:2176
    ds_read_b128 a[144:147], v187 offset:0
    ds_read_b128 a[148:151], v187 offset:64
    ds_read_b128 a[152:155], v187 offset:128
    ds_read_b128 a[156:159], v187 offset:192
    ds_read_b128 a[160:163], v187 offset:256
    ds_read_b128 a[164:167], v187 offset:320
    ds_read_b128 a[168:171], v187 offset:384
    ds_read_b128 a[172:175], v187 offset:448
    v_mov_b32 v240, s64
    v_mov_b32 v241, 0
    ds_write_b64 v186, v[240:241]
    v_cvt_pk_bf16_f32 v242, v208, v209
    v_cvt_pk_bf16_f32 v243, v210, v211
    ds_write_b64 v186, v[242:243] offset:544
    v_and_b32 v244, 127, v0
    v_lshlrev_b32_e64 v244, 4, v244
    v_add_u32 v244, L_table-L_pc+2048, v244
    global_load_dwordx4 v[152:155], v244, s[84:85] offset:-2048
    global_load_dwordx4 v[156:159], v244, s[84:85] offset:0
    global_load_dword v160, v244, s[84:85] offset:2048
    v_pk_mul_f32 v[216:217], v[208:209], v[208:209]
    v_pk_mul_f32 v[218:219], v[208:209], v[210:211]
    v_pk_fma_f32 v[220:221], v[210:211], v[210:211], v[216:217] neg_lo:[1,0,0] neg_hi:[1,0,0]
    v_pk_fma_f32 v[222:223], v[210:211], v[208:209], v[218:219]
    v_cvt_pk_bf16_f32 v240, v220, v221
    v_cvt_pk_bf16_f32 v241, v222, v223
    ds_write_b64 v186, v[240:241] offset:1088
    v_pk_mul_f32 v[216:217], v[220:221], v[208:209]
    v_pk_mul_f32 v[218:219], v[220:221], v[210:211]
    v_pk_fma_f32 v[224:225], v[222:223], v[210:211], v[216:217] neg_lo:[1,0,0] neg_hi:[1,0,0]
    v_pk_fma_f32 v[226:227], v[222:223], v[208:209], v[218:219]
    v_cvt_pk_bf16_f32 v242, v224, v225
    v_cvt_pk_bf16_f32 v243, v226, v227
    ds_write_b64 v186, v[242:243] offset:1632
    v_pk_mul_f32 v[216:217], v[224:225], v[208:209]
    v_pk_mul_f32 v[218:219], v[224:225], v[210:211]
    v_pk_fma_f32 v[220:221], v[226:227], v[210:211], v[216:217] neg_lo:[1,0,0] neg_hi:[1,0,0]
    v_pk_fma_f32 v[222:223], v[226:227], v[208:209], v[218:219]
    v_cvt_pk_bf16_f32 v240, v220, v221
    v_cvt_pk_bf16_f32 v241, v222, v223
    ds_write_b64 v186, v[240:241] offset:2176
    v_pk_mul_f32 v[216:217], v[220:221], v[208:209]
    v_pk_mul_f32 v[218:219], v[220:221], v[210:211]
    v_pk_fma_f32 v[224:225], v[222:223], v[210:211], v[216:217] neg_lo:[1,0,0] neg_hi:[1,0,0]
    v_pk_fma_f32 v[226:227], v[222:223], v[208:209], v[218:219]
    v_cvt_pk_bf16_f32 v242, v224, v225
    v_cvt_pk_bf16_f32 v243, v226, v227
    ds_write_b64 v186, v[242:243] offset:2720
    v_pk_mul_f32 v[216:217], v[224:225], v[208:209]
    v_pk_mul_f32 v[218:219], v[224:225], v[210:211]
    v_pk_fma_f32 v[220:221], v[226:227], v[210:211], v[216:217] neg_lo:[1,0,0] neg_hi:[1,0,0]
    v_pk_fma_f32 v[222:223], v[226:227], v[208:209], v[218:219]
    v_cvt_pk_bf16_f32 v240, v220, v221
    v_cvt_pk_bf16_f32 v241, v222, v223
    ds_write_b64 v186, v[240:241] offset:3264
    v_pk_mul_f32 v[216:217], v[220:221], v[208:209]
    v_pk_mul_f32 v[218:219], v[220:221], v[210:211]
    v_pk_fma_f32 v[224:225], v[222:223], v[210:211], v[216:217] neg_lo:[1,0,0] neg_hi:[1,0,0]
    v_pk_fma_f32 v[226:227], v[222:223], v[208:209], v[218:219]
    v_cvt_pk_bf16_f32 v242, v224, v225
    v_cvt_pk_bf16_f32 v243, v226, v227
    ds_write_b64 v186, v[242:243] offset:3808
    v_pk_mul_f32 v[216:217], v[224:225], v[208:209]
    v_pk_mul_f32 v[218:219], v[224:225], v[210:211]
    v_pk_fma_f32 v[220:221], v[226:227], v[210:211], v[216:217] neg_lo:[1,0,0] neg_hi:[1,0,0]
    v_pk_fma_f32 v[222:223], v[226:227], v[208:209], v[218:219]
    v_cvt_pk_bf16_f32 v240, v220, v221
    v_cvt_pk_bf16_f32 v241, v222, v223
    ds_write_b64 v186, v[240:241] offset:4352
    v_pk_mul_f32 v[216:217], v[220:221], v[208:209]
    v_pk_mul_f32 v[218:219], v[220:221], v[210:211]
    v_pk_fma_f32 v[224:225], v[222:223], v[210:211], v[216:217] neg_lo:[1,0,0] neg_hi:[1,0,0]
    v_pk_fma_f32 v[226:227], v[222:223], v[208:209], v[218:219]
    v_cvt_pk_bf16_f32 v242, v224, v225
    v_cvt_pk_bf16_f32 v243, v226, v227
    ds_write_b64 v186, v[242:243] offset:4896
    v_pk_mul_f32 v[216:217], v[224:225], v[208:209]
    v_pk_mul_f32 v[218:219], v[224:225], v[210:211]
    v_pk_fma_f32 v[220:221], v[226:227], v[210:211], v[216:217] neg_lo:[1,0,0] neg_hi:[1,0,0]
    v_pk_fma_f32 v[222:223], v[226:227], v[208:209], v[218:219]
    v_cvt_pk_bf16_f32 v240, v220, v221
    v_cvt_pk_bf16_f32 v241, v222, v223
    ds_write_b64 v186, v[240:241] offset:5440
    v_pk_mul_f32 v[216:217], v[220:221], v[208:209]
    v_pk_mul_f32 v[218:219], v[220:221], v[210:211]
    v_pk_fma_f32 v[224:225], v[222:223], v[210:211], v[216:217] neg_lo:[1,0,0] neg_hi:[1,0,0]
    v_pk_fma_f32 v[226:227], v[222:223], v[208:209], v[218:219]
    v_cvt_pk_bf16_f32 v242, v224, v225
    v_cvt_pk_bf16_f32 v243, v226, v227
    ds_write_b64 v186, v[242:243] offset:5984
    v_pk_mul_f32 v[216:217], v[224:225], v[208:209]
    v_pk_mul_f32 v[218:219], v[224:225], v[210:211]
    v_pk_fma_f32 v[220:221], v[226:227], v[210:211], v[216:217] neg_lo:[1,0,0] neg_hi:[1,0,0]
    v_pk_fma_f32 v[222:223], v[226:227], v[208:209], v[218:219]
    v_cvt_pk_bf16_f32 v240, v220, v221
    v_cvt_pk_bf16_f32 v241, v222, v223
    ds_write_b64 v186, v[240:241] offset:6528
    v_pk_mul_f32 v[216:217], v[220:221], v[208:209]
    v_pk_mul_f32 v[218:219], v[220:221], v[210:211]
    v_pk_fma_f32 v[224:225], v[222:223], v[210:211], v[216:217] neg_lo:[1,0,0] neg_hi:[1,0,0]
    v_pk_fma_f32 v[226:227], v[222:223], v[208:209], v[218:219]
    v_cvt_pk_bf16_f32 v242, v224, v225
    v_cvt_pk_bf16_f32 v243, v226, v227
    ds_write_b64 v186, v[242:243] offset:7072
    v_pk_mul_f32 v[216:217], v[224:225], v[208:209]
    v_pk_mul_f32 v[218:219], v[224:225], v[210:211]
    v_pk_fma_f32 v[220:221], v[226:227], v[210:211], v[216:217] neg_lo:[1,0,0] neg_hi:[1,0,0]
    v_pk_fma_f32 v[222:223], v[226:227], v[208:209], v[218:219]
    v_cvt_pk_bf16_f32 v240, v220, v221
    v_cvt_pk_bf16_f32 v241, v222, v223
    ds_write_b64 v186, v[240:241] offset:7616
    v_pk_mul_f32 v[216:217], v[220:221], v[208:209]
    v_pk_mul_f32 v[218:219], v[220:221], v[210:211]
    v_pk_fma_f32 v[224:225], v[222:223], v[210:211], v[216:217] neg_lo:[1,0,0] neg_hi:[1,0,0]
    v_pk_fma_f32 v[226:227], v[222:223], v[208:209], v[218:219]
    v_cvt_pk_bf16_f32 v242, v224, v225
    v_cvt_pk_bf16_f32 v243, v226, v227
    ds_write_b64 v186, v[242:243] offset:8160
    ds_read_b128 a[176:179], v187 offset:0
    ds_read_b128 a[180:183], v187 offset:64
    ds_read_b128 a[184:187], v187 offset:128
    ds_read_b128 a[188:191], v187 offset:192
    ds_read_b128 a[192:195], v187 offset:256
    ds_read_b128 a[196:199], v187 offset:320
    ds_read_b128 a[200:203], v187 offset:384
    ds_read_b128 a[204:207], v187 offset:448
    v_pk_mul_f32 v[216:217], v[224:225], v[208:209]
    v_pk_mul_f32 v[218:219], v[224:225], v[210:211]
    v_pk_fma_f32 v[220:221], v[226:227], v[210:211], v[216:217] neg_lo:[1,0,0] neg_hi:[1,0,0]
    v_pk_fma_f32 v[222:223], v[226:227], v[208:209], v[218:219]
    v_cvt_pk_bf16_f32 v240, v220, v221
    v_cvt_pk_bf16_f32 v241, v222, v223
    ds_write_b64 v186, v[240:241] offset:0
    v_pk_mul_f32 v[216:217], v[220:221], v[208:209]
    v_pk_mul_f32 v[218:219], v[220:221], v[210:211]
    v_pk_fma_f32 v[224:225], v[222:223], v[210:211], v[216:217] neg_lo:[1,0,0] neg_hi:[1,0,0]
    v_pk_fma_f32 v[226:227], v[222:223], v[208:209], v[218:219]
    v_cvt_pk_bf16_f32 v242, v224, v225
    v_cvt_pk_bf16_f32 v243, v226, v227
    ds_write_b64 v186, v[242:243] offset:544
    s_waitcnt vmcnt(3)
    v_cmp_eq_u32 vcc, 0, v60
    s_cbranch_vccnz L_slow_7
L_ok_9:
    s_barrier
    s_mov_b32 s66, 0x0
    s_mov_b64 exec, 3
    buffer_store_dword v17, v15, s[4:7], s66 offen sc1
    s_mov_b64 exec, -1
    s_nop 0
    v_pk_mul_f32 v[216:217], v[224:225], v[208:209]
    v_pk_mul_f32 v[218:219], v[224:225], v[210:211]
    v_pk_fma_f32 v[220:221], v[226:227], v[210:211], v[216:217] neg_lo:[1,0,0] neg_hi:[1,0,0]
    v_pk_fma_f32 v[222:223], v[226:227], v[208:209], v[218:219]
    v_cvt_pk_bf16_f32 v240, v220, v221
    v_cvt_pk_bf16_f32 v241, v222, v223
    ds_write_b64 v186, v[240:241] offset:1088
    v_pk_mul_f32 v[216:217], v[220:221], v[208:209]
    v_pk_mul_f32 v[218:219], v[220:221], v[210:211]
    v_pk_fma_f32 v[224:225], v[222:223], v[210:211], v[216:217] neg_lo:[1,0,0] neg_hi:[1,0,0]
    v_pk_fma_f32 v[226:227], v[222:223], v[208:209], v[218:219]
    v_cvt_pk_bf16_f32 v242, v224, v225
    v_cvt_pk_bf16_f32 v243, v226, v227
    ds_write_b64 v186, v[242:243] offset:1632
    v_pk_mul_f32 v[216:217], v[224:225], v[208:209]
    v_pk_mul_f32 v[218:219], v[224:225], v[210:211]
    v_pk_fma_f32 v[220:221], v[226:227], v[210:211], v[216:217] neg_lo:[1,0,0] neg_hi:[1,0,0]
    v_pk_fma_f32 v[222:223], v[226:227], v[208:209], v[218:219]
    v_cvt_pk_bf16_f32 v240, v220, v221
    v_cvt_pk_bf16_f32 v241, v222, v223
    ds_write_b64 v186, v[240:241] offset:2176
    v_pk_mul_f32 v[216:217], v[220:221], v[208:209]
    v_pk_mul_f32 v[218:219], v[220:221], v[210:211]
    v_pk_fma_f32 v[224:225], v[222:223], v[210:211], v[216:217] neg_lo:[1,0,0] neg_hi:[1,0,0]
    v_pk_fma_f32 v[226:227], v[222:223], v[208:209], v[218:219]
    v_cvt_pk_bf16_f32 v242, v224, v225
    v_cvt_pk_bf16_f32 v243, v226, v227
    ds_write_b64 v186, v[242:243] offset:2720
    v_pk_mul_f32 v[216:217], v[224:225], v[208:209]
    v_pk_mul_f32 v[218:219], v[224:225], v[210:211]
    v_pk_fma_f32 v[220:221], v[226:227], v[210:211], v[216:217] neg_lo:[1,0,0] neg_hi:[1,0,0]
    v_pk_fma_f32 v[222:223], v[226:227], v[208:209], v[218:219]
    v_cvt_pk_bf16_f32 v240, v220, v221
    v_cvt_pk_bf16_f32 v241, v222, v223
    ds_write_b64 v186, v[240:241] offset:3264
    v_pk_mul_f32 v[216:217], v[220:221], v[208:209]
    v_pk_mul_f32 v[218:219], v[220:221], v[210:211]
    v_pk_fma_f32 v[224:225], v[222:223], v[210:211], v[216:217] neg_lo:[1,0,0] neg_hi:[1,0,0]
    v_pk_fma_f32 v[226:227], v[222:223], v[208:209], v[218:219]
    v_cvt_pk_bf16_f32 v242, v224, v225
    v_cvt_pk_bf16_f32 v243, v226, v227
    ds_write_b64 v186, v[242:243] offset:3808
    v_pk_mul_f32 v[216:217], v[224:225], v[208:209]
    v_pk_mul_f32 v[218:219], v[224:225], v[210:211]
    v_pk_fma_f32 v[220:221], v[226:227], v[210:211], v[216:217] neg_lo:[1,0,0] neg_hi:[1,0,0]
    v_pk_fma_f32 v[222:223], v[226:227], v[208:209], v[218:219]
    v_cvt_pk_bf16_f32 v240, v220, v221
    v_cvt_pk_bf16_f32 v241, v222, v223
    ds_write_b64 v186, v[240:241] offset:4352
    v_pk_mul_f32 v[216:217], v[220:221], v[208:209]
    v_pk_mul_f32 v[218:219], v[220:221], v[210:211]
    v_pk_fma_f32 v[224:225], v[222:223], v[210:211], v[216:217] neg_lo:[1,0,0] neg_hi:[1,0,0]
    v_pk_fma_f32 v[226:227], v[222:223], v[208:209], v[218:219]
    v_cvt_pk_bf16_f32 v242, v224, v225
    v_cvt_pk_bf16_f32 v243, v226, v227
    ds_write_b64 v186, v[242:243] offset:4896
    v_pk_mul_f32 v[216:217], v[224:225], v[208:209]
    v_pk_mul_f32 v[218:219], v[224:225], v[210:211]
    v_pk_fma_f32 v[220:221], v[226:227], v[210:211], v[216:217] neg_lo:[1,0,0] neg_hi:[1,0,0]
    v_pk_fma_f32 v[222:223], v[226:227], v[208:209], v[218:219]
    v_cvt_pk_bf16_f32 v240, v220, v221
    v_cvt_pk_bf16_f32 v241, v222, v223
    ds_write_b64 v186, v[240:241] offset:5440
    v_pk_mul_f32 v[216:217], v[220:221], v[208:209]
    v_pk_mul_f32 v[218:219], v[220:221], v[210:211]
    v_pk_fma_f32 v[224:225], v[222:223], v[210:211], v[216:217] neg_lo:[1,0,0] neg_hi:[1,0,0]
    v_pk_fma_f32 v[226:227], v[222:223], v[208:209], v[218:219]
    v_cvt_pk_bf16_f32 v242, v224, v225
    v_cvt_pk_bf16_f32 v243, v226, v227
    ds_write_b64 v186, v[242:243] offset:5984
    v_pk_mul_f32 v[216:217], v[224:225], v[208:209]
    v_pk_mul_f32 v[218:219], v[224:225], v[210:211]
    v_pk_fma_f32 v[220:221], v[226:227], v[210:211], v[216:217] neg_lo:[1,0,0] neg_hi:[1,0,0]
    v_pk_fma_f32 v[222:223], v[226:227], v[208:209], v[218:219]
    v_cvt_pk_bf16_f32 v240, v220, v221
    v_cvt_pk_bf16_f32 v241, v222, v223
    ds_write_b64 v186, v[240:241] offset:6528
    v_pk_mul_f32 v[216:217], v[220:221], v[208:209]
    v_pk_mul_f32 v[218:219], v[220:221], v[210:211]
    v_pk_fma_f32 v[224:225], v[222:223], v[210:211], v[216:217] neg_lo:[1,0,0] neg_hi:[1,0,0]
    v_pk_fma_f32 v[226:227], v[222:223], v[208:209], v[218:219]
    v_cvt_pk_bf16_f32 v242, v224, v225
    v_cvt_pk_bf16_f32 v243, v226, v227
    ds_write_b64 v186, v[242:243] offset:7072
    v_pk_mul_f32 v[216:217], v[224:225], v[208:209]
    v_pk_mul_f32 v[218:219], v[224:225], v[210:211]
    v_pk_fma_f32 v[220:221], v[226:227], v[210:211], v[216:217] neg_lo:[1,0,0] neg_hi:[1,0,0]
    v_pk_fma_f32 v[222:223], v[226:227], v[208:209], v[218:219]
    v_cvt_pk_bf16_f32 v240, v220, v221
    v_cvt_pk_bf16_f32 v241, v222, v223
    ds_write_b64 v186, v[240:241] offset:7616
    v_pk_mul_f32 v[216:217], v[220:221], v[208:209]
    v_pk_mul_f32 v[218:219], v[220:221], v[210:211]
    v_pk_fma_f32 v[224:225], v[222:223], v[210:211], v[216:217] neg_lo:[1,0,0] neg_hi:[1,0,0]
    v_pk_fma_f32 v[226:227], v[222:223], v[208:209], v[218:219]
    v_cvt_pk_bf16_f32 v242, v224, v225
    v_cvt_pk_bf16_f32 v243, v226, v227
    ds_write_b64 v186, v[242:243] offset:8160
    ds_read_b128 a[208:211], v187 offset:0
    ds_read_b128 a[212:215], v187 offset:64
    ds_read_b128 a[216:219], v187 offset:128
    ds_read_b128 a[220:223], v187 offset:192
    ds_read_b128 a[224:227], v187 offset:256
    ds_read_b128 a[228:231], v187 offset:320
    ds_read_b128 a[232:235], v187 offset:384
    ds_read_b128 a[236:239], v187 offset:448
    s_waitcnt lgkmcnt(14)
    v_mfma_f32_16x16x32_bf16 v[96:99], a[112:115], a[176:179], 0
    buffer_load_dword v19, v16, s[4:7], s74 offen offset:0 sc1
    s_waitcnt vmcnt(4)
    v_mad_u32_u16 v164, v152, 8, s95
    v_mfma_f32_16x16x32_bf16 v[96:99], a[116:119], a[180:183], v[96:99]
    v_mad_u32_u16 v165, v152, 8, s95 op_sel:[1,0,0,0]
    v_mfma_f32_16x16x32_bf16 v[96:99], a[120:123], a[184:187], v[96:99]
    s_add_u32 s63, s63, 1
    s_cmp_eq_u32 s63, 7
    s_cselect_b32 s63, 0, s63
    s_lshl_b32 s70, s63, 12
    s_add_u32 m0, s70, s100
    s_mul_i32 s89, s70, 7
    s_add_u32 s89, s89, s76
    buffer_load_dwordx4 v20, s[16:19], s89 offen offset:0 lds
    v_mfma_f32_16x16x32_bf16 v[96:99], a[124:127], a[188:191], v[96:99]
    v_mad_u32_u16 v166, v153, 8, s95
    v_mfma_f32_16x16x32_bf16 v[96:99], a[128:131], a[192:195], v[96:99]
    v_mad_u32_u16 v167, v153, 8, s95 op_sel:[1,0,0,0]
    v_mfma_f32_16x16x32_bf16 v[96:99], a[132:135], a[196:199], v[96:99]
    s_add_u32 s89, s89, 6144
    buffer_load_dwordx4 v20, s[16:19], s89 offen offset:1024 lds
    s_waitcnt lgkmcnt(0)
    s_barrier
    v_mfma_f32_16x16x32_bf16 v[96:99], a[136:139], a[200:203], v[96:99]
    v_mad_u32_u16 v168, v154, 8, s95
    v_mfma_f32_16x16x32_bf16 v[96:99], a[140:143], a[204:207], v[96:99]
    v_mad_u32_u16 v169, v154, 8, s95 op_sel:[1,0,0,0]
    v_mfma_f32_16x16x32_bf16 v[100:103], a[144:147], a[176:179], 0
    s_add_u32 s89, s89, 6144
    buffer_load_dwordx4 v20, s[16:19], s89 offen offset:2048 lds
    v_mfma_f32_16x16x32_bf16 v[100:103], a[148:151], a[180:183], v[100:103]
    v_mad_u32_u16 v170, v155, 8, s95
    v_mfma_f32_16x16x32_bf16 v[100:103], a[152:155], a[184:187], v[100:103]
    v_mad_u32_u16 v171, v155, 8, s95 op_sel:[1,0,0,0]
    v_mfma_f32_16x16x32_bf16 v[100:103], a[156:159], a[188:191], v[100:103]
    s_add_u32 s89, s89, 6144
    buffer_load_dwordx4 v20, s[16:19], s89 offen offset:3072 lds
    v_mfma_f32_16x16x32_bf16 v[100:103], a[160:163], a[192:195], v[100:103]
    s_waitcnt vmcnt(7)
    v_mad_u32_u16 v172, v156, 8, s95
    v_add_f32_e64 v96, v96, v189
    ds_write2_b32 v181, v96, v97 offset0:0 offset1:66
    ds_write2_b32 v181, v98, v99 offset0:132 offset1:198
    v_mfma_f32_16x16x32_bf16 v[100:103], a[164:167], a[196:199], v[100:103]
    v_mad_u32_u16 v173, v156, 8, s95 op_sel:[1,0,0,0]
    v_mfma_f32_16x16x32_bf16 v[100:103], a[168:171], a[200:203], v[100:103]
    s_add_u32 s63, s63, 1
    s_cmp_eq_u32 s63, 7
    s_cselect_b32 s63, 0, s63
    s_lshl_b32 s70, s63, 12
    s_add_u32 m0, s70, s100
    s_mul_i32 s89, s70, 7
    s_add_u32 s89, s89, s76
    buffer_load_dwordx4 v20, s[16:19], s89 offen offset:0 lds
    v_mfma_f32_16x16x32_bf16 v[100:103], a[172:175], a[204:207], v[100:103]
    v_mad_u32_u16 v174, v157, 8, s95
    v_mfma_f32_16x16x32_bf16 v[104:107], a[112:115], a[208:211], 0
    v_mad_u32_u16 v175, v157, 8, s95 op_sel:[1,0,0,0]
    v_mfma_f32_16x16x32_bf16 v[104:107], a[116:119], a[212:215], v[104:107]
    s_add_u32 s89, s89, 6144
    buffer_load_dwordx4 v20, s[16:19], s89 offen offset:1024 lds
    v_mfma_f32_16x16x32_bf16 v[104:107], a[120:123], a[216:219], v[104:107]
    v_mad_u32_u16 v176, v158, 8, s95
    v_mfma_f32_16x16x32_bf16 v[104:107], a[124:127], a[220:223], v[104:107]
    v_mad_u32_u16 v177, v158, 8, s95 op_sel:[1,0,0,0]
L_pg1:
    s_cbranch_execz L_ret0
    v_mfma_f32_16x16x32_bf16 v[104:107], a[128:131], a[224:227], v[104:107]
    s_add_u32 s89, s89, 6144
    buffer_load_dwordx4 v20, s[16:19], s89 offen offset:2048 lds
    ds_write2_b32 v182, v100, v101 offset0:0 offset1:66
    ds_write2_b32 v182, v102, v103 offset0:132 offset1:198
    v_mfma_f32_16x16x32_bf16 v[104:107], a[132:135], a[228:231], v[104:107]
    v_mad_u32_u16 v178, v159, 8, s95
    v_mfma_f32_16x16x32_bf16 v[104:107], a[136:139], a[232:235], v[104:107]
    v_mad_u32_u16 v179, v159, 8, s95 op_sel:[1,0,0,0]
    v_mfma_f32_16x16x32_bf16 v[104:107], a[140:143], a[236:239], v[104:107]
    s_add_u32 s89, s89, 6144
    buffer_load_dwordx4 v20, s[16:19], s89 offen offset:3072 lds
    v_mfma_f32_16x16x32_bf16 v[108:111], a[144:147], a[208:211], 0
    s_waitcnt vmcnt(10)
    v_mad_u32_u16 v180, v160, 8, s95
    v_mfma_f32_16x16x32_bf16 v[108:111], a[148:151], a[212:215], v[108:111]
    v_mfma_f32_16x16x32_bf16 v[108:111], a[152:155], a[216:219], v[108:111]
    s_add_u32 s63, s63, 1
    s_cmp_eq_u32 s63, 7
    s_cselect_b32 s63, 0, s63
    s_lshl_b32 s70, s63, 12
    s_add_u32 m0, s70, s100
    s_mul_i32 s89, s70, 7
    s_add_u32 s89, s89, s76
    buffer_load_dwordx4 v20, s[16:19], s89 offen offset:0 lds
    v_mfma_f32_16x16x32_bf16 v[108:111], a[156:159], a[220:223], v[108:111]
    v_mfma_f32_16x16x32_bf16 v[108:111], a[160:163], a[224:227], v[108:111]
    ds_write2_b32 v181, v104, v105 offset0:32 offset1:98
    ds_write2_b32 v181, v106, v107 offset0:164 offset1:230
    v_mfma_f32_16x16x32_bf16 v[108:111], a[164:167], a[228:231], v[108:111]
    s_add_u32 s89, s89, 6144
    buffer_load_dwordx4 v20, s[16:19], s89 offen offset:1024 lds
    v_mfma_f32_16x16x32_bf16 v[108:111], a[168:171], a[232:235], v[108:111]
    v_mfma_f32_16x16x32_bf16 v[108:111], a[172:175], a[236:239], v[108:111]
    s_waitcnt vmcnt(10)
    v_cmp_eq_u32 vcc, 0, v19
    s_nop 5
    ds_write2_b32 v182, v108, v109 offset0:32 offset1:98
    ds_write2_b32 v182, v110, v111 offset0:164 offset1:230
    s_cbranch_vccnz L_slow_10
L_ok_12:
    s_waitcnt lgkmcnt(0)
    s_barrier
    s_mov_b32 s66, 0x1804000
    s_add_u32 s69, s75, 0x0
    s_nop 0
    buffer_load_dwordx4 v[32:35], v3, s[4:7], s66 offen offset:0 sc1
    ds_read_b64 v[190:191], v164
    ds_read_b64 v[192:193], v165
    ds_read_b64 v[194:195], v166
    ds_read_b64 v[196:197], v167
    buffer_load_dwordx2 v[40:41], v3, s[4:7], s69 offen offset:0 sc1
    ds_read_b64 v[198:199], v168
    ds_read_b64 v[200:201], v169
    ds_read_b64 v[202:203], v170
    ds_read_b64 v[204:205], v171
    buffer_load_dwordx4 v[36:39], v3, s[4:7], s66 offen offset:128 sc1
    ds_read_b64 v[206:207], v172
    ds_read_b64 v[208:209], v173
    ds_read_b64 v[210:211], v174
    ds_read_b64 v[212:213], v175
    buffer_load_dwordx2 v[42:43], v3, s[4:7], s69 offen offset:128 sc1
    ds_read_b64 v[214:215], v176
    ds_read_b64 v[216:217], v177
    ds_read_b64 v[218:219], v178
    ds_read_b64 v[220:221], v179
    ds_read_b64 v[222:223], v180
    buffer_load_dword v60, v61, s[24:27], 0 offen offset:192 sc1
    s_waitcnt lgkmcnt(8)
    v_add_f32 v190, v190, v191
    v_add_f32 v192, v192, v193
    v_add_f32 v194, v194, v195
    v_add_f32 v196, v196, v197
    v_add_f32 v198, v198, v199
    v_add_f32 v200, v200, v201
    v_add_f32 v202, v202, v203
    v_add_f32 v204, v204, v205
    v_add_f32 v206, v206, v207
    s_waitcnt lgkmcnt(0)
    v_add_f32 v208, v208, v209
    v_add_f32 v210, v210, v211
    v_add_f32 v212, v212, v213
    v_add_f32 v214, v214, v215
    v_add_f32 v216, v216, v217
    v_add_f32 v218, v218, v219
    v_add_f32 v220, v220, v221
    v_add_f32 v222, v222, v223
    s_barrier
    v_cvt_pk_bf16_f32 v224, v190, v192
    v_cvt_pk_bf16_f32 v225, v194, v196
    v_cvt_pk_bf16_f32 v226, v198, v200
    v_cvt_pk_bf16_f32 v227, v202, v204
    v_cvt_pk_bf16_f32 v228, v206, v208
    v_cvt_pk_bf16_f32 v229, v210, v212
    v_cvt_pk_bf16_f32 v230, v214, v216
    v_cvt_pk_bf16_f32 v231, v218, v220
    v_cvt_pk_bf16_f32 v232, v192, v194
    v_cvt_pk_bf16_f32 v233, v196, v198
    v_cvt_pk_bf16_f32 v234, v200, v202
    v_cvt_pk_bf16_f32 v235, v204, v206
    v_cvt_pk_bf16_f32 v236, v208, v210
    v_cvt_pk_bf16_f32 v237, v212, v214
    v_cvt_pk_bf16_f32 v238, v216, v218
    v_cvt_pk_bf16_f32 v239, v220, v222
    ds_write_b128 v188, v[224:227] offset:0
    ds_write_b128 v188, v[228:231] offset:16
    ds_write_b128 v188, v[232:235] offset:9024
    ds_write_b128 v188, v[236:239] offset:9040
    s_mov_b32 s82, 0x3b124925
    s_mov_b32 s83, 0x3727c5ac
    v_mov_b32 v136, s83
    s_waitcnt vmcnt(4)
    v_pk_mul_f32 v[32:33], v[32:33], s[82:83] op_sel_hi:[1,0]
    v_pk_fma_f32 v[34:35], v[34:35], s[82:83], v[136:137] op_sel_hi:[1,0,0]
    v_pk_fma_f32 v[34:35], v[32:33], v[32:33], v[34:35] neg_lo:[1,0,0] neg_hi:[1,0,0]
    v_max_f32 v34, s83, v34
    v_max_f32 v35, s83, v35
    v_rsq_f32 v34, v34
    v_rsq_f32 v35, v35
    s_waitcnt vmcnt(3)
    v_lshlrev_b32 v64, 16, v40
    v_and_b32 v66, s65, v40
    v_lshlrev_b32 v65, 16, v41
    v_and_b32_e64 v67, s65, v41
    v_pk_mul_f32 v[32:33], v[32:33], v[34:35]
    v_pk_fma_f32 v[64:65], v[64:65], v[34:35], v[32:33] neg_lo:[0,0,1] neg_hi:[0,0,1]
    v_perm_b32 v72, v41, v40, s91
    v_pk_fma_f32 v[66:67], v[66:67], v[34:35], v[32:33] neg_lo:[0,0,1] neg_hi:[0,0,1]
    v_perm_b32 v74, v41, v40, s92
    v_cvt_pk_bf16_f32 v68, v64, v65
    v_cvt_pk_bf16_f32 v70, v66, v67
    s_waitcnt vmcnt(2)
    v_pk_mul_f32 v[36:37], v[36:37], s[82:83] op_sel_hi:[1,0]
    v_pk_fma_f32 v[38:39], v[38:39], s[82:83], v[136:137] op_sel_hi:[1,0,0]
    v_pk_fma_f32 v[38:39], v[36:37], v[36:37], v[38:39] neg_lo:[1,0,0] neg_hi:[1,0,0]
    v_max_f32 v38, s83, v38
    v_max_f32 v39, s83, v39
    v_rsq_f32 v38, v38
    v_rsq_f32 v39, v39
    s_waitcnt vmcnt(1)
    v_lshlrev_b32 v64, 16, v42
    v_and_b32 v66, s65, v42
    v_lshlrev_b32 v65, 16, v43
    v_and_b32 v67, s65, v43
    v_pk_mul_f32 v[36:37], v[36:37], v[38:39]
    v_pk_fma_f32 v[64:65], v[64:65], v[38:39], v[36:37] neg_lo:[0,0,1] neg_hi:[0,0,1]
    v_perm_b32 v73, v43, v42, s91
    v_pk_fma_f32 v[66:67], v[66:67], v[38:39], v[36:37] neg_lo:[0,0,1] neg_hi:[0,0,1]
    v_perm_b32 v75, v43, v42, s92
    v_cvt_pk_bf16_f32 v69, v64, v65
    v_cvt_pk_bf16_f32 v71, v66, v67
    ds_write_b64 v4, v[68:69] offset:0
    ds_write_b64 v4, v[70:71] offset:4576
    ds_write_b64 v5, v[72:73] offset:0
    ds_write_b64 v5, v[74:75] offset:17920
    s_waitcnt vmcnt(0)
    v_cmp_eq_u32 vcc, 0, v60
    s_cbranch_vccnz L_slow_13
L_ok_15:
    s_waitcnt lgkmcnt(0)
    s_barrier
    s_nop 0
    ds_read_b128 a[224:227], v10 offset:1728
    ds_read2_b32 v[64:65], v6 offset0:176 offset1:177
    ds_read2_b32 v[66:67], v6 offset0:178 offset1:179
    ds_read_b128 a[228:231], v10 offset:1216
    ds_read2_b32 v[68:69], v6 offset0:48 offset1:49
    ds_read2_b32 v[70:71], v6 offset0:50 offset1:51
    ds_read_b128 a[232:235], v10 offset:704
    ds_read2_b32 v[72:73], v7 offset0:176 offset1:177
    ds_read2_b32 v[74:75], v7 offset0:178 offset1:179
    ds_read_b128 a[236:239], v10 offset:192
    ds_read2_b32 v[76:77], v7 offset0:48 offset1:49
    ds_read2_b32 v[78:79], v7 offset0:50 offset1:51
    s_waitcnt lgkmcnt(9)
    v_mfma_f32_16x16x32_bf16 v[44:47], a[224:227], v[64:67], 0
    ds_read_b128 a[224:227], v10 offset:1664
    s_waitcnt lgkmcnt(9)
    v_mfma_f32_16x16x32_bf16 v[40:43], a[228:231], v[64:67], 0
    ds_read2_b32 v[80:81], v6 offset0:160 offset1:161
    s_waitcnt lgkmcnt(8)
    v_mfma_f32_16x16x32_bf16 v[44:47], a[228:231], v[68:71], v[44:47]
    ds_read2_b32 v[82:83], v6 offset0:162 offset1:163
    s_waitcnt lgkmcnt(8)
    v_mfma_f32_16x16x32_bf16 v[36:39], a[232:235], v[64:67], 0
    ds_read_b128 a[228:231], v10 offset:1152
    v_mfma_f32_16x16x32_bf16 v[40:43], a[232:235], v[68:71], v[40:43]
    ds_read2_b32 v[84:85], v6 offset0:32 offset1:33
    s_waitcnt lgkmcnt(8)
    v_mfma_f32_16x16x32_bf16 v[44:47], a[232:235], v[72:75], v[44:47]
    ds_read2_b32 v[86:87], v6 offset0:34 offset1:35
    s_waitcnt lgkmcnt(8)
    v_mfma_f32_16x16x32_bf16 v[32:35], a[236:239], v[64:67], 0
    s_add_u32 s89, s89, 6144
    buffer_load_dwordx4 v20, s[16:19], s89 offen offset:2048 lds
    ds_read_b128 a[232:235], v10 offset:640
    v_mfma_f32_16x16x32_bf16 v[36:39], a[236:239], v[68:71], v[36:39]
    ds_read2_b32 v[88:89], v7 offset0:160 offset1:161
    v_mfma_f32_16x16x32_bf16 v[40:43], a[236:239], v[72:75], v[40:43]
    s_mov_b32 s66, 0x1806000
    ds_read2_b32 v[90:91], v7 offset0:162 offset1:163
    s_waitcnt lgkmcnt(8)
    v_mfma_f32_16x16x32_bf16 v[44:47], a[236:239], v[76:79], v[44:47]
    s_add_u32 s69, s75, 0x2000
    ds_read_b128 a[236:239], v10 offset:128
    s_waitcnt lgkmcnt(7)
    v_mfma_f32_16x16x32_bf16 v[44:47], a[224:227], v[80:83], v[44:47]
    buffer_load_dwordx4 v[244:247], v3, s[4:7], s66 offen offset:0 sc1
    ds_read2_b32 v[92:93], v7 offset0:32 offset1:33
    s_waitcnt lgkmcnt(7)
    v_mfma_f32_16x16x32_bf16 v[40:43], a[228:231], v[80:83], v[40:43]
    buffer_load_dwordx2 v[252:253], v3, s[4:7], s69 offen offset:0 sc1
    ds_read2_b32 v[94:95], v7 offset0:34 offset1:35
    s_waitcnt lgkmcnt(6)
    v_mfma_f32_16x16x32_bf16 v[44:47], a[228:231], v[84:87], v[44:47]
    buffer_load_dwordx4 v[248:251], v3, s[4:7], s66 offen offset:128 sc1
    ds_read_b128 a[224:227], v10 offset:1600
    s_waitcnt lgkmcnt(6)
    v_mfma_f32_16x16x32_bf16 v[36:39], a[232:235], v[80:83], v[36:39]
    buffer_load_dwordx2 v[254:255], v3, s[4:7], s69 offen offset:128 sc1
    ds_read2_b32 v[96:97], v6 offset0:144 offset1:145
    v_mfma_f32_16x16x32_bf16 v[40:43], a[232:235], v[84:87], v[40:43]
    s_add_u32 s89, s89, 6144
    buffer_load_dwordx4 v20, s[16:19], s89 offen offset:3072 lds
    ds_read2_b32 v[98:99], v6 offset0:146 offset1:147
    s_waitcnt lgkmcnt(6)
    v_mfma_f32_16x16x32_bf16 v[44:47], a[232:235], v[88:91], v[44:47]
    s_add_u32 s63, s63, 1
    s_cmp_eq_u32 s63, 7
    s_cselect_b32 s63, 0, s63
    s_lshl_b32 s70, s63, 12
    s_add_u32 m0, s70, s100
    s_mul_i32 s89, s70, 7
    s_add_u32 s89, s89, s76
    buffer_load_dwordx4 v20, s[16:19], s89 offen offset:0 lds
    ds_read_b128 a[228:231], v10 offset:1088
    s_waitcnt lgkmcnt(6)
    v_mfma_f32_16x16x32_bf16 v[32:35], a[236:239], v[80:83], v[32:35]
    ds_read2_b32 v[100:101], v6 offset0:16 offset1:17
    v_mfma_f32_16x16x32_bf16 v[36:39], a[236:239], v[84:87], v[36:39]
    ds_read2_b32 v[102:103], v6 offset0:18 offset1:19
    v_mfma_f32_16x16x32_bf16 v[40:43], a[236:239], v[88:91], v[40:43]
    ds_read_b64_tr_b16 v[136:137], v11 offset:0
    ds_read_b128 a[232:235], v10 offset:576
    s_waitcnt lgkmcnt(8)
    v_mfma_f32_16x16x32_bf16 v[44:47], a[236:239], v[92:95], v[44:47]
    ds_read_b64_tr_b16 v[138:139], v11 offset:512
    ds_read2_b32 v[104:105], v7 offset0:144 offset1:145
    s_waitcnt lgkmcnt(7)
    v_mfma_f32_16x16x32_bf16 v[44:47], a[224:227], v[96:99], v[44:47]
    ds_read2_b32 v[106:107], v7 offset0:146 offset1:147
    s_waitcnt lgkmcnt(7)
    v_mfma_f32_16x16x32_bf16 v[40:43], a[228:231], v[96:99], v[40:43]
    ds_read_b128 a[224:227], v10 offset:64
    s_waitcnt lgkmcnt(6)
    v_mfma_f32_16x16x32_bf16 v[44:47], a[228:231], v[100:103], v[44:47]
    ds_read2_b32 v[108:109], v7 offset0:16 offset1:17
    s_waitcnt lgkmcnt(5)
    v_mfma_f32_16x16x32_bf16 v[36:39], a[232:235], v[96:99], v[36:39]
    ds_read2_b32 v[110:111], v7 offset0:18 offset1:19
    v_mfma_f32_16x16x32_bf16 v[40:43], a[232:235], v[100:103], v[40:43]
    ds_read_b128 a[228:231], v10 offset:1536
    s_waitcnt lgkmcnt(4)
    v_mfma_f32_16x16x32_bf16 v[44:47], a[232:235], v[104:107], v[44:47]
    ds_read2_b32 v[112:113], v6 offset0:128 offset1:129
    s_waitcnt lgkmcnt(4)
    v_mfma_f32_16x16x32_bf16 v[32:35], a[224:227], v[96:99], v[32:35]
    v_lshlrev_b32 v128, 16, v136
    ds_read2_b32 v[114:115], v6 offset0:130 offset1:131
    v_mfma_f32_16x16x32_bf16 v[36:39], a[224:227], v[100:103], v[36:39]
    v_and_b32_e64 v129, s65, v136
    ds_read_b128 a[232:235], v10 offset:1024
    v_mfma_f32_16x16x32_bf16 v[40:43], a[224:227], v[104:107], v[40:43]
    v_lshlrev_b32_e64 v130, 16, v137
    ds_read2_b32 v[116:117], v6 offset0:0 offset1:1
    s_waitcnt lgkmcnt(5)
    v_mfma_f32_16x16x32_bf16 v[44:47], a[224:227], v[108:111], v[44:47]
    v_and_b32 v131, s65, v137
    ds_read2_b32 v[118:119], v6 offset0:2 offset1:3
    s_waitcnt lgkmcnt(3)
    v_mfma_f32_16x16x32_bf16 v[44:47], a[228:231], v[112:115], v[44:47]
    v_lshlrev_b32 v132, 16, v138
    ds_read_b128 a[224:227], v10 offset:512
    s_waitcnt lgkmcnt(3)
    v_mfma_f32_16x16x32_bf16 v[40:43], a[232:235], v[112:115], v[40:43]
    v_and_b32 v133, s65, v138
    ds_read2_b32 v[120:121], v7 offset0:128 offset1:129
    s_waitcnt lgkmcnt(2)
    v_mfma_f32_16x16x32_bf16 v[44:47], a[232:235], v[116:119], v[44:47]
    v_lshlrev_b32 v134, 16, v139
    ds_read2_b32 v[122:123], v7 offset0:130 offset1:131
    s_waitcnt lgkmcnt(2)
    v_mfma_f32_16x16x32_bf16 v[36:39], a[224:227], v[112:115], v[36:39]
    v_and_b32 v135, s65, v139
    ds_read_b128 a[236:239], v10 offset:0
    v_mfma_f32_16x16x32_bf16 v[40:43], a[224:227], v[116:119], v[40:43]
    s_add_u32 s89, s89, 6144
    buffer_load_dwordx4 v20, s[16:19], s89 offen offset:1024 lds
    ds_read2_b32 v[124:125], v7 offset0:0 offset1:1
    s_waitcnt lgkmcnt(2)
    v_mfma_f32_16x16x32_bf16 v[44:47], a[224:227], v[120:123], v[44:47]
    s_add_u32 s89, s89, 6144
    buffer_load_dwordx4 v20, s[16:19], s89 offen offset:2048 lds
    ds_read2_b32 v[126:127], v7 offset0:2 offset1:3
    s_waitcnt lgkmcnt(2)
    v_mfma_f32_16x16x32_bf16 v[32:35], a[236:239], v[112:115], v[32:35]
    s_add_u32 s89, s89, 6144
    buffer_load_dwordx4 v20, s[16:19], s89 offen offset:3072 lds
    ds_read2_b32 a[240:241], v9 offset0:0 offset1:1
    v_mfma_f32_16x16x32_bf16 v[36:39], a[236:239], v[116:119], v[36:39]
    s_add_u32 s63, s63, 1
    s_cmp_eq_u32 s63, 7
    s_cselect_b32 s63, 0, s63
    s_lshl_b32 s70, s63, 12
    s_add_u32 m0, s70, s100
    s_mul_i32 s89, s70, 7
    s_add_u32 s89, s89, s76
    buffer_load_dwordx4 v20, s[16:19], s89 offen offset:0 lds
    ds_read2_b32 a[242:243], v9 offset0:2 offset1:3
    v_mfma_f32_16x16x32_bf16 v[40:43], a[236:239], v[120:123], v[40:43]
    buffer_load_dword v23, v24, s[4:7], 0 offen offset:32 sc1
    s_add_u32 s89, s89, 6144
    buffer_load_dwordx4 v20, s[16:19], s89 offen offset:1024 lds
    ds_read2_b32 a[244:245], v9 offset0:128 offset1:129
    ds_read2_b32 a[246:247], v9 offset0:130 offset1:131
    s_waitcnt lgkmcnt(4)
    v_mfma_f32_16x16x32_bf16 v[44:47], a[236:239], v[124:127], v[44:47]
    ds_read2_b32 a[248:249], v8 offset0:0 offset1:1
    s_waitcnt lgkmcnt(3)
    v_mfma_f32_16x16x32_bf16 v[60:63], a[236:239], a[240:243], 0
    s_cmp_eq_u32 s93, 1
    s_cbranch_scc1 L_x1_16
    ds_write_b128 v13, v[40:43] offset:2048
    s_nop 1
    ds_write_b128 v13, v[44:47] offset:3072
    v_pk_add_f32 v[128:129], v[128:129], v[32:33]
    v_pk_add_f32 v[130:131], v[130:131], v[34:35]
    v_pk_add_f32 v[132:133], v[132:133], v[36:37]
    v_pk_add_f32 v[134:135], v[134:135], v[38:39]
    s_branch L_xj_17
    s_nop 0
L_x1_16:
    ds_write_b128 v13, v[32:35] offset:2048
    ds_write_b128 v13, v[36:39] offset:3072
    v_pk_add_f32 v[128:129], v[128:129], v[40:41]
    v_pk_add_f32 v[130:131], v[130:131], v[42:43]
    v_pk_add_f32 v[132:133], v[132:133], v[44:45]
    v_pk_add_f32 v[134:135], v[134:135], v[46:47]
L_xj_17:
    s_add_u32 s89, s89, 6144
    buffer_load_dwordx4 v20, s[16:19], s89 offen offset:2048 lds
    ds_read2_b32 a[250:251], v8 offset0:2 offset1:3
    s_waitcnt lgkmcnt(4)
    v_mfma_f32_16x16x32_bf16 v[56:59], a[236:239], a[244:247], 0
    s_waitcnt lgkmcnt(1)
    s_barrier
    ds_read_b128 v[32:35], v14 offset:2048
    ds_read_b128 v[36:39], v14 offset:3072
    ds_read2_b32 a[240:241], v8 offset0:128 offset1:129
    v_mfma_f32_16x16x32_bf16 v[60:63], a[224:227], a[244:247], v[60:63]
    ds_read2_b32 a[242:243], v8 offset0:130 offset1:131
    s_waitcnt lgkmcnt(4)
    v_mfma_f32_16x16x32_bf16 v[52:55], a[236:239], a[248:251], 0
    ds_read_b128 a[244:247], v10 offset:64
    v_mfma_f32_16x16x32_bf16 v[56:59], a[224:227], a[248:251], v[56:59]
    s_add_u32 s89, s89, 6144
    buffer_load_dwordx4 v20, s[16:19], s89 offen offset:3072 lds
    ds_read2_b32 a[252:253], v9 offset0:16 offset1:17
    v_mfma_f32_16x16x32_bf16 v[60:63], a[232:235], a[248:251], v[60:63]
    s_waitcnt lgkmcnt(5)
    v_pk_add_f32 v[128:129], v[128:129], v[32:33]
    v_pk_add_f32 v[130:131], v[130:131], v[34:35]
    s_waitcnt lgkmcnt(4)
    v_pk_add_f32 v[132:133], v[132:133], v[36:37]
    v_pk_add_f32 v[134:135], v[134:135], v[38:39]
    v_cvt_pk_bf16_f32 v40, v128, v129
    v_cvt_pk_bf16_f32 v41, v130, v131
    v_cvt_pk_bf16_f32 v42, v132, v133
    v_cvt_pk_bf16_f32 v43, v134, v135
    s_mov_b32 s67, 0x3e0000
    buffer_store_dwordx4 v[40:43], v12, s[4:7], s67 offen sc1
    ds_read2_b32 a[254:255], v9 offset0:18 offset1:19
    s_waitcnt lgkmcnt(3)
    v_mfma_f32_16x16x32_bf16 v[48:51], a[236:239], a[240:243], 0
    ds_read2_b32 a[236:237], v9 offset0:144 offset1:145
    v_mfma_f32_16x16x32_bf16 v[52:55], a[224:227], a[240:243], v[52:55]
    ds_read2_b32 a[238:239], v9 offset0:146 offset1:147
    v_mfma_f32_16x16x32_bf16 v[56:59], a[232:235], a[240:243], v[56:59]
    s_add_u32 s63, s63, 1
    s_cmp_eq_u32 s63, 7
    s_cselect_b32 s63, 0, s63
    s_lshl_b32 s70, s63, 12
    s_add_u32 m0, s70, s100
    s_mul_i32 s89, s70, 7
    s_add_u32 s89, s89, s76
    buffer_load_dwordx4 v20, s[16:19], s89 offen offset:0 lds
    ds_read_b128 a[248:251], v10 offset:576
    v_mfma_f32_16x16x32_bf16 v[60:63], a[228:231], a[240:243], v[60:63]
    ds_read2_b32 a[240:241], v8 offset0:16 offset1:17
    v_mfma_f32_16x16x32_bf16 v[48:51], a[224:227], v[124:127], v[48:51]
    ds_read2_b32 a[242:243], v8 offset0:18 offset1:19
    v_mfma_f32_16x16x32_bf16 v[52:55], a[232:235], v[124:127], v[52:55]
    ds_read_b128 a[224:227], v10 offset:1088
    v_mfma_f32_16x16x32_bf16 v[56:59], a[228:231], v[124:127], v[56:59]
    ds_read2_b32 v[140:141], v8 offset0:144 offset1:145
    v_mfma_f32_16x16x32_bf16 v[48:51], a[232:235], v[120:123], v[48:51]
    s_add_u32 s89, s89, 6144
    buffer_load_dwordx4 v20, s[16:19], s89 offen offset:1024 lds
    ds_read2_b32 v[142:143], v8 offset0:146 offset1:147
    v_mfma_f32_16x16x32_bf16 v[52:55], a[228:231], v[120:123], v[52:55]
    ds_read_b128 a[232:235], v10 offset:1600
    v_mfma_f32_16x16x32_bf16 v[48:51], a[228:231], v[116:119], v[48:51]
    ds_read_b128 a[228:231], v10 offset:128
    s_waitcnt lgkmcnt(7)
    v_mfma_f32_16x16x32_bf16 v[60:63], a[244:247], a[252:255], v[60:63]
    ds_read2_b32 a[252:253], v9 offset0:32 offset1:33
    v_mfma_f32_16x16x32_bf16 v[56:59], a[244:247], a[236:239], v[56:59]
    s_add_u32 s89, s89, 6144
    buffer_load_dwordx4 v20, s[16:19], s89 offen offset:2048 lds
    ds_read2_b32 a[254:255], v9 offset0:34 offset1:35
    v_mfma_f32_16x16x32_bf16 v[60:63], a[248:251], a[236:239], v[60:63]
    ds_read2_b32 a[236:237], v9 offset0:160 offset1:161
    s_waitcnt lgkmcnt(7)
    v_mfma_f32_16x16x32_bf16 v[52:55], a[244:247], a[240:243], v[52:55]
    ds_read2_b32 a[238:239], v9 offset0:162 offset1:163
    v_mfma_f32_16x16x32_bf16 v[56:59], a[248:251], a[240:243], v[56:59]
    ds_read_b128 v[44:47], v10 offset:640
    v_mfma_f32_16x16x32_bf16 v[60:63], a[224:227], a[240:243], v[60:63]
    s_add_u32 s89, s89, 6144
    buffer_load_dwordx4 v20, s[16:19], s89 offen offset:3072 lds
    ds_read2_b32 a[240:241], v8 offset0:32 offset1:33
    s_waitcnt lgkmcnt(7)
    v_mfma_f32_16x16x32_bf16 v[48:51], a[244:247], v[140:143], v[48:51]
    ds_read2_b32 a[242:243], v8 offset0:34 offset1:35
    v_mfma_f32_16x16x32_bf16 v[52:55], a[248:251], v[140:143], v[52:55]
    ds_read_b128 a[244:247], v10 offset:1152
    v_mfma_f32_16x16x32_bf16 v[56:59], a[224:227], v[140:143], v[56:59]
    v_mfma_f32_16x16x32_bf16 v[60:63], a[232:235], v[140:143], v[60:63]
    s_waitcnt vmcnt(8)
    v_cmp_eq_u32 vcc, 0, v23
    s_cbranch_vccnz L_slow_18
L_ok_20:
    buffer_load_dwordx4 v[144:147], v2, s[4:7], s88 offen offset:0 sc1
    ds_read2_b32 v[140:141], v8 offset0:160 offset1:161
    v_mfma_f32_16x16x32_bf16 v[48:51], a[248:251], v[108:111], v[48:51]
    ds_read2_b32 v[142:143], v8 offset0:162 offset1:163
    v_mfma_f32_16x16x32_bf16 v[52:55], a[224:227], v[108:111], v[52:55]
    ds_read_b128 a[248:251], v10 offset:1664
    v_mfma_f32_16x16x32_bf16 v[56:59], a[232:235], v[108:111], v[56:59]
    v_mfma_f32_16x16x32_bf16 v[48:51], a[224:227], v[104:107], v[48:51]
    buffer_load_dwordx4 v[148:151], v2, s[4:7], s88 offen offset:1024 sc1
    ds_read_b128 a[224:227], v10 offset:192
    v_mfma_f32_16x16x32_bf16 v[52:55], a[232:235], v[104:107], v[52:55]
    v_mfma_f32_16x16x32_bf16 v[48:51], a[232:235], v[100:103], v[48:51]
    buffer_load_dwordx4 v[152:155], v2, s[4:7], s88 offen offset:2048 sc1
    ds_read2_b32 a[232:233], v9 offset0:48 offset1:49
    s_waitcnt lgkmcnt(6)
    v_mfma_f32_16x16x32_bf16 v[60:63], a[228:231], a[252:255], v[60:63]
    ds_read2_b32 a[234:235], v9 offset0:50 offset1:51
    v_mfma_f32_16x16x32_bf16 v[56:59], a[228:231], a[236:239], v[56:59]
    ds_read2_b32 a[252:253], v9 offset0:176 offset1:177
    v_mfma_f32_16x16x32_bf16 v[60:63], v[44:47], a[236:239], v[60:63]
    ds_read2_b32 a[254:255], v9 offset0:178 offset1:179
    v_mfma_f32_16x16x32_bf16 v[52:55], a[228:231], a[240:243], v[52:55]
    ds_read_b128 a[236:239], v10 offset:704
    v_mfma_f32_16x16x32_bf16 v[56:59], v[44:47], a[240:243], v[56:59]
    s_waitcnt lgkmcnt(7)
    v_mfma_f32_16x16x32_bf16 v[60:63], a[244:247], a[240:243], v[60:63]
    buffer_load_dwordx4 v[156:159], v2, s[4:7], s88 offen offset:3072 sc1
    s_add_u32 s88, s88, 4096
    ds_read2_b32 a[240:241], v8 offset0:48 offset1:49
    v_mfma_f32_16x16x32_bf16 v[48:51], a[228:231], v[140:143], v[48:51]
    ds_read2_b32 a[242:243], v8 offset0:50 offset1:51
    v_mfma_f32_16x16x32_bf16 v[52:55], v[44:47], v[140:143], v[52:55]
    ds_read_b128 a[228:231], v10 offset:1216
    v_mfma_f32_16x16x32_bf16 v[56:59], a[244:247], v[140:143], v[56:59]
    s_waitcnt lgkmcnt(9)
    v_mfma_f32_16x16x32_bf16 v[60:63], a[248:251], v[140:143], v[60:63]
    buffer_load_dwordx4 v[160:163], v2, s[4:7], s88 offen offset:0 sc1
    ds_read2_b32 v[140:141], v8 offset0:176 offset1:177
    v_mfma_f32_16x16x32_bf16 v[48:51], v[44:47], v[92:95], v[48:51]
    ds_read2_b32 v[142:143], v8 offset0:178 offset1:179
    v_mfma_f32_16x16x32_bf16 v[52:55], a[244:247], v[92:95], v[52:55]
    ds_read_b128 v[44:47], v10 offset:1728
    v_mfma_f32_16x16x32_bf16 v[56:59], a[248:251], v[92:95], v[56:59]
    v_mfma_f32_16x16x32_bf16 v[48:51], a[244:247], v[88:91], v[48:51]
    buffer_load_dwordx4 v[164:167], v2, s[4:7], s88 offen offset:1024 sc1
    v_mfma_f32_16x16x32_bf16 v[52:55], a[248:251], v[88:91], v[52:55]
    v_mfma_f32_16x16x32_bf16 v[48:51], a[248:251], v[84:87], v[48:51]
    s_mov_b32 s82, 0x3b124925
    s_mov_b32 s83, 0x3727c5ac
    v_mov_b32 v136, s83
    v_pk_mul_f32 v[244:245], v[244:245], s[82:83] op_sel_hi:[1,0]
    v_pk_fma_f32 v[246:247], v[246:247], s[82:83], v[136:137] op_sel_hi:[1,0,0]
    v_pk_fma_f32 v[246:247], v[244:245], v[244:245], v[246:247] neg_lo:[1,0,0] neg_hi:[1,0,0]
    v_max_f32 v246, s83, v246
    v_max_f32 v247, s83, v247
    v_rsq_f32 v246, v246
    v_rsq_f32 v247, v247
    v_lshlrev_b32 v32, 16, v252
    v_and_b32 v34, s65, v252
    v_lshlrev_b32 v33, 16, v253
    v_and_b32 v35, s65, v253
    v_pk_mul_f32 v[244:245], v[244:245], v[246:247]
    v_pk_fma_f32 v[32:33], v[32:33], v[246:247], v[244:245] neg_lo:[0,0,1] neg_hi:[0,0,1]
    v_perm_b32 v40, v253, v252, s91
    v_pk_fma_f32 v[34:35], v[34:35], v[246:247], v[244:245] neg_lo:[0,0,1] neg_hi:[0,0,1]
    v_perm_b32 v42, v253, v252, s92
    v_cvt_pk_bf16_f32 v36, v32, v33
    v_cvt_pk_bf16_f32 v38, v34, v35
    v_pk_mul_f32 v[248:249], v[248:249], s[82:83] op_sel_hi:[1,0]
    v_pk_fma_f32 v[250:251], v[250:251], s[82:83], v[136:137] op_sel_hi:[1,0,0]
    v_pk_fma_f32 v[250:251], v[248:249], v[248:249], v[250:251] neg_lo:[1,0,0] neg_hi:[1,0,0]
    v_max_f32 v250, s83, v250
    v_max_f32 v251, s83, v251
    v_rsq_f32 v250, v250
    v_rsq_f32 v251, v251
    v_lshlrev_b32 v32, 16, v254
    v_and_b32 v34, s65, v254
    v_lshlrev_b32 v33, 16, v255
    v_and_b32 v35, s65, v255
    v_pk_mul_f32 v[248:249], v[248:249], v[250:251]
    v_pk_fma_f32 v[32:33], v[32:33], v[250:251], v[248:249] neg_lo:[0,0,1] neg_hi:[0,0,1]
    v_perm_b32 v41, v255, v254, s91
    v_pk_fma_f32 v[34:35], v[34:35], v[250:251], v[248:249] neg_lo:[0,0,1] neg_hi:[0,0,1]
    v_perm_b32 v43, v255, v254, s92
    v_cvt_pk_bf16_f32 v37, v32, v33
    v_cvt_pk_bf16_f32 v39, v34, v35
    s_waitcnt lgkmcnt(4)
    v_mfma_f32_16x16x32_bf16 v[60:63], a[224:227], a[232:235], v[60:63]
    ds_write_b64 v4, v[36:37] offset:2048
    ds_write_b64 v4, v[38:39] offset:6624
    v_mfma_f32_16x16x32_bf16 v[56:59], a[224:227], a[252:255], v[56:59]
    ds_write_b64 v5, v[40:41] offset:1024
    ds_write_b64 v5, v[42:43] offset:18944
    v_mfma_f32_16x16x32_bf16 v[60:63], a[236:239], a[252:255], v[60:63]
    buffer_load_dword v23, v24, s[4:7], 0 offen offset:0 sc1
    buffer_load_dwordx4 v[168:171], v2, s[4:7], s88 offen offset:2048 sc1
    v_mfma_f32_16x16x32_bf16 v[52:55], a[224:227], a[240:243], v[52:55]
    v_mfma_f32_16x16x32_bf16 v[56:59], a[236:239], a[240:243], v[56:59]
    buffer_load_dwordx4 v[172:175], v2, s[4:7], s88 offen offset:3072 sc1
    s_add_u32 s88, s88, 4096
    s_waitcnt lgkmcnt(5)
    v_mfma_f32_16x16x32_bf16 v[60:63], a[228:231], a[240:243], v[60:63]
    s_waitcnt vmcnt(13)
    s_waitcnt lgkmcnt(0)
    s_barrier
    s_mov_b32 s66, 0x8000
    s_mov_b64 exec, 3
    buffer_store_dword v17, v15, s[4:7], s66 offen sc1
    s_mov_b64 exec, -1
    ds_read_b128 a[232:235], v10 offset:3776
    ds_read_b128 a[240:243], v10 offset:3264
    ds_read_b128 a[244:247], v10 offset:2752
    ds_read_b128 a[248:251], v10 offset:2240
    ds_read_b128 a[252:255], v10 offset:3712
    v_mfma_f32_16x16x32_bf16 v[48:51], a[224:227], v[140:143], v[48:51]
    ds_read_b128 a[224:227], v10 offset:3200
    v_mfma_f32_16x16x32_bf16 v[52:55], a[236:239], v[140:143], v[52:55]
    v_mfma_f32_16x16x32_bf16 v[56:59], a[228:231], v[140:143], v[56:59]
    v_mfma_f32_16x16x32_bf16 v[60:63], v[44:47], v[140:143], v[60:63]
    buffer_load_dwordx4 v[176:179], v2, s[4:7], s88 offen offset:0 sc1
    ds_read_b128 v[140:143], v10 offset:2688
    v_mfma_f32_16x16x32_bf16 v[48:51], a[236:239], v[76:79], v[48:51]
    v_mfma_f32_16x16x32_bf16 v[52:55], a[228:231], v[76:79], v[52:55]
    ds_read_b128 a[236:239], v10 offset:2176
    v_mfma_f32_16x16x32_bf16 v[56:59], v[44:47], v[76:79], v[56:59]
    v_mfma_f32_16x16x32_bf16 v[48:51], a[228:231], v[72:75], v[48:51]
    buffer_load_dwordx4 v[180:183], v2, s[4:7], s88 offen offset:1024 sc1
    v_mfma_f32_16x16x32_bf16 v[52:55], v[44:47], v[72:75], v[52:55]
    v_mfma_f32_16x16x32_bf16 v[48:51], v[44:47], v[68:71], v[48:51]
    ds_read_b128 a[228:231], v10 offset:3648
    s_waitcnt lgkmcnt(6)
    v_mfma_f32_16x16x32_bf16 v[60:63], a[232:235], v[64:67], v[60:63]
    ds_read_b128 a[232:235], v10 offset:3136
    v_mfma_f32_16x16x32_bf16 v[56:59], a[240:243], v[64:67], v[56:59]
    v_mfma_f32_16x16x32_bf16 v[60:63], a[240:243], v[68:71], v[60:63]
    buffer_load_dwordx4 v[184:187], v2, s[4:7], s88 offen offset:2048 sc1
    ds_read_b128 a[240:243], v10 offset:2624
    v_mfma_f32_16x16x32_bf16 v[52:55], a[244:247], v[64:67], v[52:55]
    v_mfma_f32_16x16x32_bf16 v[56:59], a[244:247], v[68:71], v[56:59]
    v_mfma_f32_16x16x32_bf16 v[60:63], a[244:247], v[72:75], v[60:63]
    buffer_load_dwordx4 v[188:191], v2, s[4:7], s88 offen offset:3072 sc1
    s_add_u32 s88, s88, 4096
    ds_read_b128 a[244:247], v10 offset:2112
    s_waitcnt lgkmcnt(8)
    v_mfma_f32_16x16x32_bf16 v[48:51], a[248:251], v[64:67], v[48:51]
    v_mfma_f32_16x16x32_bf16 v[52:55], a[248:251], v[68:71], v[52:55]
    v_mfma_f32_16x16x32_bf16 v[56:59], a[248:251], v[72:75], v[56:59]
    v_mfma_f32_16x16x32_bf16 v[60:63], a[248:251], v[76:79], v[60:63]
    buffer_load_dwordx4 v[192:195], v2, s[4:7], s88 offen offset:0 sc1
    ds_read_b128 a[248:251], v10 offset:3584
    s_waitcnt lgkmcnt(6)
    v_mfma_f32_16x16x32_bf16 v[60:63], a[252:255], v[80:83], v[60:63]
    ds_read_b128 a[252:255], v10 offset:3072
    v_mfma_f32_16x16x32_bf16 v[56:59], a[224:227], v[80:83], v[56:59]
    v_mfma_f32_16x16x32_bf16 v[60:63], a[224:227], v[84:87], v[60:63]
    ds_read_b128 a[224:227], v10 offset:2560
    v_mfma_f32_16x16x32_bf16 v[52:55], v[140:143], v[80:83], v[52:55]
L_pg2:
    s_cbranch_execz L_ret0
    s_nop 0
    v_mfma_f32_16x16x32_bf16 v[56:59], v[140:143], v[84:87], v[56:59]
    buffer_load_dwordx4 v[196:199], v2, s[4:7], s88 offen offset:1024 sc1
    v_mfma_f32_16x16x32_bf16 v[60:63], v[140:143], v[88:91], v[60:63]
    ds_read_b128 v[140:143], v10 offset:2048
    s_waitcnt lgkmcnt(8)
    v_mfma_f32_16x16x32_bf16 v[48:51], a[236:239], v[80:83], v[48:51]
    v_mfma_f32_16x16x32_bf16 v[52:55], a[236:239], v[84:87], v[52:55]
    v_mfma_f32_16x16x32_bf16 v[56:59], a[236:239], v[88:91], v[56:59]
    ds_read_b64_tr_b16 v[136:137], v11 offset:1024
    ds_read_b64_tr_b16 v[138:139], v11 offset:1536
    v_mfma_f32_16x16x32_bf16 v[60:63], a[236:239], v[92:95], v[60:63]
    s_waitcnt lgkmcnt(7)
    v_mfma_f32_16x16x32_bf16 v[60:63], a[228:231], v[96:99], v[60:63]
    v_mfma_f32_16x16x32_bf16 v[56:59], a[232:235], v[96:99], v[56:59]
    v_mfma_f32_16x16x32_bf16 v[60:63], a[232:235], v[100:103], v[60:63]
    s_waitcnt lgkmcnt(1)
    v_lshlrev_b32 v128, 16, v136
    v_and_b32_e64 v129, s65, v136
    v_mfma_f32_16x16x32_bf16 v[52:55], a[240:243], v[96:99], v[52:55]
    v_lshlrev_b32 v130, 16, v137
    v_and_b32 v131, s65, v137
    v_mfma_f32_16x16x32_bf16 v[56:59], a[240:243], v[100:103], v[56:59]
    s_waitcnt lgkmcnt(0)
    v_lshlrev_b32 v132, 16, v138
    v_and_b32_e64 v133, s65, v138
    v_mfma_f32_16x16x32_bf16 v[60:63], a[240:243], v[104:107], v[60:63]
    v_lshlrev_b32 v134, 16, v139
    v_and_b32 v135, s65, v139
    v_mfma_f32_16x16x32_bf16 v[48:51], a[244:247], v[96:99], v[48:51]
    s_waitcnt vmcnt(9)
    v_cmp_eq_u32 vcc, 0, v23
    s_cbranch_vccnz L_slow_21
L_ok_23:
    buffer_load_dwordx4 v[200:203], v2, s[4:7], s88 offen offset:2048 sc1
    v_mfma_f32_16x16x32_bf16 v[52:55], a[244:247], v[100:103], v[52:55]
    buffer_load_dwordx4 v[204:207], v2, s[4:7], s88 offen offset:3072 sc1
    s_add_u32 s88, s88, 4096
    v_mfma_f32_16x16x32_bf16 v[56:59], a[244:247], v[104:107], v[56:59]
    buffer_load_dwordx4 v[208:211], v2, s[4:7], s88 offen offset:0 sc1
    v_mfma_f32_16x16x32_bf16 v[60:63], a[244:247], v[108:111], v[60:63]
    v_mfma_f32_16x16x32_bf16 v[60:63], a[248:251], v[112:115], v[60:63]
    buffer_load_dwordx4 v[212:215], v2, s[4:7], s88 offen offset:1024 sc1
    v_mfma_f32_16x16x32_bf16 v[56:59], a[252:255], v[112:115], v[56:59]
    v_mfma_f32_16x16x32_bf16 v[60:63], a[252:255], v[116:119], v[60:63]
    v_mfma_f32_16x16x32_bf16 v[52:55], a[224:227], v[112:115], v[52:55]
    v_mfma_f32_16x16x32_bf16 v[56:59], a[224:227], v[116:119], v[56:59]
    v_mfma_f32_16x16x32_bf16 v[60:63], a[224:227], v[120:123], v[60:63]
    v_mfma_f32_16x16x32_bf16 v[48:51], v[140:143], v[112:115], v[48:51]
    v_mfma_f32_16x16x32_bf16 v[52:55], v[140:143], v[116:119], v[52:55]
    v_mfma_f32_16x16x32_bf16 v[56:59], v[140:143], v[120:123], v[56:59]
    v_mfma_f32_16x16x32_bf16 v[60:63], v[140:143], v[124:127], v[60:63]
    s_cmp_eq_u32 s93, 1
    s_cbranch_scc1 L_x1_24
    s_nop 4
    ds_write_b128 v13, v[56:59] offset:2048
    ds_write_b128 v13, v[60:63] offset:3072
    v_pk_add_f32 v[128:129], v[128:129], v[48:49]
    v_pk_add_f32 v[130:131], v[130:131], v[50:51]
    v_pk_add_f32 v[132:133], v[132:133], v[52:53]
    v_pk_add_f32 v[134:135], v[134:135], v[54:55]
    s_branch L_xj_25
L_x1_24:
    s_nop 3
    ds_write_b128 v13, v[48:51] offset:2048
    ds_write_b128 v13, v[52:55] offset:3072
    v_pk_add_f32 v[128:129], v[128:129], v[56:57]
    v_pk_add_f32 v[130:131], v[130:131], v[58:59]
    v_pk_add_f32 v[132:133], v[132:133], v[60:61]
    v_pk_add_f32 v[134:135], v[134:135], v[62:63]
L_xj_25:
    s_waitcnt lgkmcnt(0)
    s_barrier
    ds_read_b128 v[32:35], v14 offset:2048
    ds_read_b128 v[36:39], v14 offset:3072
    s_add_u32 s97, s74, 0x8000
    buffer_load_dword v19, v16, s[4:7], s97 offen offset:0 sc1
    s_waitcnt lgkmcnt(1)
    v_pk_add_f32 v[128:129], v[128:129], v[32:33]
    v_pk_add_f32 v[130:131], v[130:131], v[34:35]
    s_waitcnt lgkmcnt(0)
    v_pk_add_f32 v[132:133], v[132:133], v[36:37]
    v_pk_add_f32 v[134:135], v[134:135], v[38:39]
    v_cvt_pk_bf16_f32 v40, v128, v129
    v_cvt_pk_bf16_f32 v41, v130, v131
    v_cvt_pk_bf16_f32 v42, v132, v133
    v_cvt_pk_bf16_f32 v43, v134, v135
    s_mov_b32 s67, 0x3ee000
    buffer_store_dwordx4 v[40:43], v12, s[4:7], s67 offen sc1
    buffer_load_dwordx4 v[216:219], v2, s[4:7], s88 offen offset:2048 sc1
    ds_read_b64_tr_b16 a[0:1], v21 offset:0
    ds_read_b64_tr_b16 a[2:3], v21 offset:1024
    ds_read_b64_tr_b16 a[4:5], v22 offset:0
    ds_read_b64_tr_b16 a[6:7], v22 offset:1024
    ds_read_b64_tr_b16 a[8:9], v21 offset:2048
    ds_read_b64_tr_b16 a[10:11], v21 offset:3072
    ds_read_b64_tr_b16 a[12:13], v22 offset:2048
    ds_read_b64_tr_b16 a[14:15], v22 offset:3072
    ds_read_b64_tr_b16 a[16:17], v21 offset:4096
    ds_read_b64_tr_b16 a[18:19], v21 offset:5120
    ds_read_b64_tr_b16 a[20:21], v22 offset:4096
    ds_read_b64_tr_b16 a[22:23], v22 offset:5120
    ds_read_b64_tr_b16 a[24:25], v21 offset:6144
    ds_read_b64_tr_b16 a[26:27], v21 offset:7168
    buffer_load_dwordx4 v[220:223], v2, s[4:7], s88 offen offset:3072 sc1
    s_add_u32 s88, s88, 4096
    ds_read_b64_tr_b16 a[28:29], v22 offset:6144
    ds_read_b64_tr_b16 a[30:31], v22 offset:7168
    ds_read_b64_tr_b16 a[32:33], v21 offset:8192
    ds_read_b64_tr_b16 a[34:35], v21 offset:9216
    ds_read_b64_tr_b16 a[36:37], v22 offset:8192
    ds_read_b64_tr_b16 a[38:39], v22 offset:9216
    ds_read_b64_tr_b16 a[40:41], v21 offset:10240
    ds_read_b64_tr_b16 a[42:43], v21 offset:11264
    ds_read_b64_tr_b16 a[44:45], v22 offset:10240
    ds_read_b64_tr_b16 a[46:47], v22 offset:11264
    ds_read_b64_tr_b16 a[48:49], v21 offset:12288
    ds_read_b64_tr_b16 a[50:51], v21 offset:13312
    ds_read_b64_tr_b16 a[52:53], v22 offset:12288
    ds_read_b64_tr_b16 a[54:55], v22 offset:13312
    buffer_load_dwordx4 v[224:227], v2, s[4:7], s88 offen offset:0 sc1
    ds_read_b64_tr_b16 a[56:57], v21 offset:14336
    ds_read_b64_tr_b16 a[58:59], v21 offset:15360
    ds_read_b64_tr_b16 a[60:61], v22 offset:14336
    ds_read_b64_tr_b16 a[62:63], v22 offset:15360
    ds_read_b64_tr_b16 a[64:65], v21 offset:16384
    ds_read_b64_tr_b16 a[66:67], v21 offset:17408
    ds_read_b64_tr_b16 a[68:69], v22 offset:16384
    ds_read_b64_tr_b16 a[70:71], v22 offset:17408
    ds_read_b64_tr_b16 a[72:73], v21 offset:18432
    ds_read_b64_tr_b16 a[74:75], v21 offset:19456
    ds_read_b64_tr_b16 a[76:77], v22 offset:18432
    ds_read_b64_tr_b16 a[78:79], v22 offset:19456
    ds_read_b64_tr_b16 a[80:81], v21 offset:20480
    ds_read_b64_tr_b16 a[82:83], v21 offset:21504
    buffer_load_dwordx4 v[228:231], v2, s[4:7], s88 offen offset:1024 sc1
    ds_read_b64_tr_b16 a[84:85], v22 offset:20480
    ds_read_b64_tr_b16 a[86:87], v22 offset:21504
    ds_read_b64_tr_b16 a[88:89], v21 offset:22528
    ds_read_b64_tr_b16 a[90:91], v21 offset:23552
    ds_read_b64_tr_b16 a[92:93], v22 offset:22528
    ds_read_b64_tr_b16 a[94:95], v22 offset:23552
    ds_read_b64_tr_b16 a[96:97], v21 offset:24576
    ds_read_b64_tr_b16 a[98:99], v21 offset:25600
    ds_read_b64_tr_b16 a[100:101], v22 offset:24576
    ds_read_b64_tr_b16 a[102:103], v22 offset:25600
    ds_read_b64_tr_b16 a[104:105], v21 offset:26624
    ds_read_b64_tr_b16 a[106:107], v21 offset:27648
    ds_read_b64_tr_b16 a[108:109], v22 offset:26624
    ds_read_b64_tr_b16 a[110:111], v22 offset:27648
    s_waitcnt vmcnt(5)
    v_cmp_eq_u32 vcc, 0, v19
    s_cbranch_vccnz L_slow_26
L_ok_28:
    s_waitcnt lgkmcnt(0)
    s_barrier
    v_add_u32 v112, s77, v2
    s_lshl_b32 s66, s3, 10
    s_mov_b32 m0, s66
    s_nop 0
    buffer_load_dwordx4 v112, s[4:7], m0 offen sc1 lds
    s_add_u32 m0, m0, 4096
    s_nop 0
    buffer_load_dwordx4 v112, s[4:7], m0 offen sc1 lds
    s_add_u32 m0, m0, 4096
    v_lshrrev_b32_e64 v120, 4, v1
    v_bfe_u32 v121, v1, 2, 2
    v_and_b32 v122, 3, v1
    v_lshrrev_b32 v116, 5, v1
    v_bfe_u32 v117, v1, 4, 1
    v_bfe_u32 v118, v1, 3, 1
    v_lshlrev_b32_e64 v119, 7, v121
    v_lshl_add_u32 v119, v118, 6, v119
    v_lshl_add_u32 v20, v116, 10, v119
    v_lshl_add_u32 v20, v122, 4, v20
    v_lshl_add_u32 v20, v117, 3, v20
    buffer_load_dwordx4 v112, s[4:7], m0 offen sc1 lds
    s_add_u32 m0, m0, 4096
    v_xor_b32 v21, 64, v20
    s_lshl_b32 s68, s61, 6
    v_xor_b32 v119, s68, v119
    s_lshl_b32 s68, s93, 5
    s_lshl3_add_u32 s68, s94, s68
    v_and_b32 v116, 16, v2
    v_add3_u32 v119, v119, v116, s68
    v_bfe_u32 v116, v1, 1, 1
    v_mul_u32_u24 v22, 57376, v116
    v_lshl_add_u32 v22, v120, 10, v22
    v_add_u32_e64 v22, v22, v119
    buffer_load_dwordx4 v112, s[4:7], m0 offen sc1 lds
    s_add_u32 m0, m0, 4096
    v_lshl_add_u32 v116, v120, 1, v116
    v_lshl_add_u32 v23, v116, 10, v119
    s_lshl_b32 s68, s62, 13
    v_add_u32 v23, s68, v23
    s_mul_i32 s68, s3, 9216
    v_add_u32 v24, s68, v2
    v_lshrrev_b32 v116, 3, v1
    v_and_b32 v117, 0x70, v2
    v_mul_u32_u24 v25, 1152, v116
    s_lshl_b32 s68, s3, 7
    v_add3_u32 v25, v25, v117, s68
    buffer_load_dwordx4 v112, s[4:7], m0 offen sc1 lds
    s_add_u32 m0, m0, 4096
    s_and_b32 s68, s59, 8
    s_bfe_u32 s69, s59, 0x20001
    s_add_u32 s68, s68, s69
    s_lshl2_add_u32 s68, s94, s68
    s_lshl1_add_u32 s69, s61, s93
    s_and_b32 s70, s59, 1
    v_lshlrev_b32_e64 v118, 4, v122
    v_bfe_u32 v119, v1, 2, 1
    s_lshl2_add_u32 s68, s68, s69
    s_lshl1_add_u32 s68, s68, s70
    s_lshl_b32 s68, s68, 6
    buffer_load_dwordx4 v112, s[4:7], m0 offen sc1 lds
    s_add_u32 m0, m0, 4096
    v_lshl_add_u32 v27, v119, 2, v118
    v_lshrrev_b32 v119, 5, v1
    v_lshl_add_u32 v27, v119, 3, v27
    v_add_u32 v27, s68, v27
    v_lshrrev_b32 v119, 2, v1
    v_lshl_add_u32 v26, v119, 14, v118
    s_lshl_b32 s71, s62, 18
    s_add_u32 s68, s68, s71
    v_add_u32 v26, s68, v26
    v_min_u32 v116, 13, v1
    s_mul_i32 s68, s3, 14
    buffer_load_dwordx4 v112, s[4:7], m0 offen sc1 lds
    s_add_u32 m0, m0, 4096
    v_add_lshl_u32 v28, v116, s68, 5
    s_lshl2_add_u32 s69, s60, s3
    s_lshl_b32 s68, s69, 5
    v_mov_b32 v29, s68
    s_mul_i32 s68, s59, 458752
    s_add_u32 s68, s68, 0x760000
    s_lshl_b32 s69, s69, 11
    s_add_u32 s79, s68, s69
    s_lshl2_add_u32 s69, s61, s3
    s_mul_i32 s69, s69, 28672
    s_add_u32 s78, s68, s69
    s_waitcnt vmcnt(11)
    s_barrier
    s_mov_b32 s66, 0x10000
    s_mov_b64 exec, 3
    buffer_store_dword v17, v15, s[4:7], s66 offen sc1
    s_mov_b64 exec, -1
    buffer_load_dwordx4 v112, s[4:7], m0 offen sc1 lds
    s_add_u32 m0, m0, 4096
    s_lshl_b32 s80, s59, 11
    s_nop 0
    s_add_u32 s80, s80, 0x38000
    s_add_u32 s98, s80, 32768
    buffer_load_dword v31, v28, s[4:7], s98 offen offset:0 sc1
    buffer_load_dwordx4 v112, s[4:7], m0 offen sc1 lds
    s_add_u32 m0, m0, 4096
    v_mov_b32_e64 v129, s99
    buffer_load_dword v128, v129, s[4:7], 0 offen offset:0 sc1
    s_mov_b64 exec, 0
    s_cmp_eq_u32 s3, 0
    s_cbranch_scc1 L_pg4
    s_cmp_eq_u32 s3, 1
    s_cbranch_scc1 L_pg5
    s_cmp_eq_u32 s3, 2
    s_cbranch_scc1 L_st0
    s_cmp_eq_u32 s3, 3
    s_cbranch_scc1 L_st1
L_ret1:
    s_mov_b64 exec, -1
    s_waitcnt vmcnt(10)
    s_barrier
    ds_read_b64_tr_b16 a[224:225], v20 offset:0
    ds_read_b64_tr_b16 a[226:227], v20 offset:512
    ds_read_b64_tr_b16 a[228:229], v21 offset:0
    ds_read_b64_tr_b16 a[230:231], v21 offset:512
    ds_read_b64_tr_b16 a[232:233], v20 offset:2048
    ds_read_b64_tr_b16 a[234:235], v20 offset:2560
    ds_read_b64_tr_b16 a[236:237], v21 offset:2048
    ds_read_b64_tr_b16 a[238:239], v21 offset:2560
    ds_read_b64_tr_b16 a[240:241], v20 offset:4096
    ds_read_b64_tr_b16 a[242:243], v20 offset:4608
    ds_read_b64_tr_b16 a[244:245], v21 offset:4096
    ds_read_b64_tr_b16 a[246:247], v21 offset:4608
    ds_read_b64_tr_b16 a[248:249], v20 offset:6144
    ds_read_b64_tr_b16 a[250:251], v20 offset:6656
    s_waitcnt lgkmcnt(12)
    v_mfma_f32_32x32x16_bf16 v[32:47], v[144:147], a[224:227], 0
    buffer_load_dwordx4 v112, s[4:7], m0 offen sc1 lds
    s_add_u32 m0, m0, 4096
    v_add_u32 v113, 57376, v20
    v_add_u32 v114, 57376, v21
    s_waitcnt lgkmcnt(8)
    v_mfma_f32_32x32x16_bf16 v[48:63], v[144:147], a[228:231], 0
    buffer_load_dwordx4 v[232:235], v2, s[4:7], s88 offen offset:2048 sc1
    ds_read_b64_tr_b16 a[252:253], v21 offset:6144
    ds_read_b64_tr_b16 a[254:255], v21 offset:6656
    s_waitcnt vmcnt(9)
    s_barrier
    ds_read_b64_tr_b16 a[224:225], v20 offset:8192
    ds_read_b64_tr_b16 a[226:227], v20 offset:8704
    v_mfma_f32_32x32x16_bf16 v[32:47], v[148:151], a[232:235], v[32:47]
    ds_read_b64_tr_b16 a[228:229], v21 offset:8192
    ds_read_b64_tr_b16 a[230:231], v21 offset:8704
    s_waitcnt lgkmcnt(10)
    v_mfma_f32_32x32x16_bf16 v[48:63], v[148:151], a[236:239], v[48:63]
    buffer_load_dwordx4 v112, s[4:7], m0 offen sc1 lds
    s_add_u32 m0, m0, 4096
    ds_read_b64_tr_b16 a[232:233], v20 offset:10240
    ds_read_b64_tr_b16 a[234:235], v20 offset:10752
    v_mfma_f32_32x32x16_bf16 v[32:47], v[152:155], a[240:243], v[32:47]
    buffer_load_dwordx4 v[236:239], v2, s[4:7], s88 offen offset:3072 sc1
    s_add_u32 s88, s88, 4096
    ds_read_b64_tr_b16 a[236:237], v21 offset:10240
    ds_read_b64_tr_b16 a[238:239], v21 offset:10752
    s_waitcnt lgkmcnt(10)
    v_mfma_f32_32x32x16_bf16 v[48:63], v[152:155], a[244:247], v[48:63]
    ds_read_b64_tr_b16 a[240:241], v20 offset:12288
    ds_read_b64_tr_b16 a[242:243], v20 offset:12800
    v_mfma_f32_32x32x16_bf16 v[32:47], v[156:159], a[248:251], v[32:47]
    buffer_load_dwordx4 v112, s[4:7], m0 offen sc1 lds
    s_add_u32 m0, m0, 4096
    ds_read_b64_tr_b16 a[244:245], v21 offset:12288
    ds_read_b64_tr_b16 a[246:247], v21 offset:12800
    s_waitcnt lgkmcnt(10)
    v_mfma_f32_32x32x16_bf16 v[48:63], v[156:159], a[252:255], v[48:63]
    buffer_load_dwordx4 v[240:243], v2, s[4:7], s88 offen offset:0 sc1
    ds_read_b64_tr_b16 a[248:249], v20 offset:14336
    ds_read_b64_tr_b16 a[250:251], v20 offset:14848
    v_mfma_f32_32x32x16_bf16 v[32:47], v[160:163], a[224:227], v[32:47]
    ds_read_b64_tr_b16 a[252:253], v21 offset:14336
    ds_read_b64_tr_b16 a[254:255], v21 offset:14848
    s_waitcnt lgkmcnt(10)
    v_mfma_f32_32x32x16_bf16 v[48:63], v[160:163], a[228:231], v[48:63]
    buffer_load_dwordx4 v112, s[4:7], m0 offen sc1 lds
    s_add_u32 m0, m0, 4096
    ds_read_b64_tr_b16 a[224:225], v20 offset:16384
    ds_read_b64_tr_b16 a[226:227], v20 offset:16896
    v_mfma_f32_32x32x16_bf16 v[32:47], v[164:167], a[232:235], v[32:47]
    buffer_load_dwordx4 v[244:247], v2, s[4:7], s88 offen offset:1024 sc1
    ds_read_b64_tr_b16 a[228:229], v21 offset:16384
    ds_read_b64_tr_b16 a[230:231], v21 offset:16896
    s_waitcnt lgkmcnt(10)
    v_mfma_f32_32x32x16_bf16 v[48:63], v[164:167], a[236:239], v[48:63]
    ds_read_b64_tr_b16 a[232:233], v20 offset:18432
    ds_read_b64_tr_b16 a[234:235], v20 offset:18944
    v_mfma_f32_32x32x16_bf16 v[32:47], v[168:171], a[240:243], v[32:47]
    buffer_load_dwordx4 v112, s[4:7], m0 offen sc1 lds
    v_subrev_u32 v112, 32, v112
    s_add_u32 m0, m0, 4128
    ds_read_b64_tr_b16 a[236:237], v21 offset:18432
    ds_read_b64_tr_b16 a[238:239], v21 offset:18944
    s_waitcnt lgkmcnt(10)
    v_mfma_f32_32x32x16_bf16 v[48:63], v[168:171], a[244:247], v[48:63]
    buffer_load_dwordx4 v[248:251], v2, s[4:7], s88 offen offset:2048 sc1
    s_waitcnt vmcnt(11)
    s_barrier
    ds_read_b64_tr_b16 a[240:241], v20 offset:20480
    ds_read_b64_tr_b16 a[242:243], v20 offset:20992
    v_mfma_f32_32x32x16_bf16 v[32:47], v[172:175], a[248:251], v[32:47]
    ds_read_b64_tr_b16 a[244:245], v21 offset:20480
    ds_read_b64_tr_b16 a[246:247], v21 offset:20992
    s_waitcnt lgkmcnt(10)
    v_mfma_f32_32x32x16_bf16 v[48:63], v[172:175], a[252:255], v[48:63]
    buffer_load_dwordx4 v[252:255], v2, s[4:7], s88 offen offset:3072 sc1
    s_add_u32 s88, s88, 4096
    ds_read_b64_tr_b16 a[248:249], v20 offset:22528
    ds_read_b64_tr_b16 a[250:251], v20 offset:23040
    v_mfma_f32_32x32x16_bf16 v[32:47], v[176:179], a[224:227], v[32:47]
    ds_read_b64_tr_b16 a[252:253], v21 offset:22528
    ds_read_b64_tr_b16 a[254:255], v21 offset:23040
    s_waitcnt lgkmcnt(10)
    v_mfma_f32_32x32x16_bf16 v[48:63], v[176:179], a[228:231], v[48:63]
    s_waitcnt vmcnt(11)
    v_cmp_eq_u32 vcc, 0, v128
    s_cbranch_vccnz L_slow_29
L_ok_31:
    buffer_load_dwordx4 a[112:115], v2, s[4:7], s96 offen offset:0 sc1
    ds_read_b64_tr_b16 a[224:225], v20 offset:24576
    ds_read_b64_tr_b16 a[226:227], v20 offset:25088
    v_mfma_f32_32x32x16_bf16 v[32:47], v[180:183], a[232:235], v[32:47]
    s_add_u32 s97, s74, 0x10000
    buffer_load_dword v19, v16, s[4:7], s97 offen offset:0 sc1
    ds_read_b64_tr_b16 a[228:229], v21 offset:24576
    ds_read_b64_tr_b16 a[230:231], v21 offset:25088
    s_waitcnt lgkmcnt(10)
    v_mfma_f32_32x32x16_bf16 v[48:63], v[180:183], a[236:239], v[48:63]
    buffer_load_dwordx4 a[116:119], v2, s[4:7], s96 offen offset:1024 sc1
    ds_read_b64_tr_b16 a[232:233], v20 offset:26624
    ds_read_b64_tr_b16 a[234:235], v20 offset:27136
    v_mfma_f32_32x32x16_bf16 v[32:47], v[184:187], a[240:243], v[32:47]
    ds_read_b64_tr_b16 a[236:237], v21 offset:26624
    ds_read_b64_tr_b16 a[238:239], v21 offset:27136
    s_waitcnt lgkmcnt(10)
    v_mfma_f32_32x32x16_bf16 v[48:63], v[184:187], a[244:247], v[48:63]
    buffer_load_dwordx4 a[120:123], v2, s[4:7], s96 offen offset:2048 sc1
    ds_read_b64_tr_b16 a[240:241], v20 offset:28672
    ds_read_b64_tr_b16 a[242:243], v20 offset:29184
    v_mfma_f32_32x32x16_bf16 v[32:47], v[188:191], a[248:251], v[32:47]
    ds_read_b64_tr_b16 a[244:245], v21 offset:28672
    ds_read_b64_tr_b16 a[246:247], v21 offset:29184
    s_waitcnt lgkmcnt(10)
    v_mfma_f32_32x32x16_bf16 v[48:63], v[188:191], a[252:255], v[48:63]
    buffer_load_dwordx4 a[124:127], v2, s[4:7], s96 offen offset:3072 sc1
    s_add_u32 s96, s96, 4096
    ds_read_b64_tr_b16 a[248:249], v20 offset:30720
    ds_read_b64_tr_b16 a[250:251], v20 offset:31232
    v_mfma_f32_32x32x16_bf16 v[32:47], v[192:195], a[224:227], v[32:47]
    ds_read_b64_tr_b16 a[252:253], v21 offset:30720
    ds_read_b64_tr_b16 a[254:255], v21 offset:31232
    s_waitcnt lgkmcnt(10)
    v_mfma_f32_32x32x16_bf16 v[48:63], v[192:195], a[228:231], v[48:63]
    buffer_load_dwordx4 a[128:131], v2, s[4:7], s96 offen offset:0 sc1
    ds_read_b64_tr_b16 a[224:225], v20 offset:32768
    ds_read_b64_tr_b16 a[226:227], v20 offset:33280
    v_mfma_f32_32x32x16_bf16 v[32:47], v[196:199], a[232:235], v[32:47]
    ds_read_b64_tr_b16 a[228:229], v21 offset:32768
    ds_read_b64_tr_b16 a[230:231], v21 offset:33280
    s_waitcnt lgkmcnt(10)
    v_mfma_f32_32x32x16_bf16 v[48:63], v[196:199], a[236:239], v[48:63]
    buffer_load_dwordx4 a[132:135], v2, s[4:7], s96 offen offset:1024 sc1
    ds_read_b64_tr_b16 a[232:233], v20 offset:34816
    ds_read_b64_tr_b16 a[234:235], v20 offset:35328
    v_mfma_f32_32x32x16_bf16 v[32:47], v[200:203], a[240:243], v[32:47]
    ds_read_b64_tr_b16 a[236:237], v21 offset:34816
    ds_read_b64_tr_b16 a[238:239], v21 offset:35328
    s_waitcnt lgkmcnt(10)
    v_mfma_f32_32x32x16_bf16 v[48:63], v[200:203], a[244:247], v[48:63]
    buffer_load_dwordx4 a[136:139], v2, s[4:7], s96 offen offset:2048 sc1
    s_waitcnt vmcnt(10)
    s_barrier
    ds_read_b64_tr_b16 a[240:241], v20 offset:36864
    ds_read_b64_tr_b16 a[242:243], v20 offset:37376
    v_mfma_f32_32x32x16_bf16 v[32:47], v[204:207], a[248:251], v[32:47]
    ds_read_b64_tr_b16 a[244:245], v20 offset:38912
    ds_read_b64_tr_b16 a[246:247], v20 offset:39424
    s_waitcnt lgkmcnt(10)
    v_mfma_f32_32x32x16_bf16 v[48:63], v[204:207], a[252:255], v[48:63]
    buffer_load_dwordx4 a[140:143], v2, s[4:7], s96 offen offset:3072 sc1
    s_add_u32 s96, s96, 4096
    ds_read_b64_tr_b16 a[248:249], v20 offset:40960
    ds_read_b64_tr_b16 a[250:251], v20 offset:41472
    v_mfma_f32_32x32x16_bf16 v[32:47], v[208:211], a[224:227], v[32:47]
    ds_read_b64_tr_b16 a[252:253], v20 offset:43008
    ds_read_b64_tr_b16 a[254:255], v20 offset:43520
    s_waitcnt lgkmcnt(10)
    v_mfma_f32_32x32x16_bf16 v[48:63], v[208:211], a[228:231], v[48:63]
    buffer_load_dwordx4 a[144:147], v2, s[4:7], s96 offen offset:0 sc1
    ds_read_b64_tr_b16 a[224:225], v20 offset:45056
    ds_read_b64_tr_b16 a[226:227], v20 offset:45568
    v_mfma_f32_32x32x16_bf16 v[32:47], v[212:215], a[232:235], v[32:47]
    ds_read_b64_tr_b16 a[228:229], v20 offset:47104
    ds_read_b64_tr_b16 a[230:231], v20 offset:47616
    s_waitcnt lgkmcnt(10)
    v_mfma_f32_32x32x16_bf16 v[48:63], v[212:215], a[236:239], v[48:63]
    s_waitcnt vmcnt(8)
    v_cmp_eq_u32_e64 vcc, 0, v19
    ds_read_b64_tr_b16 a[232:233], v20 offset:49152
    ds_read_b64_tr_b16 a[234:235], v20 offset:49664
    v_mfma_f32_32x32x16_bf16 v[32:47], v[216:219], a[240:243], v[32:47]
    s_cbranch_vccnz L_slow_32
L_ok_34:
    s_barrier
    s_waitcnt lgkmcnt(8)
    v_mfma_f32_32x32x16_bf16 v[32:47], v[220:223], a[244:247], v[32:47]
    buffer_load_dwordx4 v112, s[4:7], m0 offen sc1 lds
    s_add_u32 m0, m0, 4096
    ds_read_b64_tr_b16 a[236:237], v20 offset:51200
    ds_read_b64_tr_b16 a[238:239], v20 offset:51712
    v_mfma_f32_32x32x16_bf16 v[32:47], v[224:227], a[248:251], v[32:47]
    buffer_load_dwordx4 v112, s[4:7], m0 offen sc1 lds
    s_add_u32 m0, m0, 4096
    ds_read_b64_tr_b16 a[240:241], v20 offset:53248
    ds_read_b64_tr_b16 a[242:243], v20 offset:53760
    s_waitcnt lgkmcnt(8)
    v_mfma_f32_32x32x16_bf16 v[32:47], v[228:231], a[252:255], v[32:47]
    buffer_load_dwordx4 v112, s[4:7], m0 offen sc1 lds
    s_add_u32 m0, m0, 4096
    ds_read_b64_tr_b16 a[244:245], v20 offset:55296
    ds_read_b64_tr_b16 a[246:247], v20 offset:55808
    v_mfma_f32_32x32x16_bf16 v[32:47], v[232:235], a[224:227], v[32:47]
    buffer_load_dwordx4 v112, s[4:7], m0 offen sc1 lds
    s_add_u32 m0, m0, 4096
    ds_read_b64_tr_b16 a[248:249], v21 offset:36864
    ds_read_b64_tr_b16 a[250:251], v21 offset:37376
    s_waitcnt lgkmcnt(8)
    v_mfma_f32_32x32x16_bf16 v[32:47], v[236:239], a[228:231], v[32:47]
    ds_read_b64_tr_b16 a[252:253], v21 offset:38912
    ds_read_b64_tr_b16 a[254:255], v21 offset:39424
    ds_read_b64_tr_b16 a[224:225], v21 offset:40960
    ds_read_b64_tr_b16 a[226:227], v21 offset:41472
    v_mfma_f32_32x32x16_bf16 v[32:47], v[240:243], a[232:235], v[32:47]
    buffer_load_dwordx4 v112, s[4:7], m0 offen sc1 lds
    s_add_u32 m0, m0, 4096
    ds_read_b64_tr_b16 a[228:229], v21 offset:43008
    ds_read_b64_tr_b16 a[230:231], v21 offset:43520
    s_waitcnt lgkmcnt(10)
    v_mfma_f32_32x32x16_bf16 v[32:47], v[244:247], a[236:239], v[32:47]
    ds_read_b64_tr_b16 a[232:233], v21 offset:45056
    ds_read_b64_tr_b16 a[234:235], v21 offset:45568
    v_mfma_f32_32x32x16_bf16 v[32:47], v[248:251], a[240:243], v[32:47]
    buffer_load_dwordx4 v112, s[4:7], m0 offen sc1 lds
    s_add_u32 m0, m0, 4096
    ds_read_b64_tr_b16 a[236:237], v21 offset:47104
    ds_read_b64_tr_b16 a[238:239], v21 offset:47616
    s_waitcnt lgkmcnt(10)
    v_mfma_f32_32x32x16_bf16 v[32:47], v[252:255], a[244:247], v[32:47]
    ds_read_b64_tr_b16 a[240:241], v21 offset:49152
    ds_read_b64_tr_b16 a[242:243], v21 offset:49664
    v_mfma_f32_32x32x16_bf16 v[48:63], v[216:219], a[248:251], v[48:63]
    buffer_load_dwordx4 v112, s[4:7], m0 offen sc1 lds
    s_add_u32 m0, m0, 4096
    ds_read_b64_tr_b16 a[244:245], v21 offset:51200
    ds_read_b64_tr_b16 a[246:247], v21 offset:51712
    s_waitcnt lgkmcnt(10)
    v_mfma_f32_32x32x16_bf16 v[48:63], v[220:223], a[252:255], v[48:63]
    ds_read_b64_tr_b16 a[248:249], v21 offset:53248
    ds_read_b64_tr_b16 a[250:251], v21 offset:53760
    v_mfma_f32_32x32x16_bf16 v[48:63], v[224:227], a[224:227], v[48:63]
    buffer_load_dwordx4 v112, s[4:7], m0 offen sc1 lds
    s_add_u32 m0, m0, 4096
    v_cvt_pk_bf16_f32 v96, v32, v33
    v_cvt_pk_bf16_f32 v97, v34, v35
    s_waitcnt lgkmcnt(8)
    v_mfma_f32_32x32x16_bf16 v[48:63], v[228:231], a[228:231], v[48:63]
    ds_read_b64_tr_b16 a[252:253], v21 offset:55296
    ds_read_b64_tr_b16 a[254:255], v21 offset:55808
    v_cvt_pk_bf16_f32 v98, v36, v37
    v_cvt_pk_bf16_f32 v99, v38, v39
    v_pk_max_i16 v96, v96, 0
    v_pk_max_i16 v97, v97, 0
    v_pk_max_i16 v98, v98, 0
    v_mfma_f32_32x32x16_bf16 v[48:63], v[232:235], a[232:235], v[48:63]
    buffer_load_dwordx4 v112, s[4:7], m0 offen sc1 lds
    s_add_u32 m0, m0, 4096
    v_pk_max_i16 v99, v99, 0
    s_add_u32 s67, s79, 0
    s_waitcnt lgkmcnt(6)
    v_mfma_f32_32x32x16_bf16 v[48:63], v[236:239], a[236:239], v[48:63]
    buffer_store_dwordx4 v[96:99], v2, s[4:7], s67 offen offset:0 sc1
    v_cvt_pk_bf16_f32 v100, v40, v41
    v_mfma_f32_32x32x16_bf16 v[48:63], v[240:243], a[240:243], v[48:63]
    s_waitcnt vmcnt(8)
    s_barrier
    ds_read_b64_tr_b16 a[224:225], v113 offset:0
    ds_read_b64_tr_b16 a[226:227], v113 offset:512
    v_cvt_pk_bf16_f32 v101, v42, v43
    s_waitcnt lgkmcnt(4)
    v_mfma_f32_32x32x16_bf16 v[48:63], v[244:247], a[244:247], v[48:63]
    ds_read_b64_tr_b16 a[228:229], v114 offset:0
    ds_read_b64_tr_b16 a[230:231], v114 offset:512
    buffer_load_dwordx4 v112, s[4:7], m0 offen sc1 lds
    s_add_u32 m0, m0, 4096
    v_cvt_pk_bf16_f32 v102, v44, v45
    v_mfma_f32_32x32x16_bf16 v[48:63], v[248:251], a[248:251], v[48:63]
    ds_read_b64_tr_b16 a[232:233], v113 offset:2048
    ds_read_b64_tr_b16 a[234:235], v113 offset:2560
    buffer_load_dwordx4 v112, s[4:7], m0 offen sc1 lds
    s_add_u32 m0, m0, 4096
    s_waitcnt lgkmcnt(6)
    v_mfma_f32_32x32x16_bf16 v[48:63], v[252:255], a[252:255], v[48:63]
    ds_read_b64_tr_b16 a[236:237], v114 offset:2048
    ds_read_b64_tr_b16 a[238:239], v114 offset:2560
    ds_read_b64_tr_b16 a[240:241], v113 offset:4096
    ds_read_b64_tr_b16 a[242:243], v113 offset:4608
    ds_read_b64_tr_b16 a[244:245], v114 offset:4096
    ds_read_b64_tr_b16 a[246:247], v114 offset:4608
    s_waitcnt lgkmcnt(10)
    v_mfma_f32_32x32x16_bf16 v[64:79], v[144:147], a[224:227], 0
    buffer_load_dwordx4 v112, s[4:7], m0 offen sc1 lds
    s_add_u32 m0, m0, 4096
    ds_read_b64_tr_b16 a[248:249], v113 offset:6144
    ds_read_b64_tr_b16 a[250:251], v113 offset:6656
    s_waitcnt lgkmcnt(10)
    v_mfma_f32_32x32x16_bf16 v[80:95], v[144:147], a[228:231], 0
    ds_read_b64_tr_b16 a[252:253], v114 offset:6144
    ds_read_b64_tr_b16 a[254:255], v114 offset:6656
    v_cvt_pk_bf16_f32 v103, v46, v47
    v_pk_max_i16 v100, v100, 0
    v_pk_max_i16 v101, v101, 0
    v_pk_max_i16 v102, v102, 0
    s_waitcnt lgkmcnt(10)
    v_mfma_f32_32x32x16_bf16 v[64:79], v[148:151], a[232:235], v[64:79]
    buffer_load_dwordx4 v112, s[4:7], m0 offen sc1 lds
    s_add_u32 m0, m0, 4096
    s_waitcnt vmcnt(9)
    s_barrier
    ds_read_b64_tr_b16 a[224:225], v113 offset:8192
L_pg3:
    s_cbranch_execz L_ret0
    s_nop 0
    ds_read_b64_tr_b16 a[226:227], v113 offset:8704
    s_waitcnt lgkmcnt(8)
    v_mfma_f32_32x32x16_bf16 v[80:95], v[148:151], a[236:239], v[80:95]
    ds_read_b64_tr_b16 a[228:229], v114 offset:8192
    ds_read_b64_tr_b16 a[230:231], v114 offset:8704
    v_pk_max_i16 v103, v103, 0
    ds_read_b64_tr_b16 a[232:233], v113 offset:10240
    ds_read_b64_tr_b16 a[234:235], v113 offset:10752
    v_mfma_f32_32x32x16_bf16 v[64:79], v[152:155], a[240:243], v[64:79]
    buffer_store_dwordx4 v[100:103], v2, s[4:7], s67 offen offset:1024 sc1
    s_waitcnt lgkmcnt(8)
    v_mfma_f32_32x32x16_bf16 v[80:95], v[152:155], a[244:247], v[80:95]
    buffer_load_dwordx4 v112, s[4:7], m0 offen sc1 lds
    ds_read_b64_tr_b16 a[236:237], v114 offset:10240
    ds_read_b64_tr_b16 a[238:239], v114 offset:10752
    v_cvt_pk_bf16_f32 v104, v48, v49
    v_mfma_f32_32x32x16_bf16 v[64:79], v[156:159], a[248:251], v[64:79]
    buffer_load_dwordx4 a[148:151], v2, s[4:7], s96 offen offset:1024 sc1
    ds_read_b64_tr_b16 a[240:241], v113 offset:12288
    ds_read_b64_tr_b16 a[242:243], v113 offset:12800
    v_cvt_pk_bf16_f32 v105, v50, v51
    s_waitcnt lgkmcnt(8)
    v_mfma_f32_32x32x16_bf16 v[80:95], v[156:159], a[252:255], v[80:95]
    ds_read_b64_tr_b16 a[244:245], v114 offset:12288
    ds_read_b64_tr_b16 a[246:247], v114 offset:12800
    v_cvt_pk_bf16_f32 v106, v52, v53
    v_cvt_pk_bf16_f32 v107, v54, v55
    v_pk_max_i16 v104, v104, 0
    v_pk_max_i16 v105, v105, 0
    v_pk_max_i16 v106, v106, 0
    v_mfma_f32_32x32x16_bf16 v[64:79], v[160:163], a[224:227], v[64:79]
    buffer_load_dwordx4 a[152:155], v2, s[4:7], s96 offen offset:2048 sc1
    ds_read_b64_tr_b16 a[248:249], v113 offset:14336
    ds_read_b64_tr_b16 a[250:251], v113 offset:14848
    v_pk_max_i16 v107, v107, 0
    s_waitcnt lgkmcnt(8)
    v_mfma_f32_32x32x16_bf16 v[80:95], v[160:163], a[228:231], v[80:95]
    ds_read_b64_tr_b16 a[252:253], v114 offset:14336
    ds_read_b64_tr_b16 a[254:255], v114 offset:14848
    s_add_u32 s67, s79, 114688
    ds_read_b64_tr_b16 a[224:225], v113 offset:16384
    ds_read_b64_tr_b16 a[226:227], v113 offset:16896
    v_mfma_f32_32x32x16_bf16 v[64:79], v[164:167], a[232:235], v[64:79]
    buffer_store_dwordx4 v[104:107], v2, s[4:7], s67 offen offset:0 sc1
    s_waitcnt lgkmcnt(8)
    v_mfma_f32_32x32x16_bf16 v[80:95], v[164:167], a[236:239], v[80:95]
    buffer_load_dwordx4 a[156:159], v2, s[4:7], s96 offen offset:3072 sc1
    s_add_u32 s96, s96, 4096
    ds_read_b64_tr_b16 a[228:229], v114 offset:16384
    ds_read_b64_tr_b16 a[230:231], v114 offset:16896
    v_cvt_pk_bf16_f32 v108, v56, v57
    v_cvt_pk_bf16_f32 v109, v58, v59
    v_mfma_f32_32x32x16_bf16 v[64:79], v[168:171], a[240:243], v[64:79]
    ds_read_b64_tr_b16 a[232:233], v113 offset:18432
    ds_read_b64_tr_b16 a[234:235], v113 offset:18944
    v_cvt_pk_bf16_f32 v110, v60, v61
    v_cvt_pk_bf16_f32 v111, v62, v63
    v_pk_max_i16 v108, v108, 0
    v_pk_max_i16 v109, v109, 0
    s_waitcnt lgkmcnt(8)
    v_mfma_f32_32x32x16_bf16 v[80:95], v[168:171], a[244:247], v[80:95]
    buffer_load_dwordx4 a[160:163], v2, s[4:7], s96 offen offset:0 sc1
    ds_read_b64_tr_b16 a[236:237], v114 offset:18432
    ds_read_b64_tr_b16 a[238:239], v114 offset:18944
    v_pk_max_i16 v110, v110, 0
    v_pk_max_i16 v111, v111, 0
    v_mfma_f32_32x32x16_bf16 v[64:79], v[172:175], a[248:251], v[64:79]
    buffer_store_dwordx4 v[108:111], v2, s[4:7], s67 offen offset:1024 sc1
    s_waitcnt lgkmcnt(6)
    v_mfma_f32_32x32x16_bf16 v[80:95], v[172:175], a[252:255], v[80:95]
    buffer_load_dwordx4 a[164:167], v2, s[4:7], s96 offen offset:1024 sc1
    s_waitcnt vmcnt(14)
    s_barrier
    ds_read_b64_tr_b16 a[240:241], v113 offset:20480
    ds_read_b64_tr_b16 a[242:243], v113 offset:20992
    v_mfma_f32_32x32x16_bf16 v[64:79], v[176:179], a[224:227], v[64:79]
    ds_read_b64_tr_b16 a[244:245], v113 offset:22528
    ds_read_b64_tr_b16 a[246:247], v113 offset:23040
    ds_read_b64_tr_b16 a[248:249], v113 offset:24576
    ds_read_b64_tr_b16 a[250:251], v113 offset:25088
    ds_read_b64_tr_b16 a[252:253], v113 offset:26624
    ds_read_b64_tr_b16 a[254:255], v113 offset:27136
    s_waitcnt lgkmcnt(10)
    v_mfma_f32_32x32x16_bf16 v[80:95], v[176:179], a[228:231], v[80:95]
    buffer_load_dwordx4 a[168:171], v2, s[4:7], s96 offen offset:2048 sc1
    ds_read_b64_tr_b16 a[224:225], v113 offset:28672
    ds_read_b64_tr_b16 a[226:227], v113 offset:29184
    v_mfma_f32_32x32x16_bf16 v[64:79], v[180:183], a[232:235], v[64:79]
    ds_read_b64_tr_b16 a[228:229], v113 offset:30720
    ds_read_b64_tr_b16 a[230:231], v113 offset:31232
    s_waitcnt lgkmcnt(10)
    v_mfma_f32_32x32x16_bf16 v[80:95], v[180:183], a[236:239], v[80:95]
    buffer_load_dwordx4 a[172:175], v2, s[4:7], s96 offen offset:3072 sc1
    s_add_u32 s96, s96, 4096
    ds_read_b64_tr_b16 a[232:233], v113 offset:32768
    ds_read_b64_tr_b16 a[234:235], v113 offset:33280
    v_mfma_f32_32x32x16_bf16 v[64:79], v[184:187], a[240:243], v[64:79]
    ds_read_b64_tr_b16 a[236:237], v113 offset:34816
    ds_read_b64_tr_b16 a[238:239], v113 offset:35328
    s_waitcnt lgkmcnt(10)
    v_mfma_f32_32x32x16_bf16 v[64:79], v[188:191], a[244:247], v[64:79]
    buffer_load_dwordx4 a[176:179], v2, s[4:7], s96 offen offset:0 sc1
    s_waitcnt vmcnt(10)
    s_barrier
    ds_read_b64_tr_b16 a[240:241], v113 offset:36864
    ds_read_b64_tr_b16 a[242:243], v113 offset:37376
    v_mfma_f32_32x32x16_bf16 v[64:79], v[192:195], a[248:251], v[64:79]
    ds_read_b64_tr_b16 a[244:245], v113 offset:38912
    ds_read_b64_tr_b16 a[246:247], v113 offset:39424
    s_waitcnt lgkmcnt(10)
    v_mfma_f32_32x32x16_bf16 v[64:79], v[196:199], a[252:255], v[64:79]
    buffer_load_dwordx4 a[180:183], v2, s[4:7], s96 offen offset:1024 sc1
    ds_read_b64_tr_b16 a[248:249], v113 offset:40960
    ds_read_b64_tr_b16 a[250:251], v113 offset:41472
    v_mfma_f32_32x32x16_bf16 v[64:79], v[200:203], a[224:227], v[64:79]
    ds_read_b64_tr_b16 a[252:253], v113 offset:43008
    ds_read_b64_tr_b16 a[254:255], v113 offset:43520
    s_waitcnt lgkmcnt(10)
    v_mfma_f32_32x32x16_bf16 v[64:79], v[204:207], a[228:231], v[64:79]
    buffer_load_dwordx4 a[184:187], v2, s[4:7], s96 offen offset:2048 sc1
    ds_read_b64_tr_b16 a[224:225], v113 offset:45056
    ds_read_b64_tr_b16 a[226:227], v113 offset:45568
    v_mfma_f32_32x32x16_bf16 v[64:79], v[208:211], a[232:235], v[64:79]
    ds_read_b64_tr_b16 a[228:229], v113 offset:47104
    ds_read_b64_tr_b16 a[230:231], v113 offset:47616
    s_waitcnt lgkmcnt(10)
    v_mfma_f32_32x32x16_bf16 v[64:79], v[212:215], a[236:239], v[64:79]
    buffer_load_dwordx4 a[188:191], v2, s[4:7], s96 offen offset:3072 sc1
    s_add_u32 s96, s96, 4096
    ds_read_b64_tr_b16 a[232:233], v113 offset:49152
    ds_read_b64_tr_b16 a[234:235], v113 offset:49664
    v_mfma_f32_32x32x16_bf16 v[64:79], v[216:219], a[240:243], v[64:79]
    ds_read_b64_tr_b16 a[236:237], v113 offset:51200
    ds_read_b64_tr_b16 a[238:239], v113 offset:51712
    s_waitcnt lgkmcnt(10)
    v_mfma_f32_32x32x16_bf16 v[64:79], v[220:223], a[244:247], v[64:79]
    buffer_load_dwordx4 a[192:195], v2, s[4:7], s96 offen offset:0 sc1
    ds_read_b64_tr_b16 a[240:241], v113 offset:53248
    ds_read_b64_tr_b16 a[242:243], v113 offset:53760
    v_mfma_f32_32x32x16_bf16 v[64:79], v[224:227], a[248:251], v[64:79]
    ds_read_b64_tr_b16 a[244:245], v113 offset:55296
    ds_read_b64_tr_b16 a[246:247], v113 offset:55808
    s_waitcnt lgkmcnt(10)
    v_mfma_f32_32x32x16_bf16 v[64:79], v[228:231], a[252:255], v[64:79]
    buffer_load_dwordx4 a[196:199], v2, s[4:7], s96 offen offset:1024 sc1
    ds_read_b64_tr_b16 a[248:249], v114 offset:20480
    ds_read_b64_tr_b16 a[250:251], v114 offset:20992
    v_mfma_f32_32x32x16_bf16 v[64:79], v[232:235], a[224:227], v[64:79]
    ds_read_b64_tr_b16 a[252:253], v114 offset:22528
    ds_read_b64_tr_b16 a[254:255], v114 offset:23040
    s_waitcnt lgkmcnt(10)
    v_mfma_f32_32x32x16_bf16 v[64:79], v[236:239], a[228:231], v[64:79]
    buffer_load_dwordx4 a[200:203], v2, s[4:7], s96 offen offset:2048 sc1
    ds_read_b64_tr_b16 a[224:225], v114 offset:24576
    ds_read_b64_tr_b16 a[226:227], v114 offset:25088
    v_mfma_f32_32x32x16_bf16 v[64:79], v[240:243], a[232:235], v[64:79]
    ds_read_b64_tr_b16 a[228:229], v114 offset:26624
    ds_read_b64_tr_b16 a[230:231], v114 offset:27136
    s_waitcnt lgkmcnt(10)
    v_mfma_f32_32x32x16_bf16 v[64:79], v[244:247], a[236:239], v[64:79]
    s_waitcnt vmcnt(10)
    s_mov_b64 exec, 1
    buffer_store_dword v17, v29, s[4:7], s98 offen offset:0
    s_mov_b64 exec, -1
    v_mfma_f32_32x32x16_bf16 v[64:79], v[248:251], a[240:243], v[64:79]
    buffer_load_dwordx4 a[204:207], v2, s[4:7], s96 offen offset:3072 sc1
    s_add_u32 s96, s96, 4096
    ds_read_b64_tr_b16 a[232:233], v114 offset:28672
    ds_read_b64_tr_b16 a[234:235], v114 offset:29184
    s_waitcnt lgkmcnt(8)
    v_mfma_f32_32x32x16_bf16 v[64:79], v[252:255], a[244:247], v[64:79]
    ds_read_b64_tr_b16 a[236:237], v114 offset:30720
    ds_read_b64_tr_b16 a[238:239], v114 offset:31232
    ds_read_b64_tr_b16 a[240:241], v114 offset:32768
    ds_read_b64_tr_b16 a[242:243], v114 offset:33280
    v_mfma_f32_32x32x16_bf16 v[80:95], v[184:187], a[248:251], v[80:95]
    buffer_load_dwordx4 a[208:211], v2, s[4:7], s96 offen offset:0 sc1
    ds_read_b64_tr_b16 a[244:245], v114 offset:34816
    ds_read_b64_tr_b16 a[246:247], v114 offset:35328
    s_waitcnt lgkmcnt(10)
    v_mfma_f32_32x32x16_bf16 v[80:95], v[188:191], a[252:255], v[80:95]
    ds_read_b64_tr_b16 a[248:249], v114 offset:36864
    ds_read_b64_tr_b16 a[250:251], v114 offset:37376
    v_mfma_f32_32x32x16_bf16 v[80:95], v[192:195], a[224:227], v[80:95]
    buffer_load_dwordx4 a[212:215], v2, s[4:7], s96 offen offset:1024 sc1
    v_cvt_pk_bf16_f32 v96, v64, v65
    v_cvt_pk_bf16_f32 v97, v66, v67
    v_cvt_pk_bf16_f32 v98, v68, v69
    s_waitcnt lgkmcnt(8)
    v_mfma_f32_32x32x16_bf16 v[80:95], v[196:199], a[228:231], v[80:95]
    ds_read_b64_tr_b16 a[252:253], v114 offset:38912
    ds_read_b64_tr_b16 a[254:255], v114 offset:39424
    v_cvt_pk_bf16_f32 v99, v70, v71
    v_pk_max_i16 v96, v96, 0
    v_pk_max_i16 v97, v97, 0
    v_pk_max_i16 v98, v98, 0
    v_pk_max_i16 v99, v99, 0
    v_mfma_f32_32x32x16_bf16 v[80:95], v[200:203], a[232:235], v[80:95]
    buffer_load_dwordx4 a[216:219], v2, s[4:7], s96 offen offset:2048 sc1
    ds_read_b64_tr_b16 a[224:225], v114 offset:40960
    ds_read_b64_tr_b16 a[226:227], v114 offset:41472
    s_add_u32 s67, s79, 229376
    s_waitcnt lgkmcnt(8)
    v_mfma_f32_32x32x16_bf16 v[80:95], v[204:207], a[236:239], v[80:95]
    buffer_store_dwordx4 v[96:99], v2, s[4:7], s67 offen offset:0 sc1
    v_cvt_pk_bf16_f32 v100, v72, v73
    v_mfma_f32_32x32x16_bf16 v[80:95], v[208:211], a[240:243], v[80:95]
    buffer_load_dwordx4 a[220:223], v2, s[4:7], s96 offen offset:3072 sc1
    s_add_u32 s96, s96, 4096
    ds_read_b64_tr_b16 a[228:229], v114 offset:43008
    ds_read_b64_tr_b16 a[230:231], v114 offset:43520
    v_cvt_pk_bf16_f32 v101, v74, v75
    s_waitcnt lgkmcnt(6)
    v_mfma_f32_32x32x16_bf16 v[80:95], v[212:215], a[244:247], v[80:95]
    ds_read_b64_tr_b16 a[232:233], v114 offset:45056
    ds_read_b64_tr_b16 a[234:235], v114 offset:45568
    ds_read_b64_tr_b16 a[236:237], v114 offset:47104
    ds_read_b64_tr_b16 a[238:239], v114 offset:47616
    v_cvt_pk_bf16_f32 v102, v76, v77
    v_cvt_pk_bf16_f32 v103, v78, v79
    v_pk_max_i16 v100, v100, 0
    v_mfma_f32_32x32x16_bf16 v[80:95], v[216:219], a[248:251], v[80:95]
    ds_read_b64_tr_b16 a[240:241], v114 offset:49152
    ds_read_b64_tr_b16 a[242:243], v114 offset:49664
    v_pk_max_i16 v101, v101, 0
    v_pk_max_i16 v102, v102, 0
    v_pk_max_i16 v103, v103, 0
    s_waitcnt lgkmcnt(8)
    v_mfma_f32_32x32x16_bf16 v[80:95], v[220:223], a[252:255], v[80:95]
    buffer_store_dwordx4 v[100:103], v2, s[4:7], s67 offen offset:1024 sc1
    v_mfma_f32_32x32x16_bf16 v[80:95], v[224:227], a[224:227], v[80:95]
    ds_read_b64_tr_b16 a[244:245], v114 offset:51200
    ds_read_b64_tr_b16 a[246:247], v114 offset:51712
    ds_read_b64_tr_b16 a[248:249], v114 offset:53248
    ds_read_b64_tr_b16 a[250:251], v114 offset:53760
    ds_read_b64_tr_b16 a[252:253], v114 offset:55296
    ds_read_b64_tr_b16 a[254:255], v114 offset:55808
    s_waitcnt lgkmcnt(10)
    v_mfma_f32_32x32x16_bf16 v[80:95], v[228:231], a[228:231], v[80:95]
    ds_read_b64_tr_b16 v[32:33], v22 offset:0
    ds_read_b64_tr_b16 v[34:35], v22 offset:512
    ds_read_b64_tr_b16 v[36:37], v22 offset:4096
    ds_read_b64_tr_b16 v[38:39], v22 offset:4608
    ds_read_b64_tr_b16 v[40:41], v22 offset:8192
    ds_read_b64_tr_b16 v[42:43], v22 offset:8704
    ds_read_b64_tr_b16 v[44:45], v22 offset:12288
    v_mfma_f32_32x32x16_bf16 v[80:95], v[232:235], a[232:235], v[80:95]
    ds_read_b64_tr_b16 v[46:47], v22 offset:12800
    ds_read_b64_tr_b16 v[48:49], v22 offset:16384
    ds_read_b64_tr_b16 v[50:51], v22 offset:16896
    ds_read_b64_tr_b16 v[52:53], v22 offset:20480
    ds_read_b64_tr_b16 v[54:55], v22 offset:20992
    ds_read_b64_tr_b16 v[56:57], v22 offset:24576
    s_waitcnt lgkmcnt(14)
    v_mfma_f32_32x32x16_bf16 v[80:95], v[236:239], a[236:239], v[80:95]
    ds_read_b64_tr_b16 v[58:59], v22 offset:25088
    ds_read_b64_tr_b16 v[60:61], v22 offset:28672
    ds_read_b64_tr_b16 v[62:63], v22 offset:29184
    v_mfma_f32_32x32x16_bf16 v[80:95], v[240:243], a[240:243], v[80:95]
    v_mfma_f32_32x32x16_bf16 v[80:95], v[244:247], a[244:247], v[80:95]
    buffer_load_dword v31, v28, s[4:7], s98 offen offset:0 sc1
    v_mfma_f32_32x32x16_bf16 v[80:95], v[248:251], a[248:251], v[80:95]
    s_waitcnt lgkmcnt(14)
    v_mfma_f32_32x32x16_bf16 v[80:95], v[252:255], a[252:255], v[80:95]
    ds_read_b64_tr_b16 v[64:65], v22 offset:32768
    ds_read_b64_tr_b16 v[66:67], v22 offset:33280
    ds_read_b64_tr_b16 v[68:69], v22 offset:36864
    ds_read_b64_tr_b16 v[70:71], v22 offset:37376
    ds_read_b64_tr_b16 v[72:73], v22 offset:40960
    ds_read_b64_tr_b16 v[74:75], v22 offset:41472
    ds_read_b64_tr_b16 v[76:77], v22 offset:45056
    ds_read_b64_tr_b16 v[78:79], v22 offset:45568
    v_mov_b32 v116, s64
    v_mov_b32 v117, s64
    v_mov_b32 v118, s64
    v_mov_b32_e64 v119, s64
    v_cvt_pk_bf16_f32 v104, v80, v81
    v_cvt_pk_bf16_f32 v105, v82, v83
    v_cvt_pk_bf16_f32 v106, v84, v85
    v_cvt_pk_bf16_f32 v107, v86, v87
    v_pk_max_i16 v104, v104, 0
    v_pk_max_i16 v105, v105, 0
    v_pk_max_i16 v106, v106, 0
    v_pk_max_i16 v107, v107, 0
    s_add_u32 s67, s79, 344064
    buffer_store_dwordx4 v[104:107], v2, s[4:7], s67 offen offset:0 sc1
    v_cvt_pk_bf16_f32 v108, v88, v89
    v_cvt_pk_bf16_f32 v109, v90, v91
    v_cvt_pk_bf16_f32 v110, v92, v93
    v_cvt_pk_bf16_f32 v111, v94, v95
    v_pk_max_i16 v108, v108, 0
    v_pk_max_i16 v109, v109, 0
    v_pk_max_i16 v110, v110, 0
    v_pk_max_i16 v111, v111, 0
    buffer_store_dwordx4 v[108:111], v2, s[4:7], s67 offen offset:1024 sc1
    s_mov_b64 exec, 1
    buffer_store_dword v17, v29, s[4:7], s80 offen offset:0 sc1
    s_mov_b64 exec, -1
    ds_read_b64_tr_b16 v[80:81], v22 offset:49152
    ds_read_b64_tr_b16 v[82:83], v22 offset:49664
    ds_read_b64_tr_b16 v[84:85], v22 offset:53248
    ds_read_b64_tr_b16 v[86:87], v22 offset:53760
    ds_read_b64_tr_b16 v[132:133], v23 offset:0
    ds_read_b64_tr_b16 v[134:135], v23 offset:512
    ds_read_b64_tr_b16 v[136:137], v23 offset:57376
    ds_read_b64_tr_b16 v[138:139], v23 offset:57888
    s_waitcnt vmcnt(3)
    v_cmp_eq_u32 vcc, 0, v31
    s_cbranch_vccnz L_slow_35
L_ok_37:
    s_add_u32 s70, s78, 0
    buffer_load_dwordx4 a[224:227], v2, s[4:7], s70 offen offset:0 sc1
    v_mfma_f32_16x16x32_bf16 v[124:127], v[32:35], v[32:35], 0
    v_mfma_f32_16x16x32_bf16 v[120:123], v[116:119], v[32:35], 0
    s_waitcnt lgkmcnt(14)
    v_mfma_f32_16x16x32_bf16 v[124:127], v[36:39], v[36:39], v[124:127]
    buffer_load_dwordx4 a[228:231], v2, s[4:7], s70 offen offset:1024 sc1
    v_mfma_f32_16x16x32_bf16 v[120:123], v[116:119], v[36:39], v[120:123]
    v_mfma_f32_16x16x32_bf16 v[124:127], v[40:43], v[40:43], v[124:127]
    v_mfma_f32_16x16x32_bf16 v[120:123], v[116:119], v[40:43], v[120:123]
    buffer_load_dwordx4 a[232:235], v2, s[4:7], s70 offen offset:2048 sc1
    v_mfma_f32_16x16x32_bf16 v[124:127], v[44:47], v[44:47], v[124:127]
    v_mfma_f32_16x16x32_bf16 v[120:123], v[116:119], v[44:47], v[120:123]
    v_mfma_f32_16x16x32_bf16 v[124:127], v[48:51], v[48:51], v[124:127]
    buffer_load_dwordx4 a[236:239], v2, s[4:7], s70 offen offset:3072 sc1
    v_mfma_f32_16x16x32_bf16 v[120:123], v[116:119], v[48:51], v[120:123]
    v_mfma_f32_16x16x32_bf16 v[124:127], v[52:55], v[52:55], v[124:127]
    v_mfma_f32_16x16x32_bf16 v[120:123], v[116:119], v[52:55], v[120:123]
    s_add_u32 s70, s78, 4096
    buffer_load_dwordx4 a[240:243], v2, s[4:7], s70 offen offset:0 sc1
    v_mfma_f32_16x16x32_bf16 v[124:127], v[56:59], v[56:59], v[124:127]
    v_mfma_f32_16x16x32_bf16 v[120:123], v[116:119], v[56:59], v[120:123]
    v_mfma_f32_16x16x32_bf16 v[124:127], v[60:63], v[60:63], v[124:127]
    buffer_load_dwordx4 a[244:247], v2, s[4:7], s70 offen offset:1024 sc1
    v_mfma_f32_16x16x32_bf16 v[120:123], v[116:119], v[60:63], v[120:123]
    v_mfma_f32_16x16x32_bf16 v[124:127], v[64:67], v[64:67], v[124:127]
    v_mfma_f32_16x16x32_bf16 v[120:123], v[116:119], v[64:67], v[120:123]
    buffer_load_dwordx4 a[248:251], v2, s[4:7], s70 offen offset:2048 sc1
    s_waitcnt lgkmcnt(12)
    v_mfma_f32_16x16x32_bf16 v[124:127], v[68:71], v[68:71], v[124:127]
    v_mfma_f32_16x16x32_bf16 v[120:123], v[116:119], v[68:71], v[120:123]
    buffer_load_dwordx4 a[252:255], v2, s[4:7], s70 offen offset:3072 sc1
    s_waitcnt lgkmcnt(10)
    v_mfma_f32_16x16x32_bf16 v[124:127], v[72:75], v[72:75], v[124:127]
    v_mfma_f32_16x16x32_bf16 v[120:123], v[116:119], v[72:75], v[120:123]
    s_waitcnt vmcnt(9)
    s_mov_b64 exec, 1
    buffer_store_dword v17, v29, s[4:7], s98 offen offset:4
    s_mov_b64 exec, -1
    s_add_u32 s70, s78, 8192
    buffer_load_dwordx4 v[96:99], v2, s[4:7], s70 offen offset:0 sc1
    s_waitcnt lgkmcnt(8)
    v_mfma_f32_16x16x32_bf16 v[124:127], v[76:79], v[76:79], v[124:127]
    v_mfma_f32_16x16x32_bf16 v[120:123], v[116:119], v[76:79], v[120:123]
    buffer_load_dwordx4 v[100:103], v2, s[4:7], s70 offen offset:1024 sc1
    s_waitcnt lgkmcnt(6)
    v_mfma_f32_16x16x32_bf16 v[124:127], v[80:83], v[80:83], v[124:127]
    v_mfma_f32_16x16x32_bf16 v[120:123], v[116:119], v[80:83], v[120:123]
    buffer_load_dwordx4 v[104:107], v2, s[4:7], s70 offen offset:2048 sc1
    s_waitcnt lgkmcnt(4)
    v_mfma_f32_16x16x32_bf16 v[124:127], v[84:87], v[84:87], v[124:127]
    v_mfma_f32_16x16x32_bf16 v[120:123], v[116:119], v[84:87], v[120:123]
    s_waitcnt lgkmcnt(0)
    s_barrier
    s_waitcnt vmcnt(11)
    v_mfma_f32_32x32x16_bf16 v[32:47], a[0:3], a[224:227], 0
    v_mfma_f32_32x32x16_bf16 v[48:63], a[4:7], a[224:227], 0
    buffer_load_dwordx4 a[224:227], v2, s[4:7], s70 offen offset:3072 sc1
    s_waitcnt vmcnt(11)
    v_mfma_f32_32x32x16_bf16 v[32:47], a[8:11], a[228:231], v[32:47]
    s_mov_b32 vcc_lo, 0x00100001
    s_mov_b32 vcc_hi, 0x10000100
    v_cndmask_b32 v116, 0, v124, vcc
    s_lshl_b64 vcc, vcc, 1
    v_cndmask_b32 v116, v116, v125, vcc
    s_lshl_b64 vcc, vcc, 1
    v_mfma_f32_32x32x16_bf16 v[48:63], a[12:15], a[228:231], v[48:63]
    s_add_u32 s70, s78, 12288
    buffer_load_dwordx4 a[228:231], v2, s[4:7], s70 offen offset:0 sc1
    v_cndmask_b32 v116, v116, v126, vcc
    s_waitcnt vmcnt(11)
    v_mfma_f32_32x32x16_bf16 v[32:47], a[16:19], a[232:235], v[32:47]
    s_lshl_b64 vcc, vcc, 1
    v_cndmask_b32 v116, v116, v127, vcc
    v_mov_b32 v117, v116
    v_mul_f32 v120, 0x3b124925, v120
    v_mfma_f32_32x32x16_bf16 v[48:63], a[20:23], a[232:235], v[48:63]
    buffer_load_dwordx4 a[232:235], v2, s[4:7], s70 offen offset:1024 sc1
    v_permlane32_swap_b32 v116, v117
    s_waitcnt vmcnt(11)
    v_mfma_f32_32x32x16_bf16 v[32:47], a[24:27], a[236:239], v[32:47]
    v_add_f32 v116, v116, v117
    v_mov_b32 v117, v116
    v_mfma_f32_32x32x16_bf16 v[48:63], a[28:31], a[236:239], v[48:63]
    buffer_load_dwordx4 a[236:239], v2, s[4:7], s70 offen offset:2048 sc1
    s_waitcnt vmcnt(11)
    v_mfma_f32_32x32x16_bf16 v[32:47], a[32:35], a[240:243], v[32:47]
    v_permlane16_swap_b32 v116, v117
    v_add_f32_e64 v116, v116, v117
    v_mul_f32 v116, 0x3b124925, v116
    v_fma_f32 v116, -v120, v120, v116
    v_max_f32_e64 v116, 0, v116
    v_add_f32 v116, 0x3727c5ac, v116
    v_mfma_f32_32x32x16_bf16 v[48:63], a[36:39], a[240:243], v[48:63]
    buffer_load_dwordx4 a[240:243], v2, s[4:7], s70 offen offset:3072 sc1
    v_rsq_f32 v116, v116
    s_waitcnt vmcnt(11)
    v_mfma_f32_32x32x16_bf16 v[32:47], a[40:43], a[244:247], v[32:47]
    v_mov_b32 v140, v116
    v_mov_b32 v142, v116
    v_mfma_f32_32x32x16_bf16 v[48:63], a[44:47], a[244:247], v[48:63]
    s_add_u32 s70, s78, 16384
    buffer_load_dwordx4 a[244:247], v2, s[4:7], s70 offen offset:0 sc1
    s_waitcnt vmcnt(11)
    v_mfma_f32_32x32x16_bf16 v[32:47], a[48:51], a[248:251], v[32:47]
    v_mov_b32_dpp v140, v116 row_ror:8 row_mask:0xf bank_mask:0xc
    v_mov_b32_dpp v142, v116 row_ror:8 row_mask:0xf bank_mask:0x3
    v_lshlrev_b32 v116, 16, v132
    v_and_b32 v117, s65, v132
    v_lshlrev_b32 v118, 16, v133
    v_and_b32_e64 v119, s65, v133
    v_mfma_f32_32x32x16_bf16 v[48:63], a[52:55], a[248:251], v[48:63]
    buffer_load_dwordx4 a[248:251], v2, s[4:7], s70 offen offset:1024 sc1
    v_lshlrev_b32 v120, 16, v134
    s_waitcnt vmcnt(11)
    v_mfma_f32_32x32x16_bf16 v[32:47], a[56:59], a[252:255], v[32:47]
    v_and_b32 v121, s65, v134
    v_lshlrev_b32 v122, 16, v135
    v_and_b32_e64 v123, s65, v135
    v_mfma_f32_32x32x16_bf16 v[48:63], a[60:63], a[252:255], v[48:63]
    buffer_load_dwordx4 a[252:255], v2, s[4:7], s70 offen offset:2048 sc1
    s_waitcnt vmcnt(10)
    v_mfma_f32_32x32x16_bf16 v[32:47], a[64:67], v[96:99], v[32:47]
    v_mfma_f32_32x32x16_bf16 v[48:63], a[68:71], v[96:99], v[48:63]
    buffer_load_dwordx4 v[96:99], v2, s[4:7], s70 offen offset:3072 sc1
    s_waitcnt vmcnt(10)
    v_mfma_f32_32x32x16_bf16 v[32:47], a[72:75], v[100:103], v[32:47]
    v_mfma_f32_32x32x16_bf16 v[48:63], a[76:79], v[100:103], v[48:63]
    s_add_u32 s70, s78, 20480
    buffer_load_dwordx4 v[100:103], v2, s[4:7], s70 offen offset:0 sc1
    s_waitcnt vmcnt(10)
    v_mfma_f32_32x32x16_bf16 v[32:47], a[80:83], v[104:107], v[32:47]
    buffer_load_dword v31, v28, s[4:7], s98 offen offset:4 sc1
    v_mfma_f32_32x32x16_bf16 v[48:63], a[84:87], v[104:107], v[48:63]
    buffer_load_dwordx4 v[104:107], v2, s[4:7], s70 offen offset:1024 sc1
    s_waitcnt vmcnt(11)
    v_mfma_f32_32x32x16_bf16 v[32:47], a[88:91], a[224:227], v[32:47]
    v_mfma_f32_32x32x16_bf16 v[48:63], a[92:95], a[224:227], v[48:63]
    buffer_load_dwordx4 a[224:227], v2, s[4:7], s70 offen offset:2048 sc1
    s_waitcnt vmcnt(11)
    v_mfma_f32_32x32x16_bf16 v[32:47], a[96:99], a[228:231], v[32:47]
    v_mfma_f32_32x32x16_bf16 v[48:63], a[100:103], a[228:231], v[48:63]
    buffer_load_dwordx4 a[228:231], v2, s[4:7], s70 offen offset:3072 sc1
    s_waitcnt vmcnt(11)
    v_mfma_f32_32x32x16_bf16 v[32:47], a[104:107], a[232:235], v[32:47]
    v_mfma_f32_32x32x16_bf16 v[48:63], a[108:111], a[232:235], v[48:63]
    s_add_u32 s70, s78, 24576
    buffer_load_dwordx4 a[232:235], v2, s[4:7], s70 offen offset:0 sc1
    s_waitcnt vmcnt(11)
    v_mfma_f32_32x32x16_bf16 v[32:47], a[112:115], a[236:239], v[32:47]
    v_mfma_f32_32x32x16_bf16 v[48:63], a[116:119], a[236:239], v[48:63]
    buffer_load_dwordx4 a[236:239], v2, s[4:7], s70 offen offset:1024 sc1
    s_waitcnt vmcnt(11)
    v_mfma_f32_32x32x16_bf16 v[32:47], a[120:123], a[240:243], v[32:47]
    v_mfma_f32_32x32x16_bf16 v[48:63], a[124:127], a[240:243], v[48:63]
    buffer_load_dwordx4 a[240:243], v2, s[4:7], s70 offen offset:2048 sc1
    s_waitcnt vmcnt(11)
    v_mfma_f32_32x32x16_bf16 v[32:47], a[128:131], a[244:247], v[32:47]
    v_mfma_f32_32x32x16_bf16 v[48:63], a[132:135], a[244:247], v[48:63]
    buffer_load_dwordx4 a[244:247], v2, s[4:7], s70 offen offset:3072 sc1
    s_waitcnt vmcnt(11)
    v_mfma_f32_32x32x16_bf16 v[32:47], a[136:139], a[248:251], v[32:47]
    v_mfma_f32_32x32x16_bf16 v[48:63], a[140:143], a[248:251], v[48:63]
    s_waitcnt vmcnt(10)
    v_mfma_f32_32x32x16_bf16 v[32:47], a[144:147], a[252:255], v[32:47]
    v_mfma_f32_32x32x16_bf16 v[48:63], a[148:151], a[252:255], v[48:63]
    s_waitcnt vmcnt(9)
    v_mfma_f32_32x32x16_bf16 v[32:47], a[152:155], v[96:99], v[32:47]
    v_mfma_f32_32x32x16_bf16 v[48:63], a[156:159], v[96:99], v[48:63]
    s_waitcnt vmcnt(8)
    v_mfma_f32_32x32x16_bf16 v[32:47], a[160:163], v[100:103], v[32:47]
    s_waitcnt vmcnt(7)
    v_cmp_eq_u32_e64 vcc, 0, v31
    v_mfma_f32_32x32x16_bf16 v[48:63], a[164:167], v[100:103], v[48:63]
    s_cbranch_vccnz L_slow_38
L_ok_40:
    s_add_u32 s70, s78, 229376
    buffer_load_dwordx4 a[248:251], v2, s[4:7], s70 offen offset:0 sc1
    s_waitcnt vmcnt(7)
    v_mfma_f32_32x32x16_bf16 v[32:47], a[168:171], v[104:107], v[32:47]
    buffer_load_dwordx4 a[252:255], v2, s[4:7], s70 offen offset:1024 sc1
    v_mfma_f32_32x32x16_bf16 v[48:63], a[172:175], v[104:107], v[48:63]
    buffer_load_dwordx4 v[96:99], v2, s[4:7], s70 offen offset:2048 sc1
    s_waitcnt vmcnt(8)
    v_mfma_f32_32x32x16_bf16 v[32:47], a[176:179], a[224:227], v[32:47]
    buffer_load_dwordx4 v[100:103], v2, s[4:7], s70 offen offset:3072 sc1
    v_mfma_f32_32x32x16_bf16 v[48:63], a[180:183], a[224:227], v[48:63]
    s_add_u32 s70, s78, 233472
    buffer_load_dwordx4 v[104:107], v2, s[4:7], s70 offen offset:0 sc1
    s_waitcnt vmcnt(9)
    v_mfma_f32_32x32x16_bf16 v[32:47], a[184:187], a[228:231], v[32:47]
    buffer_load_dwordx4 a[224:227], v2, s[4:7], s70 offen offset:1024 sc1
    v_mfma_f32_32x32x16_bf16 v[48:63], a[188:191], a[228:231], v[48:63]
    buffer_load_dwordx4 a[228:231], v2, s[4:7], s70 offen offset:2048 sc1
    s_waitcnt vmcnt(10)
    v_mfma_f32_32x32x16_bf16 v[32:47], a[192:195], a[232:235], v[32:47]
    v_mfma_f32_32x32x16_bf16 v[48:63], a[196:199], a[232:235], v[48:63]
    buffer_load_dwordx4 a[232:235], v2, s[4:7], s70 offen offset:3072 sc1
    s_waitcnt vmcnt(10)
    v_mfma_f32_32x32x16_bf16 v[32:47], a[200:203], a[236:239], v[32:47]
    v_mfma_f32_32x32x16_bf16 v[48:63], a[204:207], a[236:239], v[48:63]
    s_add_u32 s70, s78, 237568
    buffer_load_dwordx4 a[236:239], v2, s[4:7], s70 offen offset:0 sc1
    s_waitcnt vmcnt(10)
    v_mfma_f32_32x32x16_bf16 v[32:47], a[208:211], a[240:243], v[32:47]
    v_mfma_f32_32x32x16_bf16 v[48:63], a[212:215], a[240:243], v[48:63]
    buffer_load_dwordx4 a[240:243], v2, s[4:7], s70 offen offset:1024 sc1
    s_waitcnt vmcnt(10)
    v_mfma_f32_32x32x16_bf16 v[32:47], a[216:219], a[244:247], v[32:47]
    v_mfma_f32_32x32x16_bf16 v[48:63], a[220:223], a[244:247], v[48:63]
    buffer_load_dwordx4 a[244:247], v2, s[4:7], s70 offen offset:2048 sc1
    s_waitcnt vmcnt(10)
    v_mfma_f32_32x32x16_bf16 v[64:79], a[0:3], a[248:251], 0
    v_mfma_f32_32x32x16_bf16 v[80:95], a[4:7], a[248:251], 0
    buffer_load_dwordx4 a[248:251], v2, s[4:7], s70 offen offset:3072 sc1
    s_waitcnt vmcnt(10)
    v_mfma_f32_32x32x16_bf16 v[64:79], a[8:11], a[252:255], v[64:79]
    s_mov_b64 exec, 1
    buffer_store_dword v17, v29, s[4:7], s80 offen offset:4 sc1
    s_mov_b64 exec, -1
    v_mfma_f32_32x32x16_bf16 v[80:95], a[12:15], a[252:255], v[80:95]
    s_add_u32 s70, s78, 241664
    buffer_load_dwordx4 a[252:255], v2, s[4:7], s70 offen offset:0 sc1
    ds_write_b128 v24, v[32:35] offset:0
    s_waitcnt vmcnt(11)
    v_mfma_f32_32x32x16_bf16 v[64:79], a[16:19], v[96:99], v[64:79]
    ds_write_b128 v24, v[36:39] offset:1152
    v_mfma_f32_32x32x16_bf16 v[80:95], a[20:23], v[96:99], v[80:95]
    buffer_load_dwordx4 v[96:99], v2, s[4:7], s70 offen offset:1024 sc1
    ds_write_b128 v24, v[40:43] offset:2304
    s_waitcnt vmcnt(11)
    v_mfma_f32_32x32x16_bf16 v[64:79], a[24:27], v[100:103], v[64:79]
    ds_write_b128 v24, v[44:47] offset:3456
    v_mfma_f32_32x32x16_bf16 v[80:95], a[28:31], v[100:103], v[80:95]
    buffer_load_dwordx4 v[100:103], v2, s[4:7], s70 offen offset:2048 sc1
    ds_write_b128 v24, v[48:51] offset:4608
    s_waitcnt vmcnt(11)
    v_mfma_f32_32x32x16_bf16 v[64:79], a[32:35], v[104:107], v[64:79]
    ds_write_b128 v24, v[52:55] offset:5760
    v_mfma_f32_32x32x16_bf16 v[80:95], a[36:39], v[104:107], v[80:95]
    buffer_load_dwordx4 v[104:107], v2, s[4:7], s70 offen offset:3072 sc1
    ds_write_b128 v24, v[56:59] offset:6912
    s_waitcnt vmcnt(11)
    v_mfma_f32_32x32x16_bf16 v[64:79], a[40:43], a[224:227], v[64:79]
    ds_write_b128 v24, v[60:63] offset:8064
    v_mfma_f32_32x32x16_bf16 v[80:95], a[44:47], a[224:227], v[80:95]
    s_add_u32 s70, s78, 245760
    buffer_load_dwordx4 a[224:227], v2, s[4:7], s70 offen offset:0 sc1
    s_waitcnt vmcnt(11)
    v_mfma_f32_32x32x16_bf16 v[64:79], a[48:51], a[228:231], v[64:79]
    s_waitcnt lgkmcnt(0)
    s_barrier
    ds_read_b128 v[32:35], v25 offset:0
    ds_read_b128 v[36:39], v25 offset:512
    ds_read_b128 v[40:43], v25 offset:9216
    v_mfma_f32_32x32x16_bf16 v[80:95], a[52:55], a[228:231], v[80:95]
    buffer_load_dwordx4 a[228:231], v2, s[4:7], s70 offen offset:1024 sc1
    ds_read_b128 v[44:47], v25 offset:9728
    ds_read_b128 v[48:51], v25 offset:18432
    ds_read_b128 v[52:55], v25 offset:18944
    s_waitcnt vmcnt(11)
L_pg4:
    s_cbranch_execz L_ret1
    s_nop 0
    v_mfma_f32_32x32x16_bf16 v[64:79], a[56:59], a[232:235], v[64:79]
    ds_read_b128 v[56:59], v25 offset:27648
    ds_read_b128 v[60:63], v25 offset:28160
    v_mfma_f32_32x32x16_bf16 v[80:95], a[60:63], a[232:235], v[80:95]
    buffer_load_dwordx4 a[232:235], v2, s[4:7], s70 offen offset:2048 sc1
    s_waitcnt vmcnt(11)
    v_mfma_f32_32x32x16_bf16 v[64:79], a[64:67], a[236:239], v[64:79]
    s_waitcnt lgkmcnt(5)
    v_add_f32 v32, v32, v40
    v_add_f32 v33, v33, v41
    v_add_f32 v34, v34, v42
    v_add_f32 v35, v35, v43
    s_waitcnt lgkmcnt(4)
    v_add_f32 v36, v36, v44
    v_add_f32 v37, v37, v45
    v_add_f32 v38, v38, v46
    v_add_f32 v39, v39, v47
    s_waitcnt lgkmcnt(1)
    v_add_f32 v48, v48, v56
    v_add_f32 v49, v49, v57
    v_add_f32_e64 v50, v50, v58
    v_mfma_f32_32x32x16_bf16 v[80:95], a[68:71], a[236:239], v[80:95]
    buffer_load_dwordx4 a[236:239], v2, s[4:7], s70 offen offset:3072 sc1
    v_add_f32 v51, v51, v59
    s_waitcnt lgkmcnt(0)
    v_add_f32 v52, v52, v60
    v_add_f32 v53, v53, v61
    v_add_f32 v54, v54, v62
    v_add_f32 v55, v55, v63
    v_add_f32 v32, v32, v48
    s_waitcnt vmcnt(11)
    v_mfma_f32_32x32x16_bf16 v[64:79], a[72:75], a[240:243], v[64:79]
    v_add_f32 v33, v33, v49
    v_add_f32 v34, v34, v50
    v_add_f32 v35, v35, v51
    v_add_f32 v36, v36, v52
    v_add_f32 v37, v37, v53
    v_add_f32 v38, v38, v54
    v_add_f32_e64 v39, v39, v55
    v_fma_f32 v32, v32, v140, v116
    v_fma_f32 v33, v33, v140, v117
    v_fma_f32 v34, v34, v140, v118
    v_fma_f32 v35, v35, v140, v119
    v_mfma_f32_32x32x16_bf16 v[80:95], a[76:79], a[240:243], v[80:95]
    s_add_u32 s70, s78, 249856
    buffer_load_dwordx4 a[240:243], v2, s[4:7], s70 offen offset:0 sc1
    v_fma_f32 v36, v36, v140, v120
    v_fma_f32 v37, v37, v140, v121
    v_fma_f32 v38, v38, v140, v122
    v_fma_f32 v39, v39, v140, v123
    v_cvt_pk_bf16_f32 v56, v32, v33
    v_cvt_pk_bf16_f32 v57, v34, v35
    s_waitcnt vmcnt(11)
    v_mfma_f32_32x32x16_bf16 v[64:79], a[80:83], a[244:247], v[64:79]
    v_cvt_pk_bf16_f32 v58, v36, v37
    v_cvt_pk_bf16_f32 v59, v38, v39
    s_mov_b32 vcc_lo, 0x0f0f0f0f
    s_mov_b32 vcc_hi, 0x0f0f0f0f
    v_cndmask_b32_dpp v60, v58, v56, vcc row_ror:4 row_mask:0xf bank_mask:0xf
    v_cndmask_b32_dpp v62, v59, v57, vcc row_ror:4 row_mask:0xf bank_mask:0xf
    s_not_b64 vcc, vcc
    v_cndmask_b32_dpp v61, v56, v58, vcc row_ror:12 row_mask:0xf bank_mask:0xf
    v_cndmask_b32_dpp v63, v57, v59, vcc row_ror:12 row_mask:0xf bank_mask:0xf
    s_mov_b32 s67, 0x19e0000
    buffer_store_dwordx4 v[60:63], v26, s[4:7], s67 offen sc1
    v_mfma_f32_32x32x16_bf16 v[80:95], a[84:87], a[244:247], v[80:95]
    buffer_load_dwordx4 a[244:247], v2, s[4:7], s70 offen offset:1024 sc1
    v_lshlrev_b32 v48, 16, v56
    v_and_b32 v49, s65, v56
    v_lshlrev_b32 v50, 16, v57
    v_and_b32 v51, s65, v57
    v_lshlrev_b32 v52, 16, v58
    v_and_b32 v53, s65, v58
    s_waitcnt vmcnt(12)
    v_mfma_f32_32x32x16_bf16 v[64:79], a[88:91], a[248:251], v[64:79]
    v_lshlrev_b32 v54, 16, v59
    v_and_b32 v55, s65, v59
    v_add_f32 v32, v48, v49
    v_mul_f32 v33, v48, v48
    v_fmac_f32 v33, v49, v49
    v_add_f32 v32, v32, v50
    v_fmac_f32 v33, v50, v50
    v_add_f32 v32, v32, v51
    v_fmac_f32 v33, v51, v51
    v_add_f32 v32, v32, v52
    v_fmac_f32 v33, v52, v52
    v_mfma_f32_32x32x16_bf16 v[80:95], a[92:95], a[248:251], v[80:95]
    buffer_load_dwordx4 a[248:251], v2, s[4:7], s70 offen offset:2048 sc1
    v_add_f32 v32, v32, v53
    v_fmac_f32 v33, v53, v53
    v_add_f32 v32, v32, v54
    v_fmac_f32 v33, v54, v54
    v_add_f32 v32, v32, v55
    v_fmac_f32 v33, v55, v55
    s_waitcnt vmcnt(11)
    v_mfma_f32_32x32x16_bf16 v[64:79], a[96:99], a[252:255], v[64:79]
    v_permlane32_swap_b32 v32, v33
    v_add_f32 v32, v32, v33
    v_mov_b32 v34, v32
    s_nop 1
    v_permlane16_swap_b32 v32, v34
    v_add_f32 v32, v32, v34
    s_nop 1
    v_add_f32_dpp v32, v32, v32 row_ror:8 row_mask:0xf bank_mask:0xf
    v_lshrrev_b32_e64 v34, 1, v32
    v_add_u32 v33, 0x3000000, v32
    v_add_u32 v34, 0x24400000, v34
    s_nop 1
    v_permlane32_swap_b32 v34, v33
    v_and_b32 v33, 0x7f800000, v33
    v_mfma_f32_32x32x16_bf16 v[80:95], a[100:103], a[252:255], v[80:95]
    buffer_load_dwordx4 a[252:255], v2, s[4:7], s70 offen offset:3072 sc1
    v_mul_f32 v33, 0x3fc00000, v33
    v_add_f32 v32, v32, v33
    v_sub_f32 v32, v32, v33
    s_mov_b32 s67, 0x48000
    s_mov_b32 exec_lo, 0xff
    s_mov_b32 exec_hi, 0xff
    buffer_atomic_add_f32 v32, v27, s[4:7], s67 offen sc1
    s_mov_b64 exec, -1
    s_waitcnt vmcnt(12)
    v_mfma_f32_32x32x16_bf16 v[64:79], a[104:107], v[96:99], v[64:79]
    v_lshlrev_b32 v116, 16, v136
    v_and_b32 v117, s65, v136
    v_lshlrev_b32 v118, 16, v137
    v_and_b32 v119, s65, v137
    v_lshlrev_b32 v120, 16, v138
    v_and_b32 v121, s65, v138
    v_lshlrev_b32 v122, 16, v139
    v_and_b32 v123, s65, v139
    v_mfma_f32_32x32x16_bf16 v[80:95], a[108:111], v[96:99], v[80:95]
    s_add_u32 s70, s78, 253952
    buffer_load_dwordx4 v[96:99], v2, s[4:7], s70 offen offset:0 sc1
    s_waitcnt vmcnt(12)
    v_mfma_f32_32x32x16_bf16 v[64:79], a[112:115], v[100:103], v[64:79]
    v_mfma_f32_32x32x16_bf16 v[80:95], a[116:119], v[100:103], v[80:95]
    buffer_load_dwordx4 v[100:103], v2, s[4:7], s70 offen offset:1024 sc1
    s_waitcnt vmcnt(12)
    v_mfma_f32_32x32x16_bf16 v[64:79], a[120:123], v[104:107], v[64:79]
    v_mfma_f32_32x32x16_bf16 v[80:95], a[124:127], v[104:107], v[80:95]
    buffer_load_dwordx4 v[104:107], v2, s[4:7], s70 offen offset:2048 sc1
    s_waitcnt vmcnt(12)
    v_mfma_f32_32x32x16_bf16 v[64:79], a[128:131], a[224:227], v[64:79]
    v_mfma_f32_32x32x16_bf16 v[80:95], a[132:135], a[224:227], v[80:95]
    buffer_load_dwordx4 a[224:227], v2, s[4:7], s70 offen offset:3072 sc1
    s_waitcnt vmcnt(12)
    v_mfma_f32_32x32x16_bf16 v[64:79], a[136:139], a[228:231], v[64:79]
    v_mfma_f32_32x32x16_bf16 v[80:95], a[140:143], a[228:231], v[80:95]
    s_waitcnt vmcnt(11)
    v_mfma_f32_32x32x16_bf16 v[64:79], a[144:147], a[232:235], v[64:79]
    v_mfma_f32_32x32x16_bf16 v[80:95], a[148:151], a[232:235], v[80:95]
    s_waitcnt vmcnt(10)
    v_mfma_f32_32x32x16_bf16 v[64:79], a[152:155], a[236:239], v[64:79]
    v_mfma_f32_32x32x16_bf16 v[80:95], a[156:159], a[236:239], v[80:95]
    s_waitcnt vmcnt(9)
    v_mfma_f32_32x32x16_bf16 v[64:79], a[160:163], a[240:243], v[64:79]
    v_mfma_f32_32x32x16_bf16 v[80:95], a[164:167], a[240:243], v[80:95]
    s_waitcnt vmcnt(7)
    v_mfma_f32_32x32x16_bf16 v[64:79], a[168:171], a[244:247], v[64:79]
    v_mfma_f32_32x32x16_bf16 v[80:95], a[172:175], a[244:247], v[80:95]
    s_waitcnt vmcnt(6)
    v_mfma_f32_32x32x16_bf16 v[64:79], a[176:179], a[248:251], v[64:79]
    v_mfma_f32_32x32x16_bf16 v[80:95], a[180:183], a[248:251], v[80:95]
    s_waitcnt vmcnt(5)
    v_mfma_f32_32x32x16_bf16 v[64:79], a[184:187], a[252:255], v[64:79]
    v_mfma_f32_32x32x16_bf16 v[80:95], a[188:191], a[252:255], v[80:95]
    s_waitcnt vmcnt(3)
    v_mfma_f32_32x32x16_bf16 v[64:79], a[192:195], v[96:99], v[64:79]
    s_barrier
    s_mov_b32 s66, 0x18000
    s_mov_b64 exec, 3
    buffer_store_dword v17, v15, s[4:7], s66 offen sc1
    s_mov_b64 exec, -1
    s_waitcnt vmcnt(3)
    v_mfma_f32_32x32x16_bf16 v[64:79], a[200:203], v[100:103], v[64:79]
    s_waitcnt vmcnt(2)
    v_mfma_f32_32x32x16_bf16 v[64:79], a[208:211], v[104:107], v[64:79]
    s_waitcnt vmcnt(1)
    v_mfma_f32_32x32x16_bf16 v[64:79], a[216:219], a[224:227], v[64:79]
    v_mfma_f32_32x32x16_bf16 v[80:95], a[196:199], v[96:99], v[80:95]
    s_nop 3
    v_mfma_f32_32x32x16_bf16 v[80:95], a[204:207], v[100:103], v[80:95]
    s_nop 3
    v_mfma_f32_32x32x16_bf16 v[80:95], a[212:215], v[104:107], v[80:95]
    s_nop 0
    ds_write_b128 v24, v[64:67] offset:36864
    v_mfma_f32_32x32x16_bf16 v[80:95], a[220:223], a[224:227], v[80:95]
    ds_write_b128 v24, v[68:71] offset:38016
    ds_write_b128 v24, v[72:75] offset:39168
    ds_write_b128 v24, v[76:79] offset:40320
    s_nop 8
    s_nop 0
    ds_write_b128 v24, v[80:83] offset:41472
    ds_write_b128 v24, v[84:87] offset:42624
    ds_write_b128 v24, v[88:91] offset:43776
    ds_write_b128 v24, v[92:95] offset:44928
    s_waitcnt lgkmcnt(0)
    s_barrier
    ds_read_b128 v[64:67], v25 offset:36864
    ds_read_b128 v[68:71], v25 offset:37376
    ds_read_b128 v[72:75], v25 offset:46080
    ds_read_b128 v[76:79], v25 offset:46592
    ds_read_b128 v[80:83], v25 offset:55296
    ds_read_b128 v[84:87], v25 offset:55808
    ds_read_b128 v[88:91], v25 offset:64512
    ds_read_b128 v[92:95], v25 offset:65024
    s_add_u32 s97, s74, 0x18000
    buffer_load_dword v19, v16, s[4:7], s97 offen offset:0 sc1
    s_waitcnt lgkmcnt(5)
    v_pk_add_f32 v[64:65], v[64:65], v[72:73]
    v_pk_add_f32 v[66:67], v[66:67], v[74:75]
    s_waitcnt lgkmcnt(4)
    v_pk_add_f32 v[68:69], v[68:69], v[76:77]
    v_pk_add_f32 v[70:71], v[70:71], v[78:79]
    s_waitcnt lgkmcnt(1)
    v_pk_add_f32 v[80:81], v[80:81], v[88:89]
    v_pk_add_f32 v[82:83], v[82:83], v[90:91]
    s_waitcnt lgkmcnt(0)
    v_pk_add_f32 v[84:85], v[84:85], v[92:93]
    v_pk_add_f32 v[86:87], v[86:87], v[94:95]
    v_pk_add_f32 v[64:65], v[64:65], v[80:81]
    v_pk_add_f32 v[66:67], v[66:67], v[82:83]
    v_pk_add_f32 v[68:69], v[68:69], v[84:85]
    v_pk_add_f32 v[70:71], v[70:71], v[86:87]
    v_pk_fma_f32 v[64:65], v[64:65], v[142:143], v[116:117] op_sel_hi:[1,0,1]
    v_pk_fma_f32 v[66:67], v[66:67], v[142:143], v[118:119] op_sel_hi:[1,0,1]
    v_pk_fma_f32 v[68:69], v[68:69], v[142:143], v[120:121] op_sel_hi:[1,0,1]
    v_pk_fma_f32 v[70:71], v[70:71], v[142:143], v[122:123] op_sel_hi:[1,0,1]
    v_cvt_pk_bf16_f32 v88, v64, v65
    v_cvt_pk_bf16_f32 v89, v66, v67
    v_cvt_pk_bf16_f32 v90, v68, v69
    v_cvt_pk_bf16_f32 v91, v70, v71
    s_mov_b32 vcc_lo, 0x0f0f0f0f
    s_mov_b32 vcc_hi, 0x0f0f0f0f
    v_cndmask_b32_dpp v92, v90, v88, vcc row_ror:4 row_mask:0xf bank_mask:0xf
    v_cndmask_b32_dpp v94, v91, v89, vcc row_ror:4 row_mask:0xf bank_mask:0xf
    s_not_b64 vcc, vcc
    s_nop 0
    v_cndmask_b32_dpp v93, v88, v90, vcc row_ror:12 row_mask:0xf bank_mask:0xf
    v_cndmask_b32_dpp v95, v89, v91, vcc row_ror:12 row_mask:0xf bank_mask:0xf
    s_mov_b32 s67, 0x19e2000
    buffer_store_dwordx4 v[92:95], v26, s[4:7], s67 offen sc1
    v_mov_b32 v64, 0
    v_mov_b32 v65, 0
    v_dot2c_f32_bf16 v64, s64, v88
    v_dot2c_f32_bf16 v65, v88, v88
    v_dot2c_f32_bf16 v64, s64, v89
    v_dot2c_f32_bf16 v65, v89, v89
    v_dot2c_f32_bf16 v64, s64, v90
    v_dot2c_f32_bf16 v65, v90, v90
    v_dot2c_f32_bf16 v64, s64, v91
    v_dot2c_f32_bf16 v65, v91, v91
    s_nop 2
    v_permlane32_swap_b32 v64, v65
    v_add_f32 v64, v64, v65
    v_mov_b32 v66, v64
    s_nop 1
    v_permlane16_swap_b32 v64, v66
    v_add_f32 v64, v64, v66
    s_nop 1
    v_add_f32_dpp v64, v64, v64 row_ror:8 row_mask:0xf bank_mask:0xf
    v_lshrrev_b32_e64 v66, 1, v64
    v_add_u32 v65, 0x3000000, v64
    v_add_u32 v66, 0x24400000, v66
    s_nop 1
    v_permlane32_swap_b32 v66, v65
    v_and_b32 v65, 0x7f800000, v65
    v_mul_f32 v65, 0x3fc00000, v65
    v_add_f32 v64, v64, v65
    v_sub_f32 v64, v64, v65
    s_mov_b32 s67, 0x4a000
    s_mov_b32 exec_lo, 0xff
    s_mov_b32 exec_hi, 0xff
    buffer_atomic_add_f32 v64, v27, s[4:7], s67 offen sc1
    s_mov_b64 exec, -1
    s_nop 0
    ds_read2_b32 v[64:65], v6 offset0:176 offset1:177
    ds_read2_b32 v[66:67], v6 offset0:178 offset1:179
    ds_read2_b32 v[68:69], v6 offset0:48 offset1:49
    ds_read2_b32 v[70:71], v6 offset0:50 offset1:51
    ds_read2_b32 v[72:73], v7 offset0:176 offset1:177
    ds_read2_b32 v[74:75], v7 offset0:178 offset1:179
    ds_read2_b32 v[76:77], v7 offset0:48 offset1:49
    ds_read2_b32 v[78:79], v7 offset0:50 offset1:51
    ds_read2_b32 v[80:81], v6 offset0:160 offset1:161
    ds_read2_b32 v[82:83], v6 offset0:162 offset1:163
    ds_read2_b32 v[84:85], v6 offset0:32 offset1:33
    ds_read2_b32 v[86:87], v6 offset0:34 offset1:35
    ds_read2_b32 v[88:89], v7 offset0:160 offset1:161
    ds_read2_b32 v[90:91], v7 offset0:162 offset1:163
    ds_read2_b32 v[92:93], v7 offset0:32 offset1:33
    ds_read2_b32 v[94:95], v7 offset0:34 offset1:35
    ds_read2_b32 v[96:97], v6 offset0:144 offset1:145
    ds_read2_b32 v[98:99], v6 offset0:146 offset1:147
    ds_read2_b32 v[100:101], v6 offset0:16 offset1:17
    ds_read2_b32 v[102:103], v6 offset0:18 offset1:19
    ds_read2_b32 v[104:105], v7 offset0:144 offset1:145
    ds_read2_b32 v[106:107], v7 offset0:146 offset1:147
    ds_read2_b32 v[108:109], v7 offset0:16 offset1:17
    ds_read2_b32 v[110:111], v7 offset0:18 offset1:19
    ds_read2_b32 v[112:113], v6 offset0:128 offset1:129
    ds_read2_b32 v[114:115], v6 offset0:130 offset1:131
    ds_read2_b32 v[116:117], v6 offset0:0 offset1:1
    ds_read2_b32 v[118:119], v6 offset0:2 offset1:3
    ds_read2_b32 v[120:121], v7 offset0:128 offset1:129
    ds_read2_b32 v[122:123], v7 offset0:130 offset1:131
    ds_read2_b32 v[124:125], v7 offset0:0 offset1:1
    ds_read2_b32 v[126:127], v7 offset0:2 offset1:3
    s_waitcnt vmcnt(2)
    v_cmp_eq_u32 vcc, 0, v19
    s_cbranch_vccnz L_slow_41
L_ok_43:
    s_barrier
    s_mov_b32 s66, 0x48000
    s_add_u32 s69, s75, 0x1c0000
    buffer_load_dwordx4 v[32:35], v3, s[4:7], s66 offen offset:0 sc1
    buffer_load_dwordx2 v[40:41], v3, s[4:7], s69 offen offset:0 sc1
    buffer_load_dwordx4 v[36:39], v3, s[4:7], s66 offen offset:128 sc1
    buffer_load_dwordx2 v[42:43], v3, s[4:7], s69 offen offset:128 sc1
    s_waitcnt vmcnt(4)
    s_barrier
    s_mov_b32 s66, 0x20000
    s_mov_b64 exec, 3
    buffer_store_dword v17, v15, s[4:7], s66 offen sc1
    s_mov_b64 exec, -1
    s_mov_b64 exec, 0
    s_cmp_eq_u32 s3, 0
    s_cbranch_scc1 L_pg6
    s_cmp_eq_u32 s3, 1
    s_cbranch_scc1 L_pg7
    s_cmp_eq_u32 s3, 2
    s_cbranch_scc1 L_st2
    s_cmp_eq_u32 s3, 3
    s_cbranch_scc1 L_st3
L_ret2:
    s_mov_b64 exec, -1
    s_mov_b32 s82, 0x3b124925
    s_mov_b32 s83, 0x3727c5ac
    v_mov_b32 v136, s83
    s_waitcnt vmcnt(4)
    v_pk_mul_f32 v[32:33], v[32:33], s[82:83] op_sel_hi:[1,0]
    v_pk_fma_f32 v[34:35], v[34:35], s[82:83], v[136:137] op_sel_hi:[1,0,0]
    v_pk_fma_f32 v[34:35], v[32:33], v[32:33], v[34:35] neg_lo:[1,0,0] neg_hi:[1,0,0]
    v_max_f32 v34, s83, v34
    v_max_f32 v35, s83, v35
    v_rsq_f32 v34, v34
    v_rsq_f32 v35, v35
    s_waitcnt vmcnt(3)
    v_lshlrev_b32 v44, 16, v40
    v_and_b32 v46, s65, v40
    v_lshlrev_b32 v45, 16, v41
    v_and_b32_e64 v47, s65, v41
    v_pk_mul_f32 v[32:33], v[32:33], v[34:35]
    v_pk_fma_f32 v[44:45], v[44:45], v[34:35], v[32:33] neg_lo:[0,0,1] neg_hi:[0,0,1]
    v_perm_b32 v52, v41, v40, s91
    v_pk_fma_f32 v[46:47], v[46:47], v[34:35], v[32:33] neg_lo:[0,0,1] neg_hi:[0,0,1]
    v_perm_b32 v54, v41, v40, s92
    v_cvt_pk_bf16_f32 v48, v44, v45
    v_cvt_pk_bf16_f32 v50, v46, v47
    s_waitcnt vmcnt(2)
    v_pk_mul_f32 v[36:37], v[36:37], s[82:83] op_sel_hi:[1,0]
    v_pk_fma_f32 v[38:39], v[38:39], s[82:83], v[136:137] op_sel_hi:[1,0,0]
    v_pk_fma_f32 v[38:39], v[36:37], v[36:37], v[38:39] neg_lo:[1,0,0] neg_hi:[1,0,0]
    v_max_f32 v38, s83, v38
    v_max_f32 v39, s83, v39
    v_rsq_f32 v38, v38
    v_rsq_f32 v39, v39
    s_waitcnt vmcnt(1)
    v_lshlrev_b32 v44, 16, v42
    v_and_b32 v46, s65, v42
    v_lshlrev_b32 v45, 16, v43
    v_and_b32 v47, s65, v43
    v_pk_mul_f32 v[36:37], v[36:37], v[38:39]
    v_pk_fma_f32 v[44:45], v[44:45], v[38:39], v[36:37] neg_lo:[0,0,1] neg_hi:[0,0,1]
    v_perm_b32 v53, v43, v42, s91
    v_pk_fma_f32 v[46:47], v[46:47], v[38:39], v[36:37] neg_lo:[0,0,1] neg_hi:[0,0,1]
    v_perm_b32 v55, v43, v42, s92
    v_cvt_pk_bf16_f32 v49, v44, v45
    v_cvt_pk_bf16_f32 v51, v46, v47
    ds_write_b64 v4, v[48:49] offset:0
    ds_write_b64 v4, v[50:51] offset:4576
    ds_write_b64 v5, v[52:53] offset:0
    ds_write_b64 v5, v[54:55] offset:17920
    s_waitcnt lgkmcnt(0)
    s_barrier
    ds_read_b128 a[224:227], v10 offset:1728
    ds_read_b128 a[228:231], v10 offset:1216
    ds_read_b128 a[232:235], v10 offset:704
    ds_read_b128 a[236:239], v10 offset:192
    ds_read_b128 a[240:243], v10 offset:1664
    s_waitcnt lgkmcnt(4)
    v_mfma_f32_16x16x32_bf16 v[44:47], a[224:227], v[64:67], 0
    s_add_u32 s97, s74, 0x20000
    buffer_load_dword v19, v16, s[4:7], s97 offen offset:0 sc1
    ds_read_b128 a[224:227], v10 offset:1152
    s_waitcnt lgkmcnt(4)
    v_mfma_f32_16x16x32_bf16 v[40:43], a[228:231], v[64:67], 0
    ds_read_b128 a[244:247], v10 offset:640
    v_mfma_f32_16x16x32_bf16 v[44:47], a[228:231], v[68:71], v[44:47]
    ds_read_b128 a[228:231], v10 offset:128
    s_waitcnt lgkmcnt(5)
    v_mfma_f32_16x16x32_bf16 v[36:39], a[232:235], v[64:67], 0
    ds_read_b128 a[248:251], v10 offset:1600
    v_mfma_f32_16x16x32_bf16 v[40:43], a[232:235], v[68:71], v[40:43]
    ds_read_b128 a[252:255], v10 offset:1088
    v_mfma_f32_16x16x32_bf16 v[44:47], a[232:235], v[72:75], v[44:47]
    ds_read_b128 a[232:235], v10 offset:576
    s_waitcnt lgkmcnt(7)
    v_mfma_f32_16x16x32_bf16 v[32:35], a[236:239], v[64:67], 0
    ds_read_b128 v[140:143], v10 offset:64
    v_mfma_f32_16x16x32_bf16 v[36:39], a[236:239], v[68:71], v[36:39]
    v_mfma_f32_16x16x32_bf16 v[40:43], a[236:239], v[72:75], v[40:43]
    v_mfma_f32_16x16x32_bf16 v[44:47], a[236:239], v[76:79], v[44:47]
    ds_read_b128 a[236:239], v10 offset:1536
    s_waitcnt lgkmcnt(6)
    v_mfma_f32_16x16x32_bf16 v[44:47], a[240:243], v[80:83], v[44:47]
    ds_read_b128 a[240:243], v10 offset:1024
    v_mfma_f32_16x16x32_bf16 v[40:43], a[224:227], v[80:83], v[40:43]
    v_mfma_f32_16x16x32_bf16 v[44:47], a[224:227], v[84:87], v[44:47]
    ds_read_b128 a[224:227], v10 offset:512
    v_mfma_f32_16x16x32_bf16 v[36:39], a[244:247], v[80:83], v[36:39]
    v_mfma_f32_16x16x32_bf16 v[40:43], a[244:247], v[84:87], v[40:43]
    v_mfma_f32_16x16x32_bf16 v[44:47], a[244:247], v[88:91], v[44:47]
    ds_read_b128 a[244:247], v10 offset:0
    s_waitcnt lgkmcnt(8)
    v_mfma_f32_16x16x32_bf16 v[32:35], a[228:231], v[80:83], v[32:35]
    v_mfma_f32_16x16x32_bf16 v[36:39], a[228:231], v[84:87], v[36:39]
    v_mfma_f32_16x16x32_bf16 v[40:43], a[228:231], v[88:91], v[40:43]
    ds_read_b64_tr_b16 v[136:137], v11 offset:0
    ds_read_b64_tr_b16 v[138:139], v11 offset:512
    v_mfma_f32_16x16x32_bf16 v[44:47], a[228:231], v[92:95], v[44:47]
    ds_read2_b32 a[228:229], v9 offset0:0 offset1:1
    s_waitcnt lgkmcnt(8)
    v_mfma_f32_16x16x32_bf16 v[44:47], a[248:251], v[96:99], v[44:47]
    ds_read2_b32 a[230:231], v9 offset0:2 offset1:3
    v_mfma_f32_16x16x32_bf16 v[40:43], a[252:255], v[96:99], v[40:43]
    ds_read2_b32 a[248:249], v9 offset0:128 offset1:129
    v_mfma_f32_16x16x32_bf16 v[44:47], a[252:255], v[100:103], v[44:47]
    ds_read2_b32 a[250:251], v9 offset0:130 offset1:131
    v_mfma_f32_16x16x32_bf16 v[36:39], a[232:235], v[96:99], v[36:39]
    ds_read2_b32 a[252:253], v8 offset0:0 offset1:1
    v_mfma_f32_16x16x32_bf16 v[40:43], a[232:235], v[100:103], v[40:43]
    s_waitcnt lgkmcnt(6)
    v_lshlrev_b32_e64 v128, 16, v136
    ds_read2_b32 a[254:255], v8 offset0:2 offset1:3
    v_mfma_f32_16x16x32_bf16 v[44:47], a[232:235], v[104:107], v[44:47]
    v_and_b32_e64 v129, s65, v136
    ds_read2_b32 a[232:233], v8 offset0:128 offset1:129
    v_mfma_f32_16x16x32_bf16 v[32:35], v[140:143], v[96:99], v[32:35]
    v_lshlrev_b32_e64 v130, 16, v137
    ds_read2_b32 a[234:235], v8 offset0:130 offset1:131
    v_mfma_f32_16x16x32_bf16 v[36:39], v[140:143], v[100:103], v[36:39]
    v_and_b32_e64 v131, s65, v137
    v_mfma_f32_16x16x32_bf16 v[40:43], v[140:143], v[104:107], v[40:43]
    s_waitcnt lgkmcnt(8)
    v_lshlrev_b32 v132, 16, v138
    v_and_b32_e64 v133, s65, v138
    v_mfma_f32_16x16x32_bf16 v[44:47], v[140:143], v[108:111], v[44:47]
    v_lshlrev_b32 v134, 16, v139
    v_and_b32 v135, s65, v139
    v_mfma_f32_16x16x32_bf16 v[44:47], a[236:239], v[112:115], v[44:47]
    v_mfma_f32_16x16x32_bf16 v[40:43], a[240:243], v[112:115], v[40:43]
    v_mfma_f32_16x16x32_bf16 v[44:47], a[240:243], v[116:119], v[44:47]
    v_mfma_f32_16x16x32_bf16 v[36:39], a[224:227], v[112:115], v[36:39]
    v_mfma_f32_16x16x32_bf16 v[40:43], a[224:227], v[116:119], v[40:43]
    v_mfma_f32_16x16x32_bf16 v[44:47], a[224:227], v[120:123], v[44:47]
    ds_read_b128 v[140:143], v10 offset:64
    v_mfma_f32_16x16x32_bf16 v[32:35], a[244:247], v[112:115], v[32:35]
    v_mfma_f32_16x16x32_bf16 v[36:39], a[244:247], v[116:119], v[36:39]
    v_mfma_f32_16x16x32_bf16 v[40:43], a[244:247], v[120:123], v[40:43]
    v_mfma_f32_16x16x32_bf16 v[44:47], a[244:247], v[124:127], v[44:47]
    s_waitcnt vmcnt(0)
    v_cmp_eq_u32 vcc, 0, v19
    s_waitcnt lgkmcnt(3)
    v_mfma_f32_16x16x32_bf16 v[60:63], a[244:247], a[228:231], 0
    s_cmp_eq_u32 s93, 1
    s_cbranch_scc1 L_x1_44
    s_nop 0
    ds_write_b128 v13, v[40:43] offset:2048
    ds_write_b128 v13, v[44:47] offset:3072
    v_pk_add_f32 v[128:129], v[128:129], v[32:33]
    v_pk_add_f32 v[130:131], v[130:131], v[34:35]
    v_pk_add_f32 v[132:133], v[132:133], v[36:37]
    v_pk_add_f32 v[134:135], v[134:135], v[38:39]
    s_branch L_xj_45
L_x1_44:
    ds_write_b128 v13, v[32:35] offset:2048
    ds_write_b128 v13, v[36:39] offset:3072
    v_pk_add_f32 v[128:129], v[128:129], v[40:41]
    v_pk_add_f32 v[130:131], v[130:131], v[42:43]
    v_pk_add_f32 v[132:133], v[132:133], v[44:45]
    v_pk_add_f32 v[134:135], v[134:135], v[46:47]
L_xj_45:
    ds_read2_b32 a[228:229], v9 offset0:16 offset1:17
    v_mfma_f32_16x16x32_bf16 v[56:59], a[244:247], a[248:251], 0
    s_cbranch_vccnz L_slow_46
L_ok_48:
    s_waitcnt lgkmcnt(1)
    s_barrier
    ds_read_b128 v[32:35], v14 offset:2048
    ds_read_b128 v[36:39], v14 offset:3072
    s_mov_b32 s66, 0x4a000
    ds_read2_b32 a[230:231], v9 offset0:18 offset1:19
    v_mfma_f32_16x16x32_bf16 v[60:63], a[224:227], a[248:251], v[60:63]
    s_add_u32 s69, s75, 0x1c2000
    ds_read2_b32 a[248:249], v9 offset0:144 offset1:145
    v_mfma_f32_16x16x32_bf16 v[52:55], a[244:247], a[252:255], 0
    buffer_load_dwordx4 v[20:23], v3, s[4:7], s66 offen offset:0 sc1
    ds_read2_b32 a[250:251], v9 offset0:146 offset1:147
    v_mfma_f32_16x16x32_bf16 v[56:59], a[224:227], a[252:255], v[56:59]
    buffer_load_dwordx2 v[28:29], v3, s[4:7], s69 offen offset:0 sc1
    ds_read_b128 v[44:47], v10 offset:576
    v_mfma_f32_16x16x32_bf16 v[60:63], a[240:243], a[252:255], v[60:63]
    buffer_load_dwordx4 v[24:27], v3, s[4:7], s66 offen offset:128 sc1
    buffer_load_dwordx2 v[30:31], v3, s[4:7], s69 offen offset:128 sc1
    s_waitcnt lgkmcnt(5)
    v_pk_add_f32 v[128:129], v[128:129], v[32:33]
    v_pk_add_f32 v[130:131], v[130:131], v[34:35]
    s_waitcnt lgkmcnt(4)
    v_pk_add_f32 v[132:133], v[132:133], v[36:37]
    v_pk_add_f32 v[134:135], v[134:135], v[38:39]
    v_cvt_pk_bf16_f32 v40, v128, v129
    v_cvt_pk_bf16_f32 v41, v130, v131
    v_cvt_pk_bf16_f32 v42, v132, v133
    v_cvt_pk_bf16_f32 v43, v134, v135
    s_mov_b32 s67, 0x5a0000
    buffer_store_dwordx4 v[40:43], v12, s[4:7], s67 offen sc1
    ds_read2_b32 a[252:253], v8 offset0:16 offset1:17
    v_mfma_f32_16x16x32_bf16 v[48:51], a[244:247], a[232:235], 0
    ds_read2_b32 a[254:255], v8 offset0:18 offset1:19
    v_mfma_f32_16x16x32_bf16 v[52:55], a[224:227], a[232:235], v[52:55]
    ds_read_b128 a[244:247], v10 offset:1088
    v_mfma_f32_16x16x32_bf16 v[56:59], a[240:243], a[232:235], v[56:59]
    v_mfma_f32_16x16x32_bf16 v[60:63], a[236:239], a[232:235], v[60:63]
    ds_read2_b32 a[232:233], v8 offset0:144 offset1:145
    v_mfma_f32_16x16x32_bf16 v[48:51], a[224:227], v[124:127], v[48:51]
    ds_read2_b32 a[234:235], v8 offset0:146 offset1:147
    v_mfma_f32_16x16x32_bf16 v[52:55], a[240:243], v[124:127], v[52:55]
    ds_read_b128 a[224:227], v10 offset:1600
    v_mfma_f32_16x16x32_bf16 v[56:59], a[236:239], v[124:127], v[56:59]
    v_mfma_f32_16x16x32_bf16 v[48:51], a[240:243], v[120:123], v[48:51]
    ds_read_b128 a[240:243], v10 offset:128
    v_mfma_f32_16x16x32_bf16 v[52:55], a[236:239], v[120:123], v[52:55]
    v_mfma_f32_16x16x32_bf16 v[48:51], a[236:239], v[116:119], v[48:51]
    ds_read2_b32 a[236:237], v9 offset0:32 offset1:33
    s_waitcnt lgkmcnt(6)
    v_mfma_f32_16x16x32_bf16 v[60:63], v[140:143], a[228:231], v[60:63]
    ds_read2_b32 a[238:239], v9 offset0:34 offset1:35
    v_mfma_f32_16x16x32_bf16 v[56:59], v[140:143], a[248:251], v[56:59]
    ds_read2_b32 a[228:229], v9 offset0:160 offset1:161
    v_mfma_f32_16x16x32_bf16 v[60:63], v[44:47], a[248:251], v[60:63]
    ds_read2_b32 a[230:231], v9 offset0:162 offset1:163
    v_mfma_f32_16x16x32_bf16 v[52:55], v[140:143], a[252:255], v[52:55]
    ds_read_b128 a[248:251], v10 offset:640
    v_mfma_f32_16x16x32_bf16 v[56:59], v[44:47], a[252:255], v[56:59]
    s_waitcnt lgkmcnt(7)
    v_mfma_f32_16x16x32_bf16 v[60:63], a[244:247], a[252:255], v[60:63]
    ds_read2_b32 a[252:253], v8 offset0:32 offset1:33
    v_mfma_f32_16x16x32_bf16 v[48:51], v[140:143], a[232:235], v[48:51]
    ds_read2_b32 a[254:255], v8 offset0:34 offset1:35
    v_mfma_f32_16x16x32_bf16 v[52:55], v[44:47], a[232:235], v[52:55]
    ds_read_b128 v[140:143], v10 offset:1152
    v_mfma_f32_16x16x32_bf16 v[56:59], a[244:247], a[232:235], v[56:59]
    s_waitcnt lgkmcnt(9)
    v_mfma_f32_16x16x32_bf16 v[60:63], a[224:227], a[232:235], v[60:63]
    ds_read2_b32 a[232:233], v8 offset0:160 offset1:161
    v_mfma_f32_16x16x32_bf16 v[48:51], v[44:47], v[108:111], v[48:51]
    ds_read2_b32 a[234:235], v8 offset0:162 offset1:163
    v_mfma_f32_16x16x32_bf16 v[52:55], a[244:247], v[108:111], v[52:55]
    ds_read_b128 v[44:47], v10 offset:1664
    v_mfma_f32_16x16x32_bf16 v[56:59], a[224:227], v[108:111], v[56:59]
    v_mfma_f32_16x16x32_bf16 v[48:51], a[244:247], v[104:107], v[48:51]
    ds_read_b128 a[244:247], v10 offset:192
    v_mfma_f32_16x16x32_bf16 v[52:55], a[224:227], v[104:107], v[52:55]
    v_mfma_f32_16x16x32_bf16 v[48:51], a[224:227], v[100:103], v[48:51]
    ds_read2_b32 a[224:225], v9 offset0:48 offset1:49
    s_waitcnt lgkmcnt(6)
    v_mfma_f32_16x16x32_bf16 v[60:63], a[240:243], a[236:239], v[60:63]
    ds_read2_b32 a[226:227], v9 offset0:50 offset1:51
    v_mfma_f32_16x16x32_bf16 v[56:59], a[240:243], a[228:231], v[56:59]
    ds_read2_b32 a[236:237], v9 offset0:176 offset1:177
    v_mfma_f32_16x16x32_bf16 v[60:63], a[248:251], a[228:231], v[60:63]
    ds_read2_b32 a[238:239], v9 offset0:178 offset1:179
    v_mfma_f32_16x16x32_bf16 v[52:55], a[240:243], a[252:255], v[52:55]
    ds_read_b128 a[228:231], v10 offset:704
    v_mfma_f32_16x16x32_bf16 v[56:59], a[248:251], a[252:255], v[56:59]
    s_waitcnt lgkmcnt(7)
    v_mfma_f32_16x16x32_bf16 v[60:63], v[140:143], a[252:255], v[60:63]
    ds_read2_b32 a[252:253], v8 offset0:48 offset1:49
    v_mfma_f32_16x16x32_bf16 v[48:51], a[240:243], a[232:235], v[48:51]
    ds_read2_b32 a[254:255], v8 offset0:50 offset1:51
    v_mfma_f32_16x16x32_bf16 v[52:55], a[248:251], a[232:235], v[52:55]
    ds_read_b128 a[240:243], v10 offset:1216
    v_mfma_f32_16x16x32_bf16 v[56:59], v[140:143], a[232:235], v[56:59]
    s_waitcnt lgkmcnt(9)
    v_mfma_f32_16x16x32_bf16 v[60:63], v[44:47], a[232:235], v[60:63]
    ds_read2_b32 a[232:233], v8 offset0:176 offset1:177
    v_mfma_f32_16x16x32_bf16 v[48:51], a[248:251], v[92:95], v[48:51]
    ds_read2_b32 a[234:235], v8 offset0:178 offset1:179
    v_mfma_f32_16x16x32_bf16 v[52:55], v[140:143], v[92:95], v[52:55]
    ds_read_b128 a[248:251], v10 offset:1728
    v_mfma_f32_16x16x32_bf16 v[56:59], v[44:47], v[92:95], v[56:59]
    v_mfma_f32_16x16x32_bf16 v[48:51], v[140:143], v[88:91], v[48:51]
    v_mfma_f32_16x16x32_bf16 v[52:55], v[44:47], v[88:91], v[52:55]
    v_mfma_f32_16x16x32_bf16 v[48:51], v[44:47], v[84:87], v[48:51]
    s_mov_b32 s82, 0x3b124925
    s_mov_b32 s83, 0x3727c5ac
    v_mov_b32 v136, s83
    s_waitcnt vmcnt(4)
    v_pk_mul_f32 v[20:21], v[20:21], s[82:83] op_sel_hi:[1,0]
    v_pk_fma_f32 v[22:23], v[22:23], s[82:83], v[136:137] op_sel_hi:[1,0,0]
    v_pk_fma_f32 v[22:23], v[20:21], v[20:21], v[22:23] neg_lo:[1,0,0] neg_hi:[1,0,0]
    v_max_f32 v22, s83, v22
    v_max_f32 v23, s83, v23
    v_rsq_f32 v22, v22
    v_rsq_f32 v23, v23
    s_waitcnt vmcnt(3)
    v_lshlrev_b32 v32, 16, v28
    v_and_b32 v34, s65, v28
    v_lshlrev_b32 v33, 16, v29
    v_and_b32_e64 v35, s65, v29
L_pg5:
    s_cbranch_execz L_ret1
    s_nop 0
    v_pk_mul_f32 v[20:21], v[20:21], v[22:23]
    v_pk_fma_f32 v[32:33], v[32:33], v[22:23], v[20:21] neg_lo:[0,0,1] neg_hi:[0,0,1]
    v_perm_b32 v40, v29, v28, s91
    v_pk_fma_f32 v[34:35], v[34:35], v[22:23], v[20:21] neg_lo:[0,0,1] neg_hi:[0,0,1]
    v_perm_b32 v42, v29, v28, s92
    v_cvt_pk_bf16_f32 v36, v32, v33
    v_cvt_pk_bf16_f32 v38, v34, v35
    s_waitcnt vmcnt(2)
    v_pk_mul_f32 v[24:25], v[24:25], s[82:83] op_sel_hi:[1,0]
    v_pk_fma_f32 v[26:27], v[26:27], s[82:83], v[136:137] op_sel_hi:[1,0,0]
    v_pk_fma_f32 v[26:27], v[24:25], v[24:25], v[26:27] neg_lo:[1,0,0] neg_hi:[1,0,0]
    v_max_f32 v26, s83, v26
    v_max_f32 v27, s83, v27
    v_rsq_f32 v26, v26
    v_rsq_f32 v27, v27
    s_waitcnt vmcnt(1)
    v_lshlrev_b32 v32, 16, v30
    v_and_b32 v34, s65, v30
    v_lshlrev_b32 v33, 16, v31
    v_and_b32 v35, s65, v31
    v_pk_mul_f32 v[24:25], v[24:25], v[26:27]
    v_pk_fma_f32 v[32:33], v[32:33], v[26:27], v[24:25] neg_lo:[0,0,1] neg_hi:[0,0,1]
    v_perm_b32 v41, v31, v30, s91
    v_pk_fma_f32 v[34:35], v[34:35], v[26:27], v[24:25] neg_lo:[0,0,1] neg_hi:[0,0,1]
    v_perm_b32 v43, v31, v30, s92
    v_cvt_pk_bf16_f32 v37, v32, v33
    v_cvt_pk_bf16_f32 v39, v34, v35
    s_waitcnt lgkmcnt(4)
    v_mfma_f32_16x16x32_bf16 v[60:63], a[244:247], a[224:227], v[60:63]
    ds_write_b64 v4, v[36:37] offset:2048
    ds_write_b64 v4, v[38:39] offset:6624
    v_mfma_f32_16x16x32_bf16 v[56:59], a[244:247], a[236:239], v[56:59]
    ds_write_b64 v5, v[40:41] offset:1024
    ds_write_b64 v5, v[42:43] offset:18944
    v_mfma_f32_16x16x32_bf16 v[60:63], a[228:231], a[236:239], v[60:63]
    v_mfma_f32_16x16x32_bf16 v[52:55], a[244:247], a[252:255], v[52:55]
    v_mfma_f32_16x16x32_bf16 v[56:59], a[228:231], a[252:255], v[56:59]
    s_waitcnt lgkmcnt(5)
    v_mfma_f32_16x16x32_bf16 v[60:63], a[240:243], a[252:255], v[60:63]
    s_waitcnt vmcnt(0)
    s_waitcnt lgkmcnt(0)
    s_barrier
    s_mov_b32 s66, 0x28000
    s_mov_b64 exec, 3
    buffer_store_dword v17, v15, s[4:7], s66 offen sc1
    s_mov_b64 exec, -1
    ds_read_b128 a[224:227], v10 offset:3776
    ds_read_b128 a[236:239], v10 offset:3264
    ds_read_b128 a[252:255], v10 offset:2752
    ds_read_b128 v[140:143], v10 offset:2240
    ds_read_b128 v[44:47], v10 offset:3712
    v_mfma_f32_16x16x32_bf16 v[48:51], a[244:247], a[232:235], v[48:51]
    ds_read_b128 a[244:247], v10 offset:3200
    v_mfma_f32_16x16x32_bf16 v[52:55], a[228:231], a[232:235], v[52:55]
    v_mfma_f32_16x16x32_bf16 v[56:59], a[240:243], a[232:235], v[56:59]
    v_mfma_f32_16x16x32_bf16 v[60:63], a[248:251], a[232:235], v[60:63]
    ds_read_b128 a[232:235], v10 offset:2688
    v_mfma_f32_16x16x32_bf16 v[48:51], a[228:231], v[76:79], v[48:51]
    v_mfma_f32_16x16x32_bf16 v[52:55], a[240:243], v[76:79], v[52:55]
    ds_read_b128 a[228:231], v10 offset:2176
    v_mfma_f32_16x16x32_bf16 v[56:59], a[248:251], v[76:79], v[56:59]
    v_mfma_f32_16x16x32_bf16 v[48:51], a[240:243], v[72:75], v[48:51]
    v_mfma_f32_16x16x32_bf16 v[52:55], a[248:251], v[72:75], v[52:55]
    v_mfma_f32_16x16x32_bf16 v[48:51], a[248:251], v[68:71], v[48:51]
    ds_read_b128 a[240:243], v10 offset:3648
    s_waitcnt lgkmcnt(6)
    v_mfma_f32_16x16x32_bf16 v[60:63], a[224:227], v[64:67], v[60:63]
    ds_read_b128 a[224:227], v10 offset:3136
    v_mfma_f32_16x16x32_bf16 v[56:59], a[236:239], v[64:67], v[56:59]
    v_mfma_f32_16x16x32_bf16 v[60:63], a[236:239], v[68:71], v[60:63]
    ds_read_b128 a[236:239], v10 offset:2624
    v_mfma_f32_16x16x32_bf16 v[52:55], a[252:255], v[64:67], v[52:55]
    v_mfma_f32_16x16x32_bf16 v[56:59], a[252:255], v[68:71], v[56:59]
    v_mfma_f32_16x16x32_bf16 v[60:63], a[252:255], v[72:75], v[60:63]
    ds_read_b128 a[248:251], v10 offset:2112
    s_waitcnt lgkmcnt(8)
    v_mfma_f32_16x16x32_bf16 v[48:51], v[140:143], v[64:67], v[48:51]
    v_mfma_f32_16x16x32_bf16 v[52:55], v[140:143], v[68:71], v[52:55]
    v_mfma_f32_16x16x32_bf16 v[56:59], v[140:143], v[72:75], v[56:59]
    v_mfma_f32_16x16x32_bf16 v[60:63], v[140:143], v[76:79], v[60:63]
    ds_read_b128 a[252:255], v10 offset:3584
    s_waitcnt lgkmcnt(6)
    v_mfma_f32_16x16x32_bf16 v[60:63], v[44:47], v[80:83], v[60:63]
    ds_read_b128 v[140:143], v10 offset:3072
    v_mfma_f32_16x16x32_bf16 v[56:59], a[244:247], v[80:83], v[56:59]
    v_mfma_f32_16x16x32_bf16 v[60:63], a[244:247], v[84:87], v[60:63]
    ds_read_b128 a[244:247], v10 offset:2560
    v_mfma_f32_16x16x32_bf16 v[52:55], a[232:235], v[80:83], v[52:55]
    v_mfma_f32_16x16x32_bf16 v[56:59], a[232:235], v[84:87], v[56:59]
    v_mfma_f32_16x16x32_bf16 v[60:63], a[232:235], v[88:91], v[60:63]
    ds_read_b128 a[232:235], v10 offset:2048
    s_waitcnt lgkmcnt(8)
    v_mfma_f32_16x16x32_bf16 v[48:51], a[228:231], v[80:83], v[48:51]
    v_mfma_f32_16x16x32_bf16 v[52:55], a[228:231], v[84:87], v[52:55]
    v_mfma_f32_16x16x32_bf16 v[56:59], a[228:231], v[88:91], v[56:59]
    ds_read_b64_tr_b16 v[136:137], v11 offset:1024
    ds_read_b64_tr_b16 v[138:139], v11 offset:1536
    v_mfma_f32_16x16x32_bf16 v[60:63], a[228:231], v[92:95], v[60:63]
    s_waitcnt lgkmcnt(7)
    v_mfma_f32_16x16x32_bf16 v[60:63], a[240:243], v[96:99], v[60:63]
    v_mfma_f32_16x16x32_bf16 v[56:59], a[224:227], v[96:99], v[56:59]
    v_mfma_f32_16x16x32_bf16 v[60:63], a[224:227], v[100:103], v[60:63]
    s_waitcnt lgkmcnt(1)
    v_lshlrev_b32 v128, 16, v136
    v_and_b32_e64 v129, s65, v136
    v_mfma_f32_16x16x32_bf16 v[52:55], a[236:239], v[96:99], v[52:55]
    v_lshlrev_b32 v130, 16, v137
    v_and_b32 v131, s65, v137
    v_mfma_f32_16x16x32_bf16 v[56:59], a[236:239], v[100:103], v[56:59]
    s_waitcnt lgkmcnt(0)
    v_lshlrev_b32 v132, 16, v138
    v_and_b32_e64 v133, s65, v138
    v_mfma_f32_16x16x32_bf16 v[60:63], a[236:239], v[104:107], v[60:63]
    v_lshlrev_b32 v134, 16, v139
    v_and_b32 v135, s65, v139
    v_mfma_f32_16x16x32_bf16 v[48:51], a[248:251], v[96:99], v[48:51]
    v_mfma_f32_16x16x32_bf16 v[52:55], a[248:251], v[100:103], v[52:55]
    v_mfma_f32_16x16x32_bf16 v[56:59], a[248:251], v[104:107], v[56:59]
    v_mfma_f32_16x16x32_bf16 v[60:63], a[248:251], v[108:111], v[60:63]
    v_mfma_f32_16x16x32_bf16 v[60:63], a[252:255], v[112:115], v[60:63]
    v_mfma_f32_16x16x32_bf16 v[56:59], v[140:143], v[112:115], v[56:59]
    v_mfma_f32_16x16x32_bf16 v[60:63], v[140:143], v[116:119], v[60:63]
    v_mfma_f32_16x16x32_bf16 v[52:55], a[244:247], v[112:115], v[52:55]
    v_mfma_f32_16x16x32_bf16 v[56:59], a[244:247], v[116:119], v[56:59]
    s_add_u32 s97, s74, 0x28000
    buffer_load_dword v19, v16, s[4:7], s97 offen offset:0 sc1
    v_mfma_f32_16x16x32_bf16 v[60:63], a[244:247], v[120:123], v[60:63]
    v_mfma_f32_16x16x32_bf16 v[48:51], a[232:235], v[112:115], v[48:51]
    v_mfma_f32_16x16x32_bf16 v[52:55], a[232:235], v[116:119], v[52:55]
    v_mfma_f32_16x16x32_bf16 v[56:59], a[232:235], v[120:123], v[56:59]
    v_mfma_f32_16x16x32_bf16 v[60:63], a[232:235], v[124:127], v[60:63]
    s_cmp_eq_u32 s93, 1
    s_cbranch_scc1 L_x1_49
    s_nop 4
    s_nop 0
    ds_write_b128 v13, v[56:59] offset:2048
    ds_write_b128 v13, v[60:63] offset:3072
    v_pk_add_f32 v[128:129], v[128:129], v[48:49]
    v_pk_add_f32 v[130:131], v[130:131], v[50:51]
    v_pk_add_f32 v[132:133], v[132:133], v[52:53]
    v_pk_add_f32 v[134:135], v[134:135], v[54:55]
    s_branch L_xj_50
L_x1_49:
    s_nop 3
    ds_write_b128 v13, v[48:51] offset:2048
    ds_write_b128 v13, v[52:55] offset:3072
    v_pk_add_f32 v[128:129], v[128:129], v[56:57]
    v_pk_add_f32 v[130:131], v[130:131], v[58:59]
    v_pk_add_f32 v[132:133], v[132:133], v[60:61]
    v_pk_add_f32 v[134:135], v[134:135], v[62:63]
L_xj_50:
    s_waitcnt lgkmcnt(0)
    s_barrier
    ds_read_b128 v[32:35], v14 offset:2048
    ds_read_b128 v[36:39], v14 offset:3072
    s_waitcnt lgkmcnt(1)
    v_pk_add_f32 v[128:129], v[128:129], v[32:33]
    v_pk_add_f32 v[130:131], v[130:131], v[34:35]
    s_waitcnt lgkmcnt(0)
    v_pk_add_f32 v[132:133], v[132:133], v[36:37]
    v_pk_add_f32 v[134:135], v[134:135], v[38:39]
    v_cvt_pk_bf16_f32 v40, v128, v129
    v_cvt_pk_bf16_f32 v41, v130, v131
    v_cvt_pk_bf16_f32 v42, v132, v133
    v_cvt_pk_bf16_f32 v43, v134, v135
    s_mov_b32 s67, 0x5ae000
    buffer_store_dwordx4 v[40:43], v12, s[4:7], s67 offen sc1
    s_waitcnt vmcnt(1)
    v_cmp_eq_u32 vcc, 0, v19
    s_cbranch_vccnz L_slow_51
L_ok_53:
    s_waitcnt lgkmcnt(0)
    s_barrier
    s_add_u32 s77, s77, 0x1c0000
    v_add_u32 v112, s77, v2
    s_lshl_b32 s66, s3, 10
    s_mov_b32 m0, s66
    s_nop 0
    buffer_load_dwordx4 v112, s[4:7], m0 offen sc1 lds
    s_add_u32 m0, m0, 4096
    s_nop 0
    buffer_load_dwordx4 v112, s[4:7], m0 offen sc1 lds
    s_add_u32 m0, m0, 4096
    v_lshrrev_b32_e64 v120, 4, v1
    v_bfe_u32 v121, v1, 2, 2
    v_and_b32 v122, 3, v1
    v_lshrrev_b32 v116, 5, v1
    v_bfe_u32 v117, v1, 4, 1
    v_bfe_u32 v118, v1, 3, 1
    v_lshlrev_b32_e64 v119, 7, v121
    v_lshl_add_u32 v119, v118, 6, v119
    v_lshl_add_u32 v20, v116, 10, v119
    v_lshl_add_u32 v20, v122, 4, v20
    v_lshl_add_u32 v20, v117, 3, v20
    buffer_load_dwordx4 v112, s[4:7], m0 offen sc1 lds
    s_add_u32 m0, m0, 4096
    v_xor_b32 v21, 64, v20
    s_lshl_b32 s68, s61, 6
    v_xor_b32 v119, s68, v119
    s_lshl_b32 s68, s93, 5
    s_lshl3_add_u32 s68, s94, s68
    v_and_b32 v116, 16, v2
    v_add3_u32 v119, v119, v116, s68
    v_bfe_u32 v116, v1, 1, 1
    v_mul_u32_u24 v22, 57376, v116
    v_lshl_add_u32 v22, v120, 10, v22
    v_add_u32_e64 v22, v22, v119
    buffer_load_dwordx4 v112, s[4:7], m0 offen sc1 lds
    s_add_u32 m0, m0, 4096
    v_lshl_add_u32 v116, v120, 1, v116
    v_lshl_add_u32 v23, v116, 10, v119
    s_lshl_b32 s68, s62, 13
    v_add_u32 v23, s68, v23
    s_mul_i32 s68, s3, 9216
    v_add_u32 v24, s68, v2
    v_and_b32 v116, 7, v1
    v_lshrrev_b32 v118, 3, v1
    v_lshlrev_b32 v117, 4, v118
    v_lshl_add_u32 v27, v116, 3, v118
    v_lshlrev_b32_e64 v27, 2, v27
    buffer_load_dwordx4 v112, s[4:7], m0 offen sc1 lds
    s_add_u32 m0, m0, 4096
    v_mul_u32_u24 v25, 1088, v116
    s_lshl_b32 s68, s3, 7
    v_add3_u32 v25, v25, v117, s68
    s_and_b32 s68, s59, 8
    s_bfe_u32 s69, s59, 0x20001
    s_add_u32 s68, s68, s69
    s_lshl2_add_u32 s68, s94, s68
    s_lshl1_add_u32 s69, s61, s93
    s_and_b32 s70, s59, 1
    v_and_b32 v118, 0x30, v117
    v_lshrrev_b32 v119, 5, v1
    buffer_load_dwordx4 v112, s[4:7], m0 offen sc1 lds
    s_add_u32 m0, m0, 4096
    s_lshl3_add_u32 s68, s68, s70
    s_lshl2_add_u32 s68, s68, s69
    s_lshl_b32 s68, s68, 1
    v_add3_u32 v118, v118, v119, s68
    v_mul_u32_u24 v26, 896, v118
    v_lshl_add_u32 v26, v116, 4, v26
    s_lshl_b32 s68, s62, 7
    v_add_u32 v26, s68, v26
    v_min_u32 v116, 13, v1
    s_mul_i32 s68, s3, 14
    v_add_lshl_u32 v28, v116, s68, 5
    buffer_load_dwordx4 v112, s[4:7], m0 offen sc1 lds
    s_add_u32 m0, m0, 4096
    s_lshl2_add_u32 s69, s60, s3
    s_lshl_b32 s68, s69, 5
    v_mov_b32 v29, s68
    s_mul_i32 s68, s59, 458752
    s_add_u32 s68, s68, 0xe60000
    s_lshl_b32 s69, s69, 11
    s_add_u32 s79, s68, s69
    s_lshl2_add_u32 s69, s61, s3
    s_mul_i32 s69, s69, 28672
    s_add_u32 s78, s68, s69
    s_lshl_b32 s80, s59, 11
    s_waitcnt vmcnt(7)
    s_barrier
    s_mov_b32 s66, 0x30000
    s_mov_b64 exec, 3
    buffer_store_dword v17, v15, s[4:7], s66 offen sc1
    s_mov_b64 exec, -1
    s_nop 0
    buffer_load_dwordx4 v112, s[4:7], m0 offen sc1 lds
    s_add_u32 m0, m0, 4096
    s_add_u32 s80, s80, 0x38008
    s_add_u32 s98, s80, 32768
    s_mov_b32 s8, s52
    s_nop 0
    s_and_b32 s9, s53, 0xffff
    s_mov_b32 s10, 0x1c0000
    s_mov_b32 s11, 0x20000
    buffer_load_dwordx4 v112, s[4:7], m0 offen sc1 lds
    s_add_u32 m0, m0, 4096
    s_nop 0
    buffer_load_dwordx4 v112, s[4:7], m0 offen sc1 lds
    s_add_u32 m0, m0, 4096
    s_nop 0
    buffer_load_dwordx4 v112, s[4:7], m0 offen sc1 lds
    s_add_u32 m0, m0, 4096
    s_waitcnt vmcnt(10)
    s_barrier
    ds_read_b64_tr_b16 a[224:225], v20 offset:0
    ds_read_b64_tr_b16 a[226:227], v20 offset:512
    ds_read_b64_tr_b16 a[228:229], v21 offset:0
    ds_read_b64_tr_b16 a[230:231], v21 offset:512
    ds_read_b64_tr_b16 a[232:233], v20 offset:2048
    ds_read_b64_tr_b16 a[234:235], v20 offset:2560
    ds_read_b64_tr_b16 a[236:237], v21 offset:2048
    ds_read_b64_tr_b16 a[238:239], v21 offset:2560
    ds_read_b64_tr_b16 a[240:241], v20 offset:4096
    ds_read_b64_tr_b16 a[242:243], v20 offset:4608
    ds_read_b64_tr_b16 a[244:245], v21 offset:4096
    ds_read_b64_tr_b16 a[246:247], v21 offset:4608
    ds_read_b64_tr_b16 a[248:249], v20 offset:6144
    ds_read_b64_tr_b16 a[250:251], v20 offset:6656
    s_waitcnt lgkmcnt(12)
    v_mfma_f32_32x32x16_bf16 v[32:47], v[144:147], a[224:227], 0
    buffer_load_dwordx4 v112, s[4:7], m0 offen sc1 lds
    s_add_u32 m0, m0, 4096
    v_add_u32 v113, 57376, v20
    v_add_u32 v114, 57376, v21
    s_waitcnt lgkmcnt(8)
    v_mfma_f32_32x32x16_bf16 v[48:63], v[144:147], a[228:231], 0
    buffer_load_dwordx4 v112, s[4:7], m0 offen sc1 lds
    s_add_u32 m0, m0, 4096
    ds_read_b64_tr_b16 a[252:253], v21 offset:6144
    ds_read_b64_tr_b16 a[254:255], v21 offset:6656
    v_mfma_f32_32x32x16_bf16 v[32:47], v[148:151], a[232:235], v[32:47]
    buffer_load_dwordx4 v112, s[4:7], m0 offen sc1 lds
    v_subrev_u32_e64 v112, 32, v112
    s_add_u32 m0, m0, 4128
    s_waitcnt vmcnt(10)
    s_barrier
    ds_read_b64_tr_b16 a[224:225], v20 offset:8192
    ds_read_b64_tr_b16 a[226:227], v20 offset:8704
    s_waitcnt lgkmcnt(8)
    v_mfma_f32_32x32x16_bf16 v[48:63], v[148:151], a[236:239], v[48:63]
    ds_read_b64_tr_b16 a[228:229], v21 offset:8192
    ds_read_b64_tr_b16 a[230:231], v21 offset:8704
    ds_read_b64_tr_b16 a[232:233], v20 offset:10240
    ds_read_b64_tr_b16 a[234:235], v20 offset:10752
    v_mfma_f32_32x32x16_bf16 v[32:47], v[152:155], a[240:243], v[32:47]
    ds_read_b64_tr_b16 a[236:237], v21 offset:10240
    ds_read_b64_tr_b16 a[238:239], v21 offset:10752
    s_waitcnt lgkmcnt(10)
    v_mfma_f32_32x32x16_bf16 v[48:63], v[152:155], a[244:247], v[48:63]
    ds_read_b64_tr_b16 a[240:241], v20 offset:12288
    ds_read_b64_tr_b16 a[242:243], v20 offset:12800
    v_mfma_f32_32x32x16_bf16 v[32:47], v[156:159], a[248:251], v[32:47]
    ds_read_b64_tr_b16 a[244:245], v21 offset:12288
    ds_read_b64_tr_b16 a[246:247], v21 offset:12800
    s_waitcnt lgkmcnt(10)
    v_mfma_f32_32x32x16_bf16 v[48:63], v[156:159], a[252:255], v[48:63]
    ds_read_b64_tr_b16 a[248:249], v20 offset:14336
    ds_read_b64_tr_b16 a[250:251], v20 offset:14848
    v_mfma_f32_32x32x16_bf16 v[32:47], v[160:163], a[224:227], v[32:47]
    ds_read_b64_tr_b16 a[252:253], v21 offset:14336
    ds_read_b64_tr_b16 a[254:255], v21 offset:14848
    s_waitcnt lgkmcnt(10)
    v_mfma_f32_32x32x16_bf16 v[48:63], v[160:163], a[228:231], v[48:63]
    ds_read_b64_tr_b16 a[224:225], v20 offset:16384
    ds_read_b64_tr_b16 a[226:227], v20 offset:16896
    v_mfma_f32_32x32x16_bf16 v[32:47], v[164:167], a[232:235], v[32:47]
    ds_read_b64_tr_b16 a[228:229], v21 offset:16384
    ds_read_b64_tr_b16 a[230:231], v21 offset:16896
    s_waitcnt lgkmcnt(10)
    v_mfma_f32_32x32x16_bf16 v[48:63], v[164:167], a[236:239], v[48:63]
    s_add_u32 s97, s74, 0x30000
    buffer_load_dword v19, v16, s[4:7], s97 offen offset:0 sc1
    ds_read_b64_tr_b16 a[232:233], v20 offset:18432
    ds_read_b64_tr_b16 a[234:235], v20 offset:18944
    v_mfma_f32_32x32x16_bf16 v[32:47], v[168:171], a[240:243], v[32:47]
    ds_read_b64_tr_b16 a[236:237], v21 offset:18432
    ds_read_b64_tr_b16 a[238:239], v21 offset:18944
    s_waitcnt lgkmcnt(10)
    v_mfma_f32_32x32x16_bf16 v[48:63], v[168:171], a[244:247], v[48:63]
    s_waitcnt vmcnt(6)
    s_barrier
    ds_read_b64_tr_b16 a[240:241], v20 offset:20480
    ds_read_b64_tr_b16 a[242:243], v20 offset:20992
    v_mfma_f32_32x32x16_bf16 v[32:47], v[172:175], a[248:251], v[32:47]
    ds_read_b64_tr_b16 a[244:245], v21 offset:20480
    ds_read_b64_tr_b16 a[246:247], v21 offset:20992
    s_waitcnt lgkmcnt(10)
    v_mfma_f32_32x32x16_bf16 v[48:63], v[172:175], a[252:255], v[48:63]
    ds_read_b64_tr_b16 a[248:249], v20 offset:22528
    ds_read_b64_tr_b16 a[250:251], v20 offset:23040
    v_mfma_f32_32x32x16_bf16 v[32:47], v[176:179], a[224:227], v[32:47]
    ds_read_b64_tr_b16 a[252:253], v21 offset:22528
    ds_read_b64_tr_b16 a[254:255], v21 offset:23040
    s_waitcnt lgkmcnt(10)
    v_mfma_f32_32x32x16_bf16 v[48:63], v[176:179], a[228:231], v[48:63]
    ds_read_b64_tr_b16 a[224:225], v20 offset:24576
    ds_read_b64_tr_b16 a[226:227], v20 offset:25088
    v_mfma_f32_32x32x16_bf16 v[32:47], v[180:183], a[232:235], v[32:47]
    ds_read_b64_tr_b16 a[228:229], v21 offset:24576
    ds_read_b64_tr_b16 a[230:231], v21 offset:25088
    s_waitcnt lgkmcnt(10)
    v_mfma_f32_32x32x16_bf16 v[48:63], v[180:183], a[236:239], v[48:63]
    ds_read_b64_tr_b16 a[232:233], v20 offset:26624
    ds_read_b64_tr_b16 a[234:235], v20 offset:27136
    v_mfma_f32_32x32x16_bf16 v[32:47], v[184:187], a[240:243], v[32:47]
    ds_read_b64_tr_b16 a[236:237], v21 offset:26624
    ds_read_b64_tr_b16 a[238:239], v21 offset:27136
    s_waitcnt lgkmcnt(10)
    v_mfma_f32_32x32x16_bf16 v[48:63], v[184:187], a[244:247], v[48:63]
    ds_read_b64_tr_b16 a[240:241], v20 offset:28672
    ds_read_b64_tr_b16 a[242:243], v20 offset:29184
    v_mfma_f32_32x32x16_bf16 v[32:47], v[188:191], a[248:251], v[32:47]
    ds_read_b64_tr_b16 a[244:245], v21 offset:28672
    ds_read_b64_tr_b16 a[246:247], v21 offset:29184
    s_waitcnt lgkmcnt(10)
    v_mfma_f32_32x32x16_bf16 v[48:63], v[188:191], a[252:255], v[48:63]
    ds_read_b64_tr_b16 a[248:249], v20 offset:30720
    ds_read_b64_tr_b16 a[250:251], v20 offset:31232
    v_mfma_f32_32x32x16_bf16 v[32:47], v[192:195], a[224:227], v[32:47]
    ds_read_b64_tr_b16 a[252:253], v21 offset:30720
    ds_read_b64_tr_b16 a[254:255], v21 offset:31232
    s_waitcnt lgkmcnt(10)
    v_mfma_f32_32x32x16_bf16 v[48:63], v[192:195], a[228:231], v[48:63]
    ds_read_b64_tr_b16 a[224:225], v20 offset:32768
    ds_read_b64_tr_b16 a[226:227], v20 offset:33280
    v_mfma_f32_32x32x16_bf16 v[32:47], v[196:199], a[232:235], v[32:47]
    ds_read_b64_tr_b16 a[228:229], v21 offset:32768
    ds_read_b64_tr_b16 a[230:231], v21 offset:33280
    s_waitcnt lgkmcnt(10)
    v_mfma_f32_32x32x16_bf16 v[48:63], v[196:199], a[236:239], v[48:63]
    ds_read_b64_tr_b16 a[232:233], v20 offset:34816
    ds_read_b64_tr_b16 a[234:235], v20 offset:35328
    v_mfma_f32_32x32x16_bf16 v[32:47], v[200:203], a[240:243], v[32:47]
    ds_read_b64_tr_b16 a[236:237], v21 offset:34816
    ds_read_b64_tr_b16 a[238:239], v21 offset:35328
    s_waitcnt lgkmcnt(10)
    v_mfma_f32_32x32x16_bf16 v[48:63], v[200:203], a[244:247], v[48:63]
    s_waitcnt vmcnt(0)
    v_cmp_eq_u32 vcc, 0, v19
    v_mfma_f32_32x32x16_bf16 v[32:47], v[204:207], a[248:251], v[32:47]
    s_cbranch_vccnz L_slow_54
L_ok_56:
    s_barrier
    s_waitcnt lgkmcnt(6)
    v_mfma_f32_32x32x16_bf16 v[48:63], v[204:207], a[252:255], v[48:63]
    buffer_load_dwordx4 v112, s[4:7], m0 offen sc1 lds
    s_add_u32 m0, m0, 4096
    ds_read_b64_tr_b16 a[240:241], v20 offset:36864
    ds_read_b64_tr_b16 a[242:243], v20 offset:37376
    v_mfma_f32_32x32x16_bf16 v[32:47], v[208:211], a[224:227], v[32:47]
    buffer_load_dwordx4 v112, s[4:7], m0 offen sc1 lds
    s_add_u32 m0, m0, 4096
    ds_read_b64_tr_b16 a[244:245], v20 offset:38912
    ds_read_b64_tr_b16 a[246:247], v20 offset:39424
    s_waitcnt lgkmcnt(6)
    v_mfma_f32_32x32x16_bf16 v[48:63], v[208:211], a[228:231], v[48:63]
    buffer_load_dwordx4 v112, s[4:7], m0 offen sc1 lds
    s_add_u32 m0, m0, 4096
    ds_read_b64_tr_b16 a[248:249], v20 offset:40960
    ds_read_b64_tr_b16 a[250:251], v20 offset:41472
    v_mfma_f32_32x32x16_bf16 v[32:47], v[212:215], a[232:235], v[32:47]
    buffer_load_dwordx4 v112, s[4:7], m0 offen sc1 lds
    s_add_u32 m0, m0, 4096
    ds_read_b64_tr_b16 a[252:253], v20 offset:43008
    ds_read_b64_tr_b16 a[254:255], v20 offset:43520
    s_waitcnt lgkmcnt(6)
    v_mfma_f32_32x32x16_bf16 v[48:63], v[212:215], a[236:239], v[48:63]
    ds_read_b64_tr_b16 a[224:225], v20 offset:45056
    ds_read_b64_tr_b16 a[226:227], v20 offset:45568
    ds_read_b64_tr_b16 a[228:229], v20 offset:47104
    ds_read_b64_tr_b16 a[230:231], v20 offset:47616
    ds_read_b64_tr_b16 a[232:233], v20 offset:49152
    ds_read_b64_tr_b16 a[234:235], v20 offset:49664
    v_mfma_f32_32x32x16_bf16 v[32:47], v[216:219], a[240:243], v[32:47]
    buffer_load_dwordx4 v112, s[4:7], m0 offen sc1 lds
    s_add_u32 m0, m0, 4096
    ds_read_b64_tr_b16 a[236:237], v20 offset:51200
    ds_read_b64_tr_b16 a[238:239], v20 offset:51712
    s_waitcnt lgkmcnt(10)
    v_mfma_f32_32x32x16_bf16 v[32:47], v[220:223], a[244:247], v[32:47]
    ds_read_b64_tr_b16 a[240:241], v20 offset:53248
    ds_read_b64_tr_b16 a[242:243], v20 offset:53760
    v_mfma_f32_32x32x16_bf16 v[32:47], v[224:227], a[248:251], v[32:47]
    buffer_load_dwordx4 v112, s[4:7], m0 offen sc1 lds
    s_add_u32 m0, m0, 4096
    ds_read_b64_tr_b16 a[244:245], v20 offset:55296
    ds_read_b64_tr_b16 a[246:247], v20 offset:55808
    s_waitcnt lgkmcnt(10)
    v_mfma_f32_32x32x16_bf16 v[32:47], v[228:231], a[252:255], v[32:47]
    ds_read_b64_tr_b16 a[248:249], v21 offset:36864
    ds_read_b64_tr_b16 a[250:251], v21 offset:37376
    v_mfma_f32_32x32x16_bf16 v[32:47], v[232:235], a[224:227], v[32:47]
    buffer_load_dwordx4 v112, s[4:7], m0 offen sc1 lds
    s_add_u32 m0, m0, 4096
    ds_read_b64_tr_b16 a[252:253], v21 offset:38912
    ds_read_b64_tr_b16 a[254:255], v21 offset:39424
    s_waitcnt lgkmcnt(10)
    v_mfma_f32_32x32x16_bf16 v[32:47], v[236:239], a[228:231], v[32:47]
    ds_read_b64_tr_b16 a[224:225], v21 offset:40960
    ds_read_b64_tr_b16 a[226:227], v21 offset:41472
    v_mfma_f32_32x32x16_bf16 v[32:47], v[240:243], a[232:235], v[32:47]
    buffer_load_dwordx4 v112, s[4:7], m0 offen sc1 lds
    s_add_u32 m0, m0, 4096
    ds_read_b64_tr_b16 a[228:229], v21 offset:43008
    ds_read_b64_tr_b16 a[230:231], v21 offset:43520
    s_waitcnt lgkmcnt(10)
    v_mfma_f32_32x32x16_bf16 v[32:47], v[244:247], a[236:239], v[32:47]
    ds_read_b64_tr_b16 a[232:233], v21 offset:45056
    ds_read_b64_tr_b16 a[234:235], v21 offset:45568
    v_mfma_f32_32x32x16_bf16 v[32:47], v[248:251], a[240:243], v[32:47]
    buffer_load_dwordx4 v112, s[4:7], m0 offen sc1 lds
    s_add_u32 m0, m0, 4096
    ds_read_b64_tr_b16 a[236:237], v21 offset:47104
    ds_read_b64_tr_b16 a[238:239], v21 offset:47616
    s_waitcnt lgkmcnt(10)
    v_mfma_f32_32x32x16_bf16 v[32:47], v[252:255], a[244:247], v[32:47]
    ds_read_b64_tr_b16 a[240:241], v21 offset:49152
    ds_read_b64_tr_b16 a[242:243], v21 offset:49664
    v_mfma_f32_32x32x16_bf16 v[48:63], v[216:219], a[248:251], v[48:63]
    buffer_load_dwordx4 v112, s[4:7], m0 offen sc1 lds
    s_add_u32 m0, m0, 4096
    ds_read_b64_tr_b16 a[244:245], v21 offset:51200
    ds_read_b64_tr_b16 a[246:247], v21 offset:51712
    s_waitcnt lgkmcnt(10)
    v_mfma_f32_32x32x16_bf16 v[48:63], v[220:223], a[252:255], v[48:63]
    ds_read_b64_tr_b16 a[248:249], v21 offset:53248
    ds_read_b64_tr_b16 a[250:251], v21 offset:53760
    v_mfma_f32_32x32x16_bf16 v[48:63], v[224:227], a[224:227], v[48:63]
    buffer_load_dwordx4 v112, s[4:7], m0 offen sc1 lds
    s_add_u32 m0, m0, 4096
    v_cvt_pk_bf16_f32 v96, v32, v33
    v_cvt_pk_bf16_f32 v97, v34, v35
    s_waitcnt lgkmcnt(8)
    v_mfma_f32_32x32x16_bf16 v[48:63], v[228:231], a[228:231], v[48:63]
    ds_read_b64_tr_b16 a[252:253], v21 offset:55296
    ds_read_b64_tr_b16 a[254:255], v21 offset:55808
    v_cvt_pk_bf16_f32 v98, v36, v37
    v_cvt_pk_bf16_f32 v99, v38, v39
    v_pk_max_i16 v96, v96, 0
    v_pk_max_i16 v97, v97, 0
    v_pk_max_i16 v98, v98, 0
    v_mfma_f32_32x32x16_bf16 v[48:63], v[232:235], a[232:235], v[48:63]
    buffer_load_dwordx4 v112, s[4:7], m0 offen sc1 lds
    s_add_u32 m0, m0, 4096
    v_pk_max_i16 v99, v99, 0
    s_add_u32 s67, s79, 0
    s_waitcnt lgkmcnt(6)
    v_mfma_f32_32x32x16_bf16 v[48:63], v[236:239], a[236:239], v[48:63]
    buffer_store_dwordx4 v[96:99], v2, s[4:7], s67 offen offset:0 sc1
    v_cvt_pk_bf16_f32 v100, v40, v41
    v_mfma_f32_32x32x16_bf16 v[48:63], v[240:243], a[240:243], v[48:63]
    s_waitcnt vmcnt(11)
    s_barrier
    ds_read_b64_tr_b16 a[224:225], v113 offset:0
    ds_read_b64_tr_b16 a[226:227], v113 offset:512
    v_cvt_pk_bf16_f32 v101, v42, v43
    s_waitcnt lgkmcnt(4)
    v_mfma_f32_32x32x16_bf16 v[48:63], v[244:247], a[244:247], v[48:63]
    ds_read_b64_tr_b16 a[228:229], v114 offset:0
    ds_read_b64_tr_b16 a[230:231], v114 offset:512
    buffer_load_dwordx4 v112, s[4:7], m0 offen sc1 lds
    s_add_u32 m0, m0, 4096
    v_cvt_pk_bf16_f32 v102, v44, v45
    v_mfma_f32_32x32x16_bf16 v[48:63], v[248:251], a[248:251], v[48:63]
    ds_read_b64_tr_b16 a[232:233], v113 offset:2048
    ds_read_b64_tr_b16 a[234:235], v113 offset:2560
    buffer_load_dwordx4 v112, s[4:7], m0 offen sc1 lds
    s_waitcnt lgkmcnt(6)
    v_mfma_f32_32x32x16_bf16 v[48:63], v[252:255], a[252:255], v[48:63]
    ds_read_b64_tr_b16 a[236:237], v114 offset:2048
    ds_read_b64_tr_b16 a[238:239], v114 offset:2560
    ds_read_b64_tr_b16 a[240:241], v113 offset:4096
    ds_read_b64_tr_b16 a[242:243], v113 offset:4608
    ds_read_b64_tr_b16 a[244:245], v114 offset:4096
    ds_read_b64_tr_b16 a[246:247], v114 offset:4608
    s_waitcnt lgkmcnt(10)
    v_mfma_f32_32x32x16_bf16 v[64:79], v[144:147], a[224:227], 0
    ds_read_b64_tr_b16 a[248:249], v113 offset:6144
    ds_read_b64_tr_b16 a[250:251], v113 offset:6656
    v_cvt_pk_bf16_f32 v103, v46, v47
    v_pk_max_i16 v100, v100, 0
    v_pk_max_i16 v101, v101, 0
    v_pk_max_i16 v102, v102, 0
    s_waitcnt lgkmcnt(10)
    v_mfma_f32_32x32x16_bf16 v[80:95], v[144:147], a[228:231], 0
    ds_read_b64_tr_b16 a[252:253], v114 offset:6144
    ds_read_b64_tr_b16 a[254:255], v114 offset:6656
    v_pk_max_i16 v103, v103, 0
    s_waitcnt vmcnt(10)
    s_barrier
    ds_read_b64_tr_b16 a[224:225], v113 offset:8192
    ds_read_b64_tr_b16 a[226:227], v113 offset:8704
    s_waitcnt lgkmcnt(12)
    v_mfma_f32_32x32x16_bf16 v[64:79], v[148:151], a[232:235], v[64:79]
    buffer_store_dwordx4 v[100:103], v2, s[4:7], s67 offen offset:1024 sc1
    s_waitcnt lgkmcnt(8)
    v_mfma_f32_32x32x16_bf16 v[80:95], v[148:151], a[236:239], v[80:95]
    ds_read_b64_tr_b16 a[228:229], v114 offset:8192
    ds_read_b64_tr_b16 a[230:231], v114 offset:8704
    v_cvt_pk_bf16_f32 v104, v48, v49
    v_cvt_pk_bf16_f32 v105, v50, v51
    v_cvt_pk_bf16_f32 v106, v52, v53
    v_cvt_pk_bf16_f32 v107, v54, v55
    v_pk_max_i16 v104, v104, 0
    v_mfma_f32_32x32x16_bf16 v[64:79], v[152:155], a[240:243], v[64:79]
    ds_read_b64_tr_b16 a[232:233], v113 offset:10240
L_pg6:
    s_cbranch_execz L_ret2
    s_nop 0
    ds_read_b64_tr_b16 a[234:235], v113 offset:10752
    v_pk_max_i16 v105, v105, 0
    v_pk_max_i16 v106, v106, 0
    v_pk_max_i16 v107, v107, 0
    s_add_u32 s67, s79, 114688
    s_waitcnt lgkmcnt(8)
    v_mfma_f32_32x32x16_bf16 v[80:95], v[152:155], a[244:247], v[80:95]
    buffer_store_dwordx4 v[104:107], v2, s[4:7], s67 offen offset:0 sc1
    v_cvt_pk_bf16_f32 v108, v56, v57
    v_mfma_f32_32x32x16_bf16 v[64:79], v[156:159], a[248:251], v[64:79]
    ds_read_b64_tr_b16 a[236:237], v114 offset:10240
    ds_read_b64_tr_b16 a[238:239], v114 offset:10752
    ds_read_b64_tr_b16 a[240:241], v113 offset:12288
    ds_read_b64_tr_b16 a[242:243], v113 offset:12800
    v_cvt_pk_bf16_f32 v109, v58, v59
    v_cvt_pk_bf16_f32 v110, v60, v61
    s_waitcnt lgkmcnt(8)
    v_mfma_f32_32x32x16_bf16 v[80:95], v[156:159], a[252:255], v[80:95]
    ds_read_b64_tr_b16 a[244:245], v114 offset:12288
    ds_read_b64_tr_b16 a[246:247], v114 offset:12800
    v_cvt_pk_bf16_f32 v111, v62, v63
    v_pk_max_i16 v108, v108, 0
    v_pk_max_i16 v109, v109, 0
    v_pk_max_i16 v110, v110, 0
    v_pk_max_i16 v111, v111, 0
    v_mfma_f32_32x32x16_bf16 v[64:79], v[160:163], a[224:227], v[64:79]
    buffer_store_dwordx4 v[108:111], v2, s[4:7], s67 offen offset:1024 sc1
    s_waitcnt lgkmcnt(6)
    v_mfma_f32_32x32x16_bf16 v[80:95], v[160:163], a[228:231], v[80:95]
    ds_read_b64_tr_b16 a[248:249], v113 offset:14336
    ds_read_b64_tr_b16 a[250:251], v113 offset:14848
    ds_read_b64_tr_b16 a[252:253], v114 offset:14336
    ds_read_b64_tr_b16 a[254:255], v114 offset:14848
    ds_read_b64_tr_b16 a[224:225], v113 offset:16384
    ds_read_b64_tr_b16 a[226:227], v113 offset:16896
    v_mfma_f32_32x32x16_bf16 v[64:79], v[164:167], a[232:235], v[64:79]
    ds_read_b64_tr_b16 a[228:229], v114 offset:16384
    ds_read_b64_tr_b16 a[230:231], v114 offset:16896
    s_waitcnt lgkmcnt(10)
    v_mfma_f32_32x32x16_bf16 v[80:95], v[164:167], a[236:239], v[80:95]
    ds_read_b64_tr_b16 a[232:233], v113 offset:18432
    ds_read_b64_tr_b16 a[234:235], v113 offset:18944
    v_mfma_f32_32x32x16_bf16 v[64:79], v[168:171], a[240:243], v[64:79]
    ds_read_b64_tr_b16 a[236:237], v114 offset:18432
    ds_read_b64_tr_b16 a[238:239], v114 offset:18944
    s_waitcnt lgkmcnt(10)
    v_mfma_f32_32x32x16_bf16 v[80:95], v[168:171], a[244:247], v[80:95]
    s_waitcnt vmcnt(9)
    s_barrier
    ds_read_b64_tr_b16 a[240:241], v113 offset:20480
    ds_read_b64_tr_b16 a[242:243], v113 offset:20992
    v_mfma_f32_32x32x16_bf16 v[64:79], v[172:175], a[248:251], v[64:79]
    ds_read_b64_tr_b16 a[244:245], v113 offset:22528
    ds_read_b64_tr_b16 a[246:247], v113 offset:23040
    s_waitcnt lgkmcnt(10)
    v_mfma_f32_32x32x16_bf16 v[80:95], v[172:175], a[252:255], v[80:95]
    ds_read_b64_tr_b16 a[248:249], v113 offset:24576
    ds_read_b64_tr_b16 a[250:251], v113 offset:25088
    v_mfma_f32_32x32x16_bf16 v[64:79], v[176:179], a[224:227], v[64:79]
    ds_read_b64_tr_b16 a[252:253], v113 offset:26624
    ds_read_b64_tr_b16 a[254:255], v113 offset:27136
    s_waitcnt lgkmcnt(10)
    v_mfma_f32_32x32x16_bf16 v[80:95], v[176:179], a[228:231], v[80:95]
    ds_read_b64_tr_b16 a[224:225], v113 offset:28672
    ds_read_b64_tr_b16 a[226:227], v113 offset:29184
    v_mfma_f32_32x32x16_bf16 v[64:79], v[180:183], a[232:235], v[64:79]
    ds_read_b64_tr_b16 a[228:229], v113 offset:30720
    ds_read_b64_tr_b16 a[230:231], v113 offset:31232
    s_waitcnt lgkmcnt(10)
    v_mfma_f32_32x32x16_bf16 v[80:95], v[180:183], a[236:239], v[80:95]
    ds_read_b64_tr_b16 a[232:233], v113 offset:32768
    ds_read_b64_tr_b16 a[234:235], v113 offset:33280
    v_mfma_f32_32x32x16_bf16 v[64:79], v[184:187], a[240:243], v[64:79]
    ds_read_b64_tr_b16 a[236:237], v113 offset:34816
    ds_read_b64_tr_b16 a[238:239], v113 offset:35328
    s_waitcnt lgkmcnt(10)
    v_mfma_f32_32x32x16_bf16 v[64:79], v[188:191], a[244:247], v[64:79]
    s_waitcnt vmcnt(3)
    s_barrier
    ds_read_b64_tr_b16 a[240:241], v113 offset:36864
    ds_read_b64_tr_b16 a[242:243], v113 offset:37376
    v_mfma_f32_32x32x16_bf16 v[64:79], v[192:195], a[248:251], v[64:79]
    ds_read_b64_tr_b16 a[244:245], v113 offset:38912
    ds_read_b64_tr_b16 a[246:247], v113 offset:39424
    s_waitcnt lgkmcnt(10)
    v_mfma_f32_32x32x16_bf16 v[64:79], v[196:199], a[252:255], v[64:79]
    ds_read_b64_tr_b16 a[248:249], v113 offset:40960
    ds_read_b64_tr_b16 a[250:251], v113 offset:41472
    v_mfma_f32_32x32x16_bf16 v[64:79], v[200:203], a[224:227], v[64:79]
    ds_read_b64_tr_b16 a[252:253], v113 offset:43008
    ds_read_b64_tr_b16 a[254:255], v113 offset:43520
    s_waitcnt lgkmcnt(10)
    v_mfma_f32_32x32x16_bf16 v[64:79], v[204:207], a[228:231], v[64:79]
    ds_read_b64_tr_b16 a[224:225], v113 offset:45056
    ds_read_b64_tr_b16 a[226:227], v113 offset:45568
    v_mfma_f32_32x32x16_bf16 v[64:79], v[208:211], a[232:235], v[64:79]
    ds_read_b64_tr_b16 a[228:229], v113 offset:47104
    ds_read_b64_tr_b16 a[230:231], v113 offset:47616
    s_waitcnt lgkmcnt(10)
    v_mfma_f32_32x32x16_bf16 v[64:79], v[212:215], a[236:239], v[64:79]
    ds_read_b64_tr_b16 a[232:233], v113 offset:49152
    ds_read_b64_tr_b16 a[234:235], v113 offset:49664
    v_mfma_f32_32x32x16_bf16 v[64:79], v[216:219], a[240:243], v[64:79]
    ds_read_b64_tr_b16 a[236:237], v113 offset:51200
    ds_read_b64_tr_b16 a[238:239], v113 offset:51712
    s_waitcnt lgkmcnt(10)
    v_mfma_f32_32x32x16_bf16 v[64:79], v[220:223], a[244:247], v[64:79]
    ds_read_b64_tr_b16 a[240:241], v113 offset:53248
    ds_read_b64_tr_b16 a[242:243], v113 offset:53760
    v_mfma_f32_32x32x16_bf16 v[64:79], v[224:227], a[248:251], v[64:79]
    ds_read_b64_tr_b16 a[244:245], v113 offset:55296
    ds_read_b64_tr_b16 a[246:247], v113 offset:55808
    s_waitcnt lgkmcnt(10)
    v_mfma_f32_32x32x16_bf16 v[64:79], v[228:231], a[252:255], v[64:79]
    ds_read_b64_tr_b16 a[248:249], v114 offset:20480
    ds_read_b64_tr_b16 a[250:251], v114 offset:20992
    v_mfma_f32_32x32x16_bf16 v[64:79], v[232:235], a[224:227], v[64:79]
    ds_read_b64_tr_b16 a[252:253], v114 offset:22528
    ds_read_b64_tr_b16 a[254:255], v114 offset:23040
    s_waitcnt lgkmcnt(10)
    v_mfma_f32_32x32x16_bf16 v[64:79], v[236:239], a[228:231], v[64:79]
    ds_read_b64_tr_b16 a[224:225], v114 offset:24576
    ds_read_b64_tr_b16 a[226:227], v114 offset:25088
    v_mfma_f32_32x32x16_bf16 v[64:79], v[240:243], a[232:235], v[64:79]
    ds_read_b64_tr_b16 a[228:229], v114 offset:26624
    ds_read_b64_tr_b16 a[230:231], v114 offset:27136
    s_waitcnt lgkmcnt(10)
    v_mfma_f32_32x32x16_bf16 v[64:79], v[244:247], a[236:239], v[64:79]
    s_waitcnt vmcnt(0)
    s_mov_b64 exec, 1
    buffer_store_dword v17, v29, s[4:7], s98 offen offset:0
    s_mov_b64 exec, -1
    v_mfma_f32_32x32x16_bf16 v[64:79], v[248:251], a[240:243], v[64:79]
    ds_read_b64_tr_b16 a[232:233], v114 offset:28672
    ds_read_b64_tr_b16 a[234:235], v114 offset:29184
    ds_read_b64_tr_b16 a[236:237], v114 offset:30720
    ds_read_b64_tr_b16 a[238:239], v114 offset:31232
    s_waitcnt lgkmcnt(10)
    v_mfma_f32_32x32x16_bf16 v[64:79], v[252:255], a[244:247], v[64:79]
    ds_read_b64_tr_b16 a[240:241], v114 offset:32768
    ds_read_b64_tr_b16 a[242:243], v114 offset:33280
    v_mfma_f32_32x32x16_bf16 v[80:95], v[184:187], a[248:251], v[80:95]
    ds_read_b64_tr_b16 a[244:245], v114 offset:34816
    ds_read_b64_tr_b16 a[246:247], v114 offset:35328
    s_waitcnt lgkmcnt(10)
    v_mfma_f32_32x32x16_bf16 v[80:95], v[188:191], a[252:255], v[80:95]
    ds_read_b64_tr_b16 a[248:249], v114 offset:36864
    ds_read_b64_tr_b16 a[250:251], v114 offset:37376
    v_mfma_f32_32x32x16_bf16 v[80:95], v[192:195], a[224:227], v[80:95]
    s_nop 1
    v_cvt_pk_bf16_f32 v96, v64, v65
    v_cvt_pk_bf16_f32 v97, v66, v67
    v_cvt_pk_bf16_f32 v98, v68, v69
    v_cvt_pk_bf16_f32 v99, v70, v71
    v_pk_max_i16 v96, v96, 0
    v_pk_max_i16 v97, v97, 0
    s_waitcnt lgkmcnt(8)
    v_mfma_f32_32x32x16_bf16 v[80:95], v[196:199], a[228:231], v[80:95]
    ds_read_b64_tr_b16 a[252:253], v114 offset:38912
    ds_read_b64_tr_b16 a[254:255], v114 offset:39424
    v_pk_max_i16 v98, v98, 0
    v_pk_max_i16 v99, v99, 0
    s_add_u32 s67, s79, 229376
    ds_read_b64_tr_b16 a[224:225], v114 offset:40960
    ds_read_b64_tr_b16 a[226:227], v114 offset:41472
    v_mfma_f32_32x32x16_bf16 v[80:95], v[200:203], a[232:235], v[80:95]
    buffer_store_dwordx4 v[96:99], v2, s[4:7], s67 offen offset:0 sc1
    s_waitcnt lgkmcnt(8)
    v_mfma_f32_32x32x16_bf16 v[80:95], v[204:207], a[236:239], v[80:95]
    ds_read_b64_tr_b16 a[228:229], v114 offset:43008
    ds_read_b64_tr_b16 a[230:231], v114 offset:43520
    v_cvt_pk_bf16_f32 v100, v72, v73
    v_cvt_pk_bf16_f32 v101, v74, v75
    v_cvt_pk_bf16_f32 v102, v76, v77
    v_cvt_pk_bf16_f32 v103, v78, v79
    v_pk_max_i16 v100, v100, 0
    v_mfma_f32_32x32x16_bf16 v[80:95], v[208:211], a[240:243], v[80:95]
    ds_read_b64_tr_b16 a[232:233], v114 offset:45056
    ds_read_b64_tr_b16 a[234:235], v114 offset:45568
    v_pk_max_i16 v101, v101, 0
    v_pk_max_i16 v102, v102, 0
    v_pk_max_i16 v103, v103, 0
    s_waitcnt lgkmcnt(8)
    v_mfma_f32_32x32x16_bf16 v[80:95], v[212:215], a[244:247], v[80:95]
    buffer_store_dwordx4 v[100:103], v2, s[4:7], s67 offen offset:1024 sc1
    v_mfma_f32_32x32x16_bf16 v[80:95], v[216:219], a[248:251], v[80:95]
    ds_read_b64_tr_b16 a[236:237], v114 offset:47104
    ds_read_b64_tr_b16 a[238:239], v114 offset:47616
    ds_read_b64_tr_b16 a[240:241], v114 offset:49152
    ds_read_b64_tr_b16 a[242:243], v114 offset:49664
    ds_read_b64_tr_b16 a[244:245], v114 offset:51200
    ds_read_b64_tr_b16 a[246:247], v114 offset:51712
    s_waitcnt lgkmcnt(10)
    v_mfma_f32_32x32x16_bf16 v[80:95], v[220:223], a[252:255], v[80:95]
    ds_read_b64_tr_b16 a[248:249], v114 offset:53248
    ds_read_b64_tr_b16 a[250:251], v114 offset:53760
    v_mfma_f32_32x32x16_bf16 v[80:95], v[224:227], a[224:227], v[80:95]
    ds_read_b64_tr_b16 a[252:253], v114 offset:55296
    ds_read_b64_tr_b16 a[254:255], v114 offset:55808
    ds_read_b64_tr_b16 v[32:33], v22 offset:0
    ds_read_b64_tr_b16 v[34:35], v22 offset:512
    ds_read_b64_tr_b16 v[36:37], v22 offset:4096
    ds_read_b64_tr_b16 v[38:39], v22 offset:4608
    s_waitcnt lgkmcnt(14)
    v_mfma_f32_32x32x16_bf16 v[80:95], v[228:231], a[228:231], v[80:95]
    ds_read_b64_tr_b16 v[40:41], v22 offset:8192
    ds_read_b64_tr_b16 v[42:43], v22 offset:8704
    ds_read_b64_tr_b16 v[44:45], v22 offset:12288
    ds_read_b64_tr_b16 v[46:47], v22 offset:12800
    ds_read_b64_tr_b16 v[48:49], v22 offset:16384
    ds_read_b64_tr_b16 v[50:51], v22 offset:16896
    ds_read_b64_tr_b16 v[52:53], v22 offset:20480
    v_mfma_f32_32x32x16_bf16 v[80:95], v[232:235], a[232:235], v[80:95]
    ds_read_b64_tr_b16 v[54:55], v22 offset:20992
    ds_read_b64_tr_b16 v[56:57], v22 offset:24576
    ds_read_b64_tr_b16 v[58:59], v22 offset:25088
    ds_read_b64_tr_b16 v[60:61], v22 offset:28672
    ds_read_b64_tr_b16 v[62:63], v22 offset:29184
    s_waitcnt lgkmcnt(14)
    v_mfma_f32_32x32x16_bf16 v[80:95], v[236:239], a[236:239], v[80:95]
    v_mfma_f32_32x32x16_bf16 v[80:95], v[240:243], a[240:243], v[80:95]
    v_mfma_f32_32x32x16_bf16 v[80:95], v[244:247], a[244:247], v[80:95]
    buffer_load_dword v31, v28, s[4:7], s98 offen offset:0 sc1
    v_mfma_f32_32x32x16_bf16 v[80:95], v[248:251], a[248:251], v[80:95]
    v_mfma_f32_32x32x16_bf16 v[80:95], v[252:255], a[252:255], v[80:95]
    ds_read_b64_tr_b16 v[64:65], v22 offset:32768
    ds_read_b64_tr_b16 v[66:67], v22 offset:33280
    ds_read_b64_tr_b16 v[68:69], v22 offset:36864
    ds_read_b64_tr_b16 v[70:71], v22 offset:37376
    ds_read_b64_tr_b16 v[72:73], v22 offset:40960
    ds_read_b64_tr_b16 v[74:75], v22 offset:41472
    ds_read_b64_tr_b16 v[76:77], v22 offset:45056
    ds_read_b64_tr_b16 v[78:79], v22 offset:45568
    v_mov_b32 v116, s64
    v_mov_b32 v117, s64
    v_mov_b32 v118, s64
    v_mov_b32 v119, s64
    v_cvt_pk_bf16_f32 v104, v80, v81
    v_cvt_pk_bf16_f32 v105, v82, v83
    v_cvt_pk_bf16_f32 v106, v84, v85
    v_cvt_pk_bf16_f32 v107, v86, v87
    v_pk_max_i16 v104, v104, 0
    v_pk_max_i16 v105, v105, 0
    v_pk_max_i16 v106, v106, 0
    v_pk_max_i16 v107, v107, 0
    s_add_u32 s67, s79, 344064
    buffer_store_dwordx4 v[104:107], v2, s[4:7], s67 offen offset:0 sc1
    v_cvt_pk_bf16_f32 v108, v88, v89
    v_cvt_pk_bf16_f32 v109, v90, v91
    v_cvt_pk_bf16_f32 v110, v92, v93
    v_cvt_pk_bf16_f32 v111, v94, v95
    v_pk_max_i16 v108, v108, 0
    v_pk_max_i16 v109, v109, 0
    v_pk_max_i16 v110, v110, 0
    v_pk_max_i16 v111, v111, 0
    buffer_store_dwordx4 v[108:111], v2, s[4:7], s67 offen offset:1024 sc1
    s_mov_b64 exec, 1
    buffer_store_dword v17, v29, s[4:7], s80 offen offset:0 sc1
    s_mov_b64 exec, -1
    ds_read_b64_tr_b16 v[80:81], v22 offset:49152
    ds_read_b64_tr_b16 v[82:83], v22 offset:49664
    ds_read_b64_tr_b16 v[84:85], v22 offset:53248
    ds_read_b64_tr_b16 v[86:87], v22 offset:53760
    ds_read_b64_tr_b16 v[132:133], v23 offset:0
    ds_read_b64_tr_b16 v[134:135], v23 offset:512
    ds_read_b64_tr_b16 v[136:137], v23 offset:57376
    ds_read_b64_tr_b16 v[138:139], v23 offset:57888
    s_waitcnt vmcnt(3)
    v_cmp_eq_u32 vcc, 0, v31
    s_cbranch_vccnz L_slow_57
L_ok_59:
    s_add_u32 s70, s78, 0
    buffer_load_dwordx4 a[224:227], v2, s[4:7], s70 offen offset:0 sc1
    v_mfma_f32_16x16x32_bf16 v[124:127], v[32:35], v[32:35], 0
    v_mfma_f32_16x16x32_bf16 v[120:123], v[116:119], v[32:35], 0
    s_waitcnt lgkmcnt(14)
    v_mfma_f32_16x16x32_bf16 v[124:127], v[36:39], v[36:39], v[124:127]
    buffer_load_dwordx4 a[228:231], v2, s[4:7], s70 offen offset:1024 sc1
    v_mfma_f32_16x16x32_bf16 v[120:123], v[116:119], v[36:39], v[120:123]
    v_mfma_f32_16x16x32_bf16 v[124:127], v[40:43], v[40:43], v[124:127]
    v_mfma_f32_16x16x32_bf16 v[120:123], v[116:119], v[40:43], v[120:123]
    buffer_load_dwordx4 a[232:235], v2, s[4:7], s70 offen offset:2048 sc1
    v_mfma_f32_16x16x32_bf16 v[124:127], v[44:47], v[44:47], v[124:127]
    v_mfma_f32_16x16x32_bf16 v[120:123], v[116:119], v[44:47], v[120:123]
    v_mfma_f32_16x16x32_bf16 v[124:127], v[48:51], v[48:51], v[124:127]
    buffer_load_dwordx4 a[236:239], v2, s[4:7], s70 offen offset:3072 sc1
    v_mfma_f32_16x16x32_bf16 v[120:123], v[116:119], v[48:51], v[120:123]
    v_mfma_f32_16x16x32_bf16 v[124:127], v[52:55], v[52:55], v[124:127]
    v_mfma_f32_16x16x32_bf16 v[120:123], v[116:119], v[52:55], v[120:123]
    s_add_u32 s70, s78, 4096
    buffer_load_dwordx4 a[240:243], v2, s[4:7], s70 offen offset:0 sc1
    v_mfma_f32_16x16x32_bf16 v[124:127], v[56:59], v[56:59], v[124:127]
    v_mfma_f32_16x16x32_bf16 v[120:123], v[116:119], v[56:59], v[120:123]
    v_mfma_f32_16x16x32_bf16 v[124:127], v[60:63], v[60:63], v[124:127]
    buffer_load_dwordx4 a[244:247], v2, s[4:7], s70 offen offset:1024 sc1
    v_mfma_f32_16x16x32_bf16 v[120:123], v[116:119], v[60:63], v[120:123]
    v_mfma_f32_16x16x32_bf16 v[124:127], v[64:67], v[64:67], v[124:127]
    v_mfma_f32_16x16x32_bf16 v[120:123], v[116:119], v[64:67], v[120:123]
    buffer_load_dwordx4 a[248:251], v2, s[4:7], s70 offen offset:2048 sc1
    s_waitcnt lgkmcnt(12)
    v_mfma_f32_16x16x32_bf16 v[124:127], v[68:71], v[68:71], v[124:127]
    v_mfma_f32_16x16x32_bf16 v[120:123], v[116:119], v[68:71], v[120:123]
    buffer_load_dwordx4 a[252:255], v2, s[4:7], s70 offen offset:3072 sc1
    s_waitcnt lgkmcnt(10)
    v_mfma_f32_16x16x32_bf16 v[124:127], v[72:75], v[72:75], v[124:127]
    v_mfma_f32_16x16x32_bf16 v[120:123], v[116:119], v[72:75], v[120:123]
    s_waitcnt vmcnt(9)
    s_mov_b64 exec, 1
    buffer_store_dword v17, v29, s[4:7], s98 offen offset:4
    s_mov_b64 exec, -1
    s_add_u32 s70, s78, 8192
    buffer_load_dwordx4 v[96:99], v2, s[4:7], s70 offen offset:0 sc1
    s_waitcnt lgkmcnt(8)
    v_mfma_f32_16x16x32_bf16 v[124:127], v[76:79], v[76:79], v[124:127]
    v_mfma_f32_16x16x32_bf16 v[120:123], v[116:119], v[76:79], v[120:123]
    buffer_load_dwordx4 v[100:103], v2, s[4:7], s70 offen offset:1024 sc1
    s_waitcnt lgkmcnt(6)
    v_mfma_f32_16x16x32_bf16 v[124:127], v[80:83], v[80:83], v[124:127]
    v_mfma_f32_16x16x32_bf16 v[120:123], v[116:119], v[80:83], v[120:123]
    buffer_load_dwordx4 v[104:107], v2, s[4:7], s70 offen offset:2048 sc1
    s_waitcnt lgkmcnt(4)
    v_mfma_f32_16x16x32_bf16 v[124:127], v[84:87], v[84:87], v[124:127]
    v_mfma_f32_16x16x32_bf16 v[120:123], v[116:119], v[84:87], v[120:123]
    s_waitcnt lgkmcnt(0)
    s_barrier
    s_waitcnt vmcnt(11)
    v_mfma_f32_32x32x16_bf16 v[32:47], a[0:3], a[224:227], 0
    v_mfma_f32_32x32x16_bf16 v[48:63], a[4:7], a[224:227], 0
    buffer_load_dwordx4 a[224:227], v2, s[4:7], s70 offen offset:3072 sc1
    s_waitcnt vmcnt(11)
    v_mfma_f32_32x32x16_bf16 v[32:47], a[8:11], a[228:231], v[32:47]
    s_mov_b32 vcc_lo, 0x00100001
    s_mov_b32 vcc_hi, 0x10000100
    v_cndmask_b32 v116, 0, v124, vcc
    s_lshl_b64 vcc, vcc, 1
    v_cndmask_b32 v116, v116, v125, vcc
    s_lshl_b64 vcc, vcc, 1
    v_mfma_f32_32x32x16_bf16 v[48:63], a[12:15], a[228:231], v[48:63]
    s_add_u32 s70, s78, 12288
    buffer_load_dwordx4 a[228:231], v2, s[4:7], s70 offen offset:0 sc1
    v_cndmask_b32 v116, v116, v126, vcc
    s_waitcnt vmcnt(11)
    v_mfma_f32_32x32x16_bf16 v[32:47], a[16:19], a[232:235], v[32:47]
    s_lshl_b64 vcc, vcc, 1
    v_cndmask_b32 v116, v116, v127, vcc
    v_mov_b32 v117, v116
    v_mul_f32 v120, 0x3b124925, v120
    v_mfma_f32_32x32x16_bf16 v[48:63], a[20:23], a[232:235], v[48:63]
    buffer_load_dwordx4 a[232:235], v2, s[4:7], s70 offen offset:1024 sc1
    v_permlane32_swap_b32 v116, v117
    s_waitcnt vmcnt(11)
    v_mfma_f32_32x32x16_bf16 v[32:47], a[24:27], a[236:239], v[32:47]
    v_add_f32 v116, v116, v117
    v_mov_b32 v117, v116
    v_mfma_f32_32x32x16_bf16 v[48:63], a[28:31], a[236:239], v[48:63]
    buffer_load_dwordx4 a[236:239], v2, s[4:7], s70 offen offset:2048 sc1
    s_waitcnt vmcnt(11)
    v_mfma_f32_32x32x16_bf16 v[32:47], a[32:35], a[240:243], v[32:47]
    v_permlane16_swap_b32 v116, v117
    v_add_f32_e64 v116, v116, v117
    v_mul_f32 v116, 0x3b124925, v116
    v_fma_f32 v116, -v120, v120, v116
    v_max_f32_e64 v116, 0, v116
    v_add_f32 v116, 0x3727c5ac, v116
    v_mfma_f32_32x32x16_bf16 v[48:63], a[36:39], a[240:243], v[48:63]
    buffer_load_dwordx4 a[240:243], v2, s[4:7], s70 offen offset:3072 sc1
    v_rsq_f32 v116, v116
    s_waitcnt vmcnt(11)
    v_mfma_f32_32x32x16_bf16 v[32:47], a[40:43], a[244:247], v[32:47]
    v_mov_b32 v140, v116
    v_mov_b32 v142, v116
    v_mfma_f32_32x32x16_bf16 v[48:63], a[44:47], a[244:247], v[48:63]
    s_add_u32 s70, s78, 16384
    buffer_load_dwordx4 a[244:247], v2, s[4:7], s70 offen offset:0 sc1
    s_waitcnt vmcnt(11)
    v_mfma_f32_32x32x16_bf16 v[32:47], a[48:51], a[248:251], v[32:47]
    v_mov_b32_dpp v140, v116 row_ror:8 row_mask:0xf bank_mask:0xc
    v_mov_b32_dpp v142, v116 row_ror:8 row_mask:0xf bank_mask:0x3
    ds_bpermute_b32 v132, v27, v132
    v_mfma_f32_32x32x16_bf16 v[48:63], a[52:55], a[248:251], v[48:63]
    buffer_load_dwordx4 a[248:251], v2, s[4:7], s70 offen offset:1024 sc1
    s_waitcnt vmcnt(11)
    v_mfma_f32_32x32x16_bf16 v[32:47], a[56:59], a[252:255], v[32:47]
    ds_bpermute_b32 v133, v27, v133
    ds_bpermute_b32 v134, v27, v134
    v_mfma_f32_32x32x16_bf16 v[48:63], a[60:63], a[252:255], v[48:63]
    buffer_load_dwordx4 a[252:255], v2, s[4:7], s70 offen offset:2048 sc1
    s_waitcnt vmcnt(10)
    v_mfma_f32_32x32x16_bf16 v[32:47], a[64:67], v[96:99], v[32:47]
    ds_bpermute_b32 v135, v27, v135
    ds_bpermute_b32 v136, v27, v136
    v_mfma_f32_32x32x16_bf16 v[48:63], a[68:71], v[96:99], v[48:63]
    buffer_load_dwordx4 v[96:99], v2, s[4:7], s70 offen offset:3072 sc1
    s_waitcnt vmcnt(10)
    v_mfma_f32_32x32x16_bf16 v[32:47], a[72:75], v[100:103], v[32:47]
    buffer_load_dword v31, v28, s[4:7], s98 offen offset:4 sc1
    v_mfma_f32_32x32x16_bf16 v[48:63], a[76:79], v[100:103], v[48:63]
    s_add_u32 s70, s78, 20480
    buffer_load_dwordx4 v[100:103], v2, s[4:7], s70 offen offset:0 sc1
    s_waitcnt vmcnt(11)
    v_mfma_f32_32x32x16_bf16 v[32:47], a[80:83], v[104:107], v[32:47]
    ds_bpermute_b32 v137, v27, v137
    ds_bpermute_b32 v138, v27, v138
    v_mfma_f32_32x32x16_bf16 v[48:63], a[84:87], v[104:107], v[48:63]
    buffer_load_dwordx4 v[104:107], v2, s[4:7], s70 offen offset:1024 sc1
    s_waitcnt vmcnt(11)
    v_mfma_f32_32x32x16_bf16 v[32:47], a[88:91], a[224:227], v[32:47]
    ds_bpermute_b32 v139, v27, v139
    ds_bpermute_b32 v140, v27, v140
    v_mfma_f32_32x32x16_bf16 v[48:63], a[92:95], a[224:227], v[48:63]
    buffer_load_dwordx4 a[224:227], v2, s[4:7], s70 offen offset:2048 sc1
    s_waitcnt vmcnt(11)
    v_mfma_f32_32x32x16_bf16 v[32:47], a[96:99], a[228:231], v[32:47]
    ds_bpermute_b32 v142, v27, v142
    v_mfma_f32_32x32x16_bf16 v[48:63], a[100:103], a[228:231], v[48:63]
    buffer_load_dwordx4 a[228:231], v2, s[4:7], s70 offen offset:3072 sc1
    s_waitcnt vmcnt(11)
    v_mfma_f32_32x32x16_bf16 v[32:47], a[104:107], a[232:235], v[32:47]
    v_mfma_f32_32x32x16_bf16 v[48:63], a[108:111], a[232:235], v[48:63]
    s_add_u32 s70, s78, 24576
    buffer_load_dwordx4 a[232:235], v2, s[4:7], s70 offen offset:0 sc1
    s_waitcnt lgkmcnt(9)
    v_lshlrev_b32 v116, 16, v132
    s_waitcnt vmcnt(11)
    v_mfma_f32_32x32x16_bf16 v[32:47], a[112:115], a[236:239], v[32:47]
    v_and_b32 v117, s65, v132
    s_waitcnt lgkmcnt(8)
    v_lshlrev_b32 v118, 16, v133
    v_and_b32 v119, s65, v133
    s_waitcnt lgkmcnt(7)
    v_lshlrev_b32 v120, 16, v134
    v_and_b32 v121, s65, v134
    s_waitcnt lgkmcnt(6)
    v_lshlrev_b32 v122, 16, v135
    v_mfma_f32_32x32x16_bf16 v[48:63], a[116:119], a[236:239], v[48:63]
    buffer_load_dwordx4 a[236:239], v2, s[4:7], s70 offen offset:1024 sc1
    v_and_b32 v123, s65, v135
    s_waitcnt vmcnt(11)
    v_mfma_f32_32x32x16_bf16 v[32:47], a[120:123], a[240:243], v[32:47]
    v_mfma_f32_32x32x16_bf16 v[48:63], a[124:127], a[240:243], v[48:63]
    buffer_load_dwordx4 a[240:243], v2, s[4:7], s70 offen offset:2048 sc1
    s_waitcnt vmcnt(11)
    v_mfma_f32_32x32x16_bf16 v[32:47], a[128:131], a[244:247], v[32:47]
    v_mfma_f32_32x32x16_bf16 v[48:63], a[132:135], a[244:247], v[48:63]
    buffer_load_dwordx4 a[244:247], v2, s[4:7], s70 offen offset:3072 sc1
    s_waitcnt vmcnt(11)
    v_mfma_f32_32x32x16_bf16 v[32:47], a[136:139], a[248:251], v[32:47]
    v_mfma_f32_32x32x16_bf16 v[48:63], a[140:143], a[248:251], v[48:63]
    s_waitcnt vmcnt(10)
    v_mfma_f32_32x32x16_bf16 v[32:47], a[144:147], a[252:255], v[32:47]
    v_mfma_f32_32x32x16_bf16 v[48:63], a[148:151], a[252:255], v[48:63]
    s_waitcnt vmcnt(9)
    v_mfma_f32_32x32x16_bf16 v[32:47], a[152:155], v[96:99], v[32:47]
    s_waitcnt vmcnt(8)
    v_cmp_eq_u32 vcc, 0, v31
    v_mfma_f32_32x32x16_bf16 v[48:63], a[156:159], v[96:99], v[48:63]
    s_cbranch_vccnz L_slow_60
L_ok_62:
    s_add_u32 s70, s78, 229376
    buffer_load_dwordx4 a[248:251], v2, s[4:7], s70 offen offset:0 sc1
    s_waitcnt vmcnt(8)
    v_mfma_f32_32x32x16_bf16 v[32:47], a[160:163], v[100:103], v[32:47]
    buffer_load_dwordx4 a[252:255], v2, s[4:7], s70 offen offset:1024 sc1
    v_mfma_f32_32x32x16_bf16 v[48:63], a[164:167], v[100:103], v[48:63]
    buffer_load_dwordx4 v[96:99], v2, s[4:7], s70 offen offset:2048 sc1
    s_waitcnt vmcnt(9)
    v_mfma_f32_32x32x16_bf16 v[32:47], a[168:171], v[104:107], v[32:47]
    buffer_load_dwordx4 v[100:103], v2, s[4:7], s70 offen offset:3072 sc1
    v_mfma_f32_32x32x16_bf16 v[48:63], a[172:175], v[104:107], v[48:63]
    s_add_u32 s70, s78, 233472
    buffer_load_dwordx4 v[104:107], v2, s[4:7], s70 offen offset:0 sc1
    s_waitcnt vmcnt(10)
    v_mfma_f32_32x32x16_bf16 v[32:47], a[176:179], a[224:227], v[32:47]
    v_mfma_f32_32x32x16_bf16 v[48:63], a[180:183], a[224:227], v[48:63]
    buffer_load_dwordx4 a[224:227], v2, s[4:7], s70 offen offset:1024 sc1
    s_waitcnt vmcnt(10)
    v_mfma_f32_32x32x16_bf16 v[32:47], a[184:187], a[228:231], v[32:47]
    v_mfma_f32_32x32x16_bf16 v[48:63], a[188:191], a[228:231], v[48:63]
    buffer_load_dwordx4 a[228:231], v2, s[4:7], s70 offen offset:2048 sc1
    s_waitcnt vmcnt(10)
    v_mfma_f32_32x32x16_bf16 v[32:47], a[192:195], a[232:235], v[32:47]
    v_mfma_f32_32x32x16_bf16 v[48:63], a[196:199], a[232:235], v[48:63]
    buffer_load_dwordx4 a[232:235], v2, s[4:7], s70 offen offset:3072 sc1
    s_waitcnt vmcnt(10)
    v_mfma_f32_32x32x16_bf16 v[32:47], a[200:203], a[236:239], v[32:47]
    v_mfma_f32_32x32x16_bf16 v[48:63], a[204:207], a[236:239], v[48:63]
    s_add_u32 s70, s78, 237568
    buffer_load_dwordx4 a[236:239], v2, s[4:7], s70 offen offset:0 sc1
    s_waitcnt vmcnt(10)
    v_mfma_f32_32x32x16_bf16 v[32:47], a[208:211], a[240:243], v[32:47]
    v_mfma_f32_32x32x16_bf16 v[48:63], a[212:215], a[240:243], v[48:63]
    buffer_load_dwordx4 a[240:243], v2, s[4:7], s70 offen offset:1024 sc1
    s_waitcnt vmcnt(10)
    v_mfma_f32_32x32x16_bf16 v[32:47], a[216:219], a[244:247], v[32:47]
    v_mfma_f32_32x32x16_bf16 v[48:63], a[220:223], a[244:247], v[48:63]
    buffer_load_dwordx4 a[244:247], v2, s[4:7], s70 offen offset:2048 sc1
    s_waitcnt vmcnt(10)
    v_mfma_f32_32x32x16_bf16 v[64:79], a[0:3], a[248:251], 0
    v_mfma_f32_32x32x16_bf16 v[80:95], a[4:7], a[248:251], 0
    buffer_load_dwordx4 a[248:251], v2, s[4:7], s70 offen offset:3072 sc1
    s_waitcnt vmcnt(10)
    v_mfma_f32_32x32x16_bf16 v[64:79], a[8:11], a[252:255], v[64:79]
    s_mov_b64 exec, 1
    buffer_store_dword v17, v29, s[4:7], s80 offen offset:4 sc1
    s_mov_b64 exec, -1
    v_mfma_f32_32x32x16_bf16 v[80:95], a[12:15], a[252:255], v[80:95]
    s_add_u32 s70, s78, 241664
    buffer_load_dwordx4 a[252:255], v2, s[4:7], s70 offen offset:0 sc1
    ds_write_b128 v24, v[32:35] offset:0
    s_waitcnt vmcnt(11)
    v_mfma_f32_32x32x16_bf16 v[64:79], a[16:19], v[96:99], v[64:79]
    ds_write_b128 v24, v[36:39] offset:1088
    v_mfma_f32_32x32x16_bf16 v[80:95], a[20:23], v[96:99], v[80:95]
    buffer_load_dwordx4 v[96:99], v2, s[4:7], s70 offen offset:1024 sc1
    ds_write_b128 v24, v[40:43] offset:2176
    s_waitcnt vmcnt(11)
    v_mfma_f32_32x32x16_bf16 v[64:79], a[24:27], v[100:103], v[64:79]
    ds_write_b128 v24, v[44:47] offset:3264
    v_mfma_f32_32x32x16_bf16 v[80:95], a[28:31], v[100:103], v[80:95]
    buffer_load_dwordx4 v[100:103], v2, s[4:7], s70 offen offset:2048 sc1
    ds_write_b128 v24, v[48:51] offset:4352
    s_waitcnt vmcnt(11)
    v_mfma_f32_32x32x16_bf16 v[64:79], a[32:35], v[104:107], v[64:79]
    ds_write_b128 v24, v[52:55] offset:5440
    v_mfma_f32_32x32x16_bf16 v[80:95], a[36:39], v[104:107], v[80:95]
    buffer_load_dwordx4 v[104:107], v2, s[4:7], s70 offen offset:3072 sc1
    ds_write_b128 v24, v[56:59] offset:6528
    s_waitcnt vmcnt(11)
    v_mfma_f32_32x32x16_bf16 v[64:79], a[40:43], a[224:227], v[64:79]
    ds_write_b128 v24, v[60:63] offset:7616
    v_mfma_f32_32x32x16_bf16 v[80:95], a[44:47], a[224:227], v[80:95]
    s_add_u32 s70, s78, 245760
    buffer_load_dwordx4 a[224:227], v2, s[4:7], s70 offen offset:0 sc1
    s_waitcnt vmcnt(11)
    v_mfma_f32_32x32x16_bf16 v[64:79], a[48:51], a[228:231], v[64:79]
    s_waitcnt lgkmcnt(0)
    s_barrier
    ds_read_b128 v[32:35], v25 offset:0
    v_mfma_f32_32x32x16_bf16 v[80:95], a[52:55], a[228:231], v[80:95]
    buffer_load_dwordx4 a[228:231], v2, s[4:7], s70 offen offset:1024 sc1
    s_waitcnt vmcnt(11)
    v_mfma_f32_32x32x16_bf16 v[64:79], a[56:59], a[232:235], v[64:79]
    ds_read_b128 v[36:39], v25 offset:512
    ds_read_b128 v[40:43], v25 offset:9216
    ds_read_b128 v[44:47], v25 offset:9728
    v_mfma_f32_32x32x16_bf16 v[80:95], a[60:63], a[232:235], v[80:95]
    buffer_load_dwordx4 a[232:235], v2, s[4:7], s70 offen offset:2048 sc1
    s_waitcnt vmcnt(11)
    v_mfma_f32_32x32x16_bf16 v[64:79], a[64:67], a[236:239], v[64:79]
    ds_read_b128 v[48:51], v25 offset:18432
    ds_read_b128 v[52:55], v25 offset:18944
    ds_read_b128 v[56:59], v25 offset:27648
    v_mfma_f32_32x32x16_bf16 v[80:95], a[68:71], a[236:239], v[80:95]
    buffer_load_dwordx4 a[236:239], v2, s[4:7], s70 offen offset:3072 sc1
    s_waitcnt vmcnt(11)
    v_mfma_f32_32x32x16_bf16 v[64:79], a[72:75], a[240:243], v[64:79]
    ds_read_b128 v[60:63], v25 offset:28160
    v_mfma_f32_32x32x16_bf16 v[80:95], a[76:79], a[240:243], v[80:95]
    s_add_u32 s70, s78, 249856
    buffer_load_dwordx4 a[240:243], v2, s[4:7], s70 offen offset:0 sc1
    s_waitcnt vmcnt(11)
    v_mfma_f32_32x32x16_bf16 v[64:79], a[80:83], a[244:247], v[64:79]
    s_waitcnt lgkmcnt(5)
    v_add_f32 v32, v32, v40
    v_add_f32 v33, v33, v41
    v_add_f32 v34, v34, v42
    v_add_f32 v35, v35, v43
    s_waitcnt lgkmcnt(4)
    v_add_f32 v36, v36, v44
    v_add_f32 v37, v37, v45
    v_mfma_f32_32x32x16_bf16 v[80:95], a[84:87], a[244:247], v[80:95]
    buffer_load_dwordx4 a[244:247], v2, s[4:7], s70 offen offset:1024 sc1
    v_add_f32 v38, v38, v46
    s_waitcnt vmcnt(11)
    v_mfma_f32_32x32x16_bf16 v[64:79], a[88:91], a[248:251], v[64:79]
    v_add_f32 v39, v39, v47
    s_waitcnt lgkmcnt(1)
    v_add_f32 v48, v48, v56
    v_add_f32 v49, v49, v57
    v_add_f32 v50, v50, v58
    v_add_f32 v51, v51, v59
    s_waitcnt lgkmcnt(0)
    v_add_f32 v52, v52, v60
    v_mfma_f32_32x32x16_bf16 v[80:95], a[92:95], a[248:251], v[80:95]
    buffer_load_dwordx4 a[248:251], v2, s[4:7], s70 offen offset:2048 sc1
L_pg7:
    s_cbranch_execz L_ret2
    v_add_f32 v53, v53, v61
    s_waitcnt vmcnt(10)
    v_mfma_f32_32x32x16_bf16 v[64:79], a[96:99], a[252:255], v[64:79]
    v_add_f32 v54, v54, v62
    v_add_f32 v55, v55, v63
    v_add_f32 v32, v32, v48
    v_add_f32 v33, v33, v49
    v_add_f32 v34, v34, v50
    v_add_f32_e64 v35, v35, v51
    v_mfma_f32_32x32x16_bf16 v[80:95], a[100:103], a[252:255], v[80:95]
    buffer_load_dwordx4 a[252:255], v2, s[4:7], s70 offen offset:3072 sc1
    v_add_f32 v36, v36, v52
    s_waitcnt vmcnt(10)
    v_mfma_f32_32x32x16_bf16 v[64:79], a[104:107], v[96:99], v[64:79]
    v_add_f32 v37, v37, v53
    v_add_f32 v38, v38, v54
    v_add_f32_e64 v39, v39, v55
    v_fma_f32 v32, v32, v140, v116
    v_fma_f32 v33, v33, v140, v117
    v_fma_f32 v34, v34, v140, v118
    v_mfma_f32_32x32x16_bf16 v[80:95], a[108:111], v[96:99], v[80:95]
    s_add_u32 s70, s78, 253952
    buffer_load_dwordx4 v[96:99], v2, s[4:7], s70 offen offset:0 sc1
    v_fma_f32 v35, v35, v140, v119
    s_waitcnt vmcnt(10)
    v_mfma_f32_32x32x16_bf16 v[64:79], a[112:115], v[100:103], v[64:79]
    v_fma_f32 v36, v36, v140, v120
    v_fma_f32 v37, v37, v140, v121
    v_fma_f32 v38, v38, v140, v122
    v_fma_f32 v39, v39, v140, v123
    v_cvt_pk_bf16_f32 v56, v32, v33
    v_cvt_pk_bf16_f32 v57, v34, v35
    v_mfma_f32_32x32x16_bf16 v[80:95], a[116:119], v[100:103], v[80:95]
    buffer_load_dwordx4 v[100:103], v2, s[4:7], s70 offen offset:1024 sc1
    v_cvt_pk_bf16_f32 v58, v36, v37
    s_waitcnt vmcnt(10)
    v_mfma_f32_32x32x16_bf16 v[64:79], a[120:123], v[104:107], v[64:79]
    v_cvt_pk_bf16_f32 v59, v38, v39
    s_mov_b32 s67, 0
    v_mfma_f32_32x32x16_bf16 v[80:95], a[124:127], v[104:107], v[80:95]
    buffer_load_dwordx4 v[104:107], v2, s[4:7], s70 offen offset:2048 sc1
    s_waitcnt vmcnt(10)
    v_mfma_f32_32x32x16_bf16 v[64:79], a[128:131], a[224:227], v[64:79]
    v_mfma_f32_32x32x16_bf16 v[80:95], a[132:135], a[224:227], v[80:95]
    buffer_load_dwordx4 a[224:227], v2, s[4:7], s70 offen offset:3072 sc1
    buffer_store_dwordx4 v[56:59], v26, s[8:11], s67 offen nt
    s_waitcnt vmcnt(11)
    v_mfma_f32_32x32x16_bf16 v[64:79], a[136:139], a[228:231], v[64:79]
    v_lshlrev_b32 v116, 16, v136
    v_and_b32 v117, s65, v136
    v_lshlrev_b32 v118, 16, v137
    v_and_b32 v119, s65, v137
    v_lshlrev_b32 v120, 16, v138
    v_and_b32_e64 v121, s65, v138
    v_mfma_f32_32x32x16_bf16 v[80:95], a[140:143], a[228:231], v[80:95]
    v_lshlrev_b32 v122, 16, v139
    v_and_b32 v123, s65, v139
    s_waitcnt vmcnt(10)
    v_mfma_f32_32x32x16_bf16 v[64:79], a[144:147], a[232:235], v[64:79]
    v_mfma_f32_32x32x16_bf16 v[80:95], a[148:151], a[232:235], v[80:95]
    s_waitcnt vmcnt(9)
    v_mfma_f32_32x32x16_bf16 v[64:79], a[152:155], a[236:239], v[64:79]
    v_mfma_f32_32x32x16_bf16 v[80:95], a[156:159], a[236:239], v[80:95]
    s_waitcnt vmcnt(8)
    v_mfma_f32_32x32x16_bf16 v[64:79], a[160:163], a[240:243], v[64:79]
    v_mfma_f32_32x32x16_bf16 v[80:95], a[164:167], a[240:243], v[80:95]
    s_waitcnt vmcnt(7)
    v_mfma_f32_32x32x16_bf16 v[64:79], a[168:171], a[244:247], v[64:79]
    v_mfma_f32_32x32x16_bf16 v[80:95], a[172:175], a[244:247], v[80:95]
    s_waitcnt vmcnt(6)
    v_mfma_f32_32x32x16_bf16 v[64:79], a[176:179], a[248:251], v[64:79]
    v_mfma_f32_32x32x16_bf16 v[80:95], a[180:183], a[248:251], v[80:95]
    s_waitcnt vmcnt(5)
    v_mfma_f32_32x32x16_bf16 v[64:79], a[184:187], a[252:255], v[64:79]
    v_mfma_f32_32x32x16_bf16 v[80:95], a[188:191], a[252:255], v[80:95]
    s_waitcnt vmcnt(4)
    v_mfma_f32_32x32x16_bf16 v[64:79], a[192:195], v[96:99], v[64:79]
    s_waitcnt vmcnt(3)
    v_mfma_f32_32x32x16_bf16 v[64:79], a[200:203], v[100:103], v[64:79]
    s_waitcnt vmcnt(2)
    v_mfma_f32_32x32x16_bf16 v[64:79], a[208:211], v[104:107], v[64:79]
    s_waitcnt vmcnt(1)
    v_mfma_f32_32x32x16_bf16 v[64:79], a[216:219], a[224:227], v[64:79]
    v_mfma_f32_32x32x16_bf16 v[80:95], a[196:199], v[96:99], v[80:95]
    s_nop 3
    v_mfma_f32_32x32x16_bf16 v[80:95], a[204:207], v[100:103], v[80:95]
    s_nop 3
    v_mfma_f32_32x32x16_bf16 v[80:95], a[212:215], v[104:107], v[80:95]
    s_nop 0
    ds_write_b128 v24, v[64:67] offset:36864
    v_mfma_f32_32x32x16_bf16 v[80:95], a[220:223], a[224:227], v[80:95]
    ds_write_b128 v24, v[68:71] offset:37952
    ds_write_b128 v24, v[72:75] offset:39040
    ds_write_b128 v24, v[76:79] offset:40128
    s_nop 8
    ds_write_b128 v24, v[80:83] offset:41216
    ds_write_b128 v24, v[84:87] offset:42304
    ds_write_b128 v24, v[88:91] offset:43392
    ds_write_b128 v24, v[92:95] offset:44480
    s_waitcnt lgkmcnt(0)
    s_barrier
    ds_read_b128 v[64:67], v25 offset:36864
    ds_read_b128 v[68:71], v25 offset:37376
    ds_read_b128 v[72:75], v25 offset:46080
    ds_read_b128 v[76:79], v25 offset:46592
    ds_read_b128 v[80:83], v25 offset:55296
    ds_read_b128 v[84:87], v25 offset:55808
    ds_read_b128 v[88:91], v25 offset:64512
    ds_read_b128 v[92:95], v25 offset:65024
    s_waitcnt lgkmcnt(5)
    v_pk_add_f32 v[64:65], v[64:65], v[72:73]
    v_pk_add_f32 v[66:67], v[66:67], v[74:75]
    s_waitcnt lgkmcnt(4)
    v_pk_add_f32 v[68:69], v[68:69], v[76:77]
    v_pk_add_f32 v[70:71], v[70:71], v[78:79]
    s_waitcnt lgkmcnt(1)
    v_pk_add_f32 v[80:81], v[80:81], v[88:89]
    v_pk_add_f32 v[82:83], v[82:83], v[90:91]
    s_waitcnt lgkmcnt(0)
    v_pk_add_f32 v[84:85], v[84:85], v[92:93]
    v_pk_add_f32 v[86:87], v[86:87], v[94:95]
    v_pk_add_f32 v[64:65], v[64:65], v[80:81]
    v_pk_add_f32 v[66:67], v[66:67], v[82:83]
    v_pk_add_f32 v[68:69], v[68:69], v[84:85]
    v_pk_add_f32 v[70:71], v[70:71], v[86:87]
    v_pk_fma_f32 v[64:65], v[64:65], v[142:143], v[116:117] op_sel_hi:[1,0,1]
    v_pk_fma_f32 v[66:67], v[66:67], v[142:143], v[118:119] op_sel_hi:[1,0,1]
    v_pk_fma_f32 v[68:69], v[68:69], v[142:143], v[120:121] op_sel_hi:[1,0,1]
    v_pk_fma_f32 v[70:71], v[70:71], v[142:143], v[122:123] op_sel_hi:[1,0,1]
    v_cvt_pk_bf16_f32 v88, v64, v65
    v_cvt_pk_bf16_f32 v89, v66, v67
    v_cvt_pk_bf16_f32 v90, v68, v69
    v_cvt_pk_bf16_f32 v91, v70, v71
    s_mov_b32 s67, 917504
    buffer_store_dwordx4 v[88:91], v26, s[8:11], s67 offen nt
L_end:
    s_endpgm
L_slow_4:
    s_mov_b32 s81, 0
L_poll_5:
    buffer_load_dword v60, v63, s[24:27], 0 offen offset:0 sc1
    s_add_u32 s81, s81, 1
    s_waitcnt vmcnt(0)
    v_cmp_eq_u32_e64 vcc, 0, v60
    s_cmp_gt_u32 s81, 65536
    s_cbranch_scc1 L_ok_6
    s_cbranch_vccnz L_poll_5
    s_branch L_ok_6
L_slow_7:
    s_mov_b32 s81, 0
L_poll_8:
    buffer_load_dword v60, v62, s[24:27], 0 offen offset:128 sc1
    s_add_u32 s81, s81, 1
    s_waitcnt vmcnt(0)
    v_cmp_eq_u32_e64 vcc, 0, v60
    s_cmp_gt_u32 s81, 65536
    s_cbranch_scc1 L_ok_9
    s_cbranch_vccnz L_poll_8
    s_branch L_ok_9
L_slow_10:
    buffer_load_dword v19, v16, s[4:7], s74 offen offset:0 sc1
    s_mov_b32 s81, 0
    s_sleep 3
L_poll_11:
    buffer_load_dword v0, v16, s[4:7], s74 offen offset:0 sc1
    s_add_u32 s81, s81, 1
    s_waitcnt vmcnt(1)
    v_cmp_eq_u32 vcc, 0, v19
    s_cmp_gt_u32 s81, 65536
    s_cbranch_vccz L_ok_12
    buffer_load_dword v19, v16, s[4:7], s74 offen offset:0 sc1
    s_waitcnt vmcnt(1)
    v_cmp_eq_u32 vcc, 0, v0
    s_cbranch_scc1 L_ok_12
    s_cbranch_vccnz L_poll_11
    s_branch L_ok_12
L_slow_13:
    s_mov_b32 s81, 0
L_poll_14:
    buffer_load_dword v60, v61, s[24:27], 0 offen offset:192 sc1
    s_add_u32 s81, s81, 1
    s_waitcnt vmcnt(0)
    v_cmp_eq_u32 vcc, 0, v60
    s_cmp_gt_u32 s81, 65536
    s_cbranch_scc1 L_ok_15
    s_cbranch_vccnz L_poll_14
    s_branch L_ok_15
L_slow_18:
    s_mov_b32 s81, 0
L_poll_19:
    buffer_load_dword v23, v24, s[4:7], 0 offen offset:32 sc1
    s_add_u32 s81, s81, 1
    s_waitcnt vmcnt(0)
    v_cmp_eq_u32_e64 vcc, 0, v23
    s_cmp_gt_u32 s81, 65536
    s_cbranch_scc1 L_ok_20
    s_cbranch_vccnz L_poll_19
    s_branch L_ok_20
L_slow_21:
    s_mov_b32 s81, 0
L_poll_22:
    buffer_load_dword v23, v24, s[4:7], 0 offen offset:0 sc1
    s_add_u32 s81, s81, 1
    s_waitcnt vmcnt(0)
    v_cmp_eq_u32_e64 vcc, 0, v23
    s_cmp_gt_u32 s81, 65536
    s_cbranch_scc1 L_ok_23
    s_cbranch_vccnz L_poll_22
    s_branch L_ok_23
L_slow_26:
    buffer_load_dword v19, v16, s[4:7], s97 offen offset:0 sc1
    s_mov_b32 s81, 0
    s_sleep 3
L_poll_27:
    buffer_load_dword v0, v16, s[4:7], s97 offen offset:0 sc1
    s_add_u32 s81, s81, 1
    s_waitcnt vmcnt(1)
    v_cmp_eq_u32 vcc, 0, v19
    s_cmp_gt_u32 s81, 65536
    s_cbranch_vccz L_ok_28
    buffer_load_dword v19, v16, s[4:7], s97 offen offset:0 sc1
    s_waitcnt vmcnt(1)
    v_cmp_eq_u32 vcc, 0, v0
    s_cbranch_scc1 L_ok_28
    s_cbranch_vccnz L_poll_27
    s_branch L_ok_28
L_st0:
    s_branch L_ret1
L_slow_29:
    s_mov_b32 s81, 0
L_poll_30:
    buffer_load_dword v128, v129, s[4:7], 0 offen offset:0 sc1
    s_add_u32 s81, s81, 1
    s_waitcnt vmcnt(0)
    v_cmp_eq_u32_e64 vcc, 0, v128
    s_cmp_gt_u32 s81, 65536
    s_cbranch_scc1 L_ok_31
    s_cbranch_vccnz L_poll_30
    s_branch L_ok_31
L_slow_32:
    buffer_load_dword v19, v16, s[4:7], s97 offen offset:0 sc1
    s_mov_b32 s81, 0
    s_sleep 3
L_poll_33:
    buffer_load_dword v0, v16, s[4:7], s97 offen offset:0 sc1
    s_add_u32 s81, s81, 1
    s_waitcnt vmcnt(1)
    v_cmp_eq_u32 vcc, 0, v19
    s_cmp_gt_u32 s81, 65536
    s_cbranch_vccz L_ok_34
    buffer_load_dword v19, v16, s[4:7], s97 offen offset:0 sc1
    s_waitcnt vmcnt(1)
    v_cmp_eq_u32 vcc, 0, v0
    s_cbranch_scc1 L_ok_34
    s_cbranch_vccnz L_poll_33
    s_branch L_ok_34
L_slow_35:
    s_mov_b32 s81, 0
L_poll_36q:
    buffer_load_dword v31, v28, s[4:7], s98 offen offset:0 sc1
    s_add_u32 s81, s81, 1
    s_waitcnt vmcnt(0)
    v_cmp_eq_u32 vcc, 0, v31
    s_cmp_lt_u32 s81, 10
    s_cbranch_vccz L_ok_37
    s_cbranch_scc1 L_poll_36q
    s_mov_b64 exec, 1
    buffer_store_dword v17, v29, s[4:7], s80 offen offset:0 sc1
    s_mov_b64 exec, -1
    s_mov_b32 s81, 0
L_poll_36:
    buffer_load_dword v31, v28, s[4:7], s98 offen offset:0 sc1
    s_add_u32 s81, s81, 1
    buffer_load_dword v30, v28, s[4:7], s80 offen offset:0 sc1
    s_waitcnt vmcnt(0)
    v_or_b32 v31, v31, v30
    v_cmp_eq_u32 vcc, 0, v31
    s_cmp_gt_u32 s81, 65536
    s_cbranch_scc1 L_ok_37
    s_cbranch_vccnz L_poll_36
    s_branch L_ok_37
L_st1:
    s_branch L_ret1
L_slow_38:
    s_mov_b32 s81, 0
L_poll_39q:
    buffer_load_dword v31, v28, s[4:7], s98 offen offset:4 sc1
    s_add_u32 s81, s81, 1
    s_waitcnt vmcnt(0)
    v_cmp_eq_u32 vcc, 0, v31
    s_cmp_lt_u32 s81, 10
    s_cbranch_vccz L_ok_40
    s_cbranch_scc1 L_poll_39q
    s_mov_b64 exec, 1
    buffer_store_dword v17, v29, s[4:7], s80 offen offset:4 sc1
    s_mov_b64 exec, -1
    s_mov_b32 s81, 0
L_poll_39:
    buffer_load_dword v31, v28, s[4:7], s98 offen offset:4 sc1
    s_add_u32 s81, s81, 1
    buffer_load_dword v30, v28, s[4:7], s80 offen offset:4 sc1
    s_waitcnt vmcnt(0)
    v_or_b32 v31, v31, v30
    v_cmp_eq_u32 vcc, 0, v31
    s_cmp_gt_u32 s81, 65536
    s_cbranch_scc1 L_ok_40
    s_cbranch_vccnz L_poll_39
    s_branch L_ok_40
L_slow_41:
    buffer_load_dword v19, v16, s[4:7], s97 offen offset:0 sc1
    s_mov_b32 s81, 0
    s_sleep 3
L_poll_42:
    buffer_load_dword v0, v16, s[4:7], s97 offen offset:0 sc1
    s_add_u32 s81, s81, 1
    s_waitcnt vmcnt(1)
    v_cmp_eq_u32 vcc, 0, v19
    s_cmp_gt_u32 s81, 65536
    s_cbranch_vccz L_ok_43
    buffer_load_dword v19, v16, s[4:7], s97 offen offset:0 sc1
    s_waitcnt vmcnt(1)
    v_cmp_eq_u32 vcc, 0, v0
    s_cbranch_scc1 L_ok_43
    s_cbranch_vccnz L_poll_42
    s_branch L_ok_43
L_slow_46:
    buffer_load_dword v19, v16, s[4:7], s97 offen offset:0 sc1
    s_mov_b32 s81, 0
    s_sleep 3
L_poll_47:
    buffer_load_dword v0, v16, s[4:7], s97 offen offset:0 sc1
    s_add_u32 s81, s81, 1
    s_waitcnt vmcnt(1)
    v_cmp_eq_u32_e64 vcc, 0, v19
    s_cmp_gt_u32 s81, 65536
    s_cbranch_vccz L_ok_48
    buffer_load_dword v19, v16, s[4:7], s97 offen offset:0 sc1
    s_waitcnt vmcnt(1)
    v_cmp_eq_u32 vcc, 0, v0
    s_cbranch_scc1 L_ok_48
    s_cbranch_vccnz L_poll_47
    s_branch L_ok_48
L_st2:
    s_branch L_ret2
L_slow_51:
    buffer_load_dword v19, v16, s[4:7], s97 offen offset:0 sc1
    s_mov_b32 s81, 0
    s_sleep 3
L_poll_52:
    buffer_load_dword v0, v16, s[4:7], s97 offen offset:0 sc1
    s_add_u32 s81, s81, 1
    s_waitcnt vmcnt(1)
    v_cmp_eq_u32 vcc, 0, v19
    s_cmp_gt_u32 s81, 65536
    s_cbranch_vccz L_ok_53
    buffer_load_dword v19, v16, s[4:7], s97 offen offset:0 sc1
    s_waitcnt vmcnt(1)
    v_cmp_eq_u32 vcc, 0, v0
    s_cbranch_scc1 L_ok_53
    s_cbranch_vccnz L_poll_52
    s_branch L_ok_53
L_slow_54:
    buffer_load_dword v19, v16, s[4:7], s97 offen offset:0 sc1
    s_mov_b32 s81, 0
    s_sleep 3
L_poll_55:
    buffer_load_dword v0, v16, s[4:7], s97 offen offset:0 sc1
    s_add_u32 s81, s81, 1
    s_waitcnt vmcnt(1)
    v_cmp_eq_u32_e64 vcc, 0, v19
    s_cmp_gt_u32 s81, 65536
    s_cbranch_vccz L_ok_56
    buffer_load_dword v19, v16, s[4:7], s97 offen offset:0 sc1
    s_waitcnt vmcnt(1)
    v_cmp_eq_u32 vcc, 0, v0
    s_cbranch_scc1 L_ok_56
    s_cbranch_vccnz L_poll_55
    s_branch L_ok_56
L_slow_57:
    s_mov_b32 s81, 0
L_poll_58q:
    buffer_load_dword v31, v28, s[4:7], s98 offen offset:0 sc1
    s_add_u32 s81, s81, 1
    s_waitcnt vmcnt(0)
    v_cmp_eq_u32 vcc, 0, v31
    s_cmp_lt_u32 s81, 10
    s_cbranch_vccz L_ok_59
    s_cbranch_scc1 L_poll_58q
    s_mov_b64 exec, 1
    buffer_store_dword v17, v29, s[4:7], s80 offen offset:0 sc1
    s_mov_b64 exec, -1
    s_mov_b32 s81, 0
L_poll_58:
    buffer_load_dword v31, v28, s[4:7], s98 offen offset:0 sc1
    s_add_u32 s81, s81, 1
    buffer_load_dword v30, v28, s[4:7], s80 offen offset:0 sc1
    s_waitcnt vmcnt(0)
    v_or_b32 v31, v31, v30
    v_cmp_eq_u32 vcc, 0, v31
    s_cmp_gt_u32 s81, 65536
    s_cbranch_scc1 L_ok_59
    s_cbranch_vccnz L_poll_58
    s_branch L_ok_59
L_st3:
    s_branch L_ret2
L_slow_60:
    s_mov_b32 s81, 0
L_poll_61q:
    buffer_load_dword v31, v28, s[4:7], s98 offen offset:4 sc1
    s_add_u32 s81, s81, 1
    s_waitcnt vmcnt(0)
    v_cmp_eq_u32 vcc, 0, v31
    s_cmp_lt_u32 s81, 10
    s_cbranch_vccz L_ok_62
    s_cbranch_scc1 L_poll_61q
    s_mov_b64 exec, 1
    buffer_store_dword v17, v29, s[4:7], s80 offen offset:4 sc1
    s_mov_b64 exec, -1
    s_mov_b32 s81, 0
L_poll_61:
    buffer_load_dword v31, v28, s[4:7], s98 offen offset:4 sc1
    s_add_u32 s81, s81, 1
    buffer_load_dword v30, v28, s[4:7], s80 offen offset:4 sc1
    s_waitcnt vmcnt(0)
    v_or_b32 v31, v31, v30
    v_cmp_eq_u32 vcc, 0, v31
    s_cmp_gt_u32 s81, 65536
    s_cbranch_scc1 L_ok_62
    s_cbranch_vccnz L_poll_61
    s_branch L_ok_62
    s_nop 0
L_helper:
    s_mov_b32 s12, s48
    s_and_b32 s13, s49, 0xffff
    s_mov_b32 s14, 0x188000
    s_mov_b32 s15, 0x20000
    s_mov_b32 s16, s50
    s_and_b32 s17, s51, 0xffff
    s_mov_b32 s18, 0x188000
    s_mov_b32 s19, 0x20000
    v_lshrrev_b32_e64 v104, 3, v1
    v_mul_u32_u24 v106, 3584, v104
    v_and_b32_e64 v104, 7, v1
    v_bfe_u32 v105, v1, 4, 1
    v_lshlrev_b32 v105, 2, v105
    v_xor_b32 v104, v104, v105
    v_lshl_add_u32 v106, v104, 4, v106
    v_lshrrev_b32_e64 v104, 3, v1
    v_mul_u32_u24 v107, 896, v104
    v_and_b32_e64 v104, 7, v1
    v_bfe_u32 v105, v1, 4, 1
    v_lshlrev_b32 v105, 2, v105
    v_xor_b32 v104, v104, v105
    v_lshl_add_u32 v107, v104, 4, v107
    s_mov_b32 s8, s40
    s_and_b32 s9, s41, 0xffff
    s_mov_b32 s10, 0x38000
    s_mov_b32 s11, 0x20000
    s_lshl_b32 s66, s2, 13
    v_lshlrev_b32_e64 v104, 5, v0
    buffer_load_dword v105, v104, s[8:11], s66 offen
    s_waitcnt vmcnt(0)
    s_mul_i32 s66, s3, 401408
    s_lshl_b32 s67, s2, 7
    s_add_u32 s66, s66, s67
    s_mul_i32 s69, s3, 14336
    s_mov_b32 m0, s69
    s_nop 0
    s_nop 0
    buffer_load_dwordx4 v106, s[12:15], s66 offen lds
    s_add_u32 m0, m0, 1024
    s_add_u32 s66, s66, 28672
    buffer_load_dwordx4 v106, s[12:15], s66 offen lds
    s_add_u32 m0, m0, 1024
    s_add_u32 s66, s66, 28672
    buffer_load_dwordx4 v106, s[12:15], s66 offen lds
    s_add_u32 m0, m0, 1024
    s_add_u32 s66, s66, 28672
    buffer_load_dwordx4 v106, s[12:15], s66 offen lds
    s_add_u32 m0, m0, 1024
    s_add_u32 s66, s66, 28672
    buffer_load_dwordx4 v106, s[12:15], s66 offen lds
    s_add_u32 m0, m0, 1024
    s_add_u32 s66, s66, 28672
    buffer_load_dwordx4 v106, s[12:15], s66 offen lds
    s_add_u32 m0, m0, 1024
    s_add_u32 s66, s66, 28672
    buffer_load_dwordx4 v106, s[12:15], s66 offen lds
    s_add_u32 m0, m0, 1024
    s_add_u32 s66, s66, 28672
    buffer_load_dwordx4 v106, s[12:15], s66 offen lds
    s_add_u32 m0, m0, 1024
    s_add_u32 s66, s66, 28672
    buffer_load_dwordx4 v106, s[12:15], s66 offen lds
    s_add_u32 m0, m0, 1024
    s_add_u32 s66, s66, 28672
    buffer_load_dwordx4 v106, s[12:15], s66 offen lds
    s_add_u32 m0, m0, 1024
    s_add_u32 s66, s66, 28672
    buffer_load_dwordx4 v106, s[12:15], s66 offen lds
    s_add_u32 m0, m0, 1024
    s_add_u32 s66, s66, 28672
    buffer_load_dwordx4 v106, s[12:15], s66 offen lds
    s_add_u32 m0, m0, 1024
    s_add_u32 s66, s66, 28672
    buffer_load_dwordx4 v106, s[12:15], s66 offen lds
    s_add_u32 m0, m0, 1024
    s_add_u32 s66, s66, 28672
    buffer_load_dwordx4 v106, s[12:15], s66 offen lds
    s_add_u32 m0, m0, 1024
    s_add_u32 s66, s66, 28672
    v_bfe_u32 v105, v1, 2, 2
    v_lshlrev_b32_e64 v104, 7, v105
    v_bfe_u32 v105, v1, 3, 1
    v_lshl_add_u32 v104, v105, 6, v104
    v_bfe_u32 v105, v1, 4, 1
    v_lshl_add_u32 v104, v105, 5, v104
    v_and_b32_e64 v105, 3, v1
    v_lshl_add_u32 v104, v105, 3, v104
    v_lshrrev_b32_e64 v105, 5, v1
    v_lshl_add_u32 v106, v105, 10, v104
    v_lshl_add_u32 v108, v105, 9, v104
    s_lshl_b32 s66, s94, 6
    v_xor_b32 v106, s66, v106
    s_mul_i32 s66, s93, 2048
    v_add_u32 v106, s66, v106
    s_lshl_b32 s66, s93, 6
    v_xor_b32 v108, s66, v108
    v_xor_b32 v109, 64, v108
    s_mul_i32 s67, s3, 7
    s_lshr_b32 s66, s67, 1
    s_lshl_b32 s66, s66, 11
    s_add_u32 s66, s66, 57344
    v_add_u32 v108, s66, v108
    s_add_u32 s66, s67, 1
    s_lshr_b32 s66, s66, 1
    s_lshl_b32 s66, s66, 11
    s_add_u32 s66, s66, 57344
    v_add_u32 v109, s66, v109
    s_waitcnt vmcnt(0)
    s_barrier
    ds_read_b64_tr_b16 v[144:145], v106 offset:0
    ds_read_b64_tr_b16 v[146:147], v106 offset:512
    ds_read_b64_tr_b16 v[148:149], v106 offset:4096
    ds_read_b64_tr_b16 v[150:151], v106 offset:4608
    ds_read_b64_tr_b16 v[152:153], v106 offset:8192
    ds_read_b64_tr_b16 v[154:155], v106 offset:8704
    ds_read_b64_tr_b16 v[156:157], v106 offset:12288
    ds_read_b64_tr_b16 v[158:159], v106 offset:12800
    ds_read_b64_tr_b16 v[160:161], v106 offset:16384
    ds_read_b64_tr_b16 v[162:163], v106 offset:16896
    ds_read_b64_tr_b16 v[164:165], v106 offset:20480
    ds_read_b64_tr_b16 v[166:167], v106 offset:20992
    ds_read_b64_tr_b16 v[168:169], v106 offset:24576
    ds_read_b64_tr_b16 v[170:171], v106 offset:25088
    ds_read_b64_tr_b16 v[172:173], v106 offset:28672
    ds_read_b64_tr_b16 v[174:175], v106 offset:29184
    ds_read_b64_tr_b16 v[176:177], v106 offset:32768
    ds_read_b64_tr_b16 v[178:179], v106 offset:33280
    ds_read_b64_tr_b16 v[180:181], v106 offset:36864
    ds_read_b64_tr_b16 v[182:183], v106 offset:37376
    ds_read_b64_tr_b16 v[184:185], v106 offset:40960
    ds_read_b64_tr_b16 v[186:187], v106 offset:41472
    ds_read_b64_tr_b16 v[188:189], v106 offset:45056
    ds_read_b64_tr_b16 v[190:191], v106 offset:45568
    ds_read_b64_tr_b16 v[192:193], v106 offset:49152
    ds_read_b64_tr_b16 v[194:195], v106 offset:49664
    ds_read_b64_tr_b16 v[196:197], v106 offset:53248
    ds_read_b64_tr_b16 v[198:199], v106 offset:53760
    s_and_b32 s78, s2, 3
    s_lshl3_add_u32 s78, s78, s3
    s_add_u32 s78, s78, 4
    s_mul_i32 s78, s78, 50176
    s_lshr_b32 s79, s2, 2
    s_lshl_b32 s79, s79, 7
    s_add_u32 s78, s78, s79
    s_mul_i32 s69, s3, 7168
    s_add_u32 m0, s69, 57344
    s_nop 0
    s_nop 0
    buffer_load_dwordx4 v107, s[16:19], s78 offen lds
    s_add_u32 m0, m0, 1024
    s_add_u32 s78, s78, 7168
    buffer_load_dwordx4 v107, s[16:19], s78 offen lds
    s_add_u32 m0, m0, 1024
    s_add_u32 s78, s78, 7168
    buffer_load_dwordx4 v107, s[16:19], s78 offen lds
    s_add_u32 m0, m0, 1024
    s_add_u32 s78, s78, 7168
    buffer_load_dwordx4 v107, s[16:19], s78 offen lds
    s_add_u32 m0, m0, 1024
    s_add_u32 s78, s78, 7168
    buffer_load_dwordx4 v107, s[16:19], s78 offen lds
    s_add_u32 m0, m0, 1024
    s_add_u32 s78, s78, 7168
    buffer_load_dwordx4 v107, s[16:19], s78 offen lds
    s_add_u32 m0, m0, 1024
    s_add_u32 s78, s78, 7168
    buffer_load_dwordx4 v107, s[16:19], s78 offen lds
    s_add_u32 m0, m0, 1024
    s_add_u32 s78, s78, 7168
    s_waitcnt lgkmcnt(14)
    v_dot2c_f32_bf16 v96, s64, v144
    v_dot2c_f32_bf16 v96, s64, v145
    v_dot2c_f32_bf16 v96, s64, v146
    v_dot2c_f32_bf16 v96, s64, v147
    v_dot2c_f32_bf16 v96, s64, v148
    v_dot2c_f32_bf16 v96, s64, v149
    v_dot2c_f32_bf16 v96, s64, v150
    v_dot2c_f32_bf16 v96, s64, v151
    v_dot2c_f32_bf16 v96, s64, v152
    v_dot2c_f32_bf16 v96, s64, v153
    v_dot2c_f32_bf16 v96, s64, v154
    v_dot2c_f32_bf16 v96, s64, v155
    v_dot2c_f32_bf16 v96, s64, v156
    v_dot2c_f32_bf16 v96, s64, v157
    v_dot2c_f32_bf16 v96, s64, v158
    v_dot2c_f32_bf16 v96, s64, v159
    v_dot2c_f32_bf16 v96, s64, v160
    v_dot2c_f32_bf16 v96, s64, v161
    v_dot2c_f32_bf16 v96, s64, v162
    v_dot2c_f32_bf16 v96, s64, v163
    v_dot2c_f32_bf16 v96, s64, v164
    v_dot2c_f32_bf16 v96, s64, v165
    v_dot2c_f32_bf16 v96, s64, v166
    v_dot2c_f32_bf16 v96, s64, v167
    v_dot2c_f32_bf16 v96, s64, v168
    v_dot2c_f32_bf16 v96, s64, v169
    v_dot2c_f32_bf16 v96, s64, v170
    v_dot2c_f32_bf16 v96, s64, v171
    s_waitcnt lgkmcnt(13)
    v_dot2c_f32_bf16 v96, s64, v172
    v_dot2c_f32_bf16 v96, s64, v173
    s_waitcnt lgkmcnt(12)
    v_dot2c_f32_bf16 v96, s64, v174
    v_dot2c_f32_bf16 v96, s64, v175
    s_waitcnt lgkmcnt(11)
    v_dot2c_f32_bf16 v96, s64, v176
    v_dot2c_f32_bf16 v96, s64, v177
    s_waitcnt lgkmcnt(10)
    v_dot2c_f32_bf16 v96, s64, v178
    v_dot2c_f32_bf16 v96, s64, v179
    s_waitcnt lgkmcnt(9)
    v_dot2c_f32_bf16 v96, s64, v180
    v_dot2c_f32_bf16 v96, s64, v181
    s_waitcnt lgkmcnt(8)
    v_dot2c_f32_bf16 v96, s64, v182
    v_dot2c_f32_bf16 v96, s64, v183
    s_waitcnt lgkmcnt(7)
    v_dot2c_f32_bf16 v96, s64, v184
    v_dot2c_f32_bf16 v96, s64, v185
    s_waitcnt lgkmcnt(6)
    v_dot2c_f32_bf16 v96, s64, v186
    v_dot2c_f32_bf16 v96, s64, v187
    s_waitcnt lgkmcnt(5)
    v_dot2c_f32_bf16 v96, s64, v188
    v_dot2c_f32_bf16 v96, s64, v189
    s_waitcnt lgkmcnt(4)
    v_dot2c_f32_bf16 v96, s64, v190
    v_dot2c_f32_bf16 v96, s64, v191
    s_waitcnt lgkmcnt(3)
    v_dot2c_f32_bf16 v96, s64, v192
    v_dot2c_f32_bf16 v96, s64, v193
    s_waitcnt lgkmcnt(2)
    v_dot2c_f32_bf16 v96, s64, v194
    v_dot2c_f32_bf16 v96, s64, v195
    s_waitcnt lgkmcnt(1)
    v_dot2c_f32_bf16 v96, s64, v196
    v_dot2c_f32_bf16 v96, s64, v197
    s_waitcnt lgkmcnt(0)
    v_dot2c_f32_bf16 v96, s64, v198
    v_dot2c_f32_bf16 v96, s64, v199
    s_nop 2
    v_mov_b32 v98, v96
    s_nop 1
    v_permlane32_swap_b32 v96, v98
    v_add_f32 v96, v96, v98
    v_lshlrev_b32_e64 v104, 2, v0
    v_add_u32 v104, 0x18000, v104
    ds_write_b32 v104, v96
    v_xor_b32 v104, 256, v104
    s_waitcnt lgkmcnt(0)
    s_barrier
    ds_read_b32 v98, v104
    s_lshl2_add_u32 s67, s2, s3
    s_mul_i32 s66, s67, 14336
    s_add_u32 s66, s66, 0x1560000
    s_mul_i32 s68, s93, 13312
    s_sub_u32 s66, s66, s68
    buffer_load_dword v60, v61, s[24:27], 0 offen offset:192 sc1
    s_mul_i32 s67, s67, 7168
    s_add_u32 s67, s67, 0x1740000
    s_waitcnt lgkmcnt(0)
    v_add_f32 v96, v96, v98
    v_mul_f32 v96, 0xbb124925, v96
    v_mov_b32 v112, v96
    v_mov_b32 v113, v96
    v_lshlrev_b32 v100, 16, v144
    v_and_b32 v101, s65, v144
    v_pk_add_f32 v[100:101], v[100:101], v[112:113]
    v_cvt_pk_bf16_f32 v144, v100, v101
    v_pk_add_f32 v[112:113], v[100:101], v[96:97] op_sel_hi:[1,0]
    v_lshlrev_b32 v102, 16, v144
    v_and_b32 v103, s65, v144
    v_pk_add_f32 v[112:113], v[112:113], v[102:103] neg_lo:[0,1] neg_hi:[0,1]
    v_lshlrev_b32 v100, 16, v145
    v_and_b32 v101, s65, v145
    v_pk_add_f32 v[100:101], v[100:101], v[112:113]
    v_cvt_pk_bf16_f32 v145, v100, v101
    v_pk_add_f32 v[112:113], v[100:101], v[96:97] op_sel_hi:[1,0]
    v_lshlrev_b32 v102, 16, v145
    v_and_b32 v103, s65, v145
    v_pk_add_f32 v[112:113], v[112:113], v[102:103] neg_lo:[0,1] neg_hi:[0,1]
    v_lshlrev_b32 v100, 16, v146
    v_and_b32 v101, s65, v146
    v_pk_add_f32 v[100:101], v[100:101], v[112:113]
    v_cvt_pk_bf16_f32 v146, v100, v101
    v_pk_add_f32 v[112:113], v[100:101], v[96:97] op_sel_hi:[1,0]
    v_lshlrev_b32 v102, 16, v146
    v_and_b32 v103, s65, v146
    v_pk_add_f32 v[112:113], v[112:113], v[102:103] neg_lo:[0,1] neg_hi:[0,1]
    v_lshlrev_b32 v100, 16, v147
    v_and_b32 v101, s65, v147
    v_pk_add_f32 v[100:101], v[100:101], v[112:113]
    v_cvt_pk_bf16_f32 v147, v100, v101
    v_pk_add_f32 v[112:113], v[100:101], v[96:97] op_sel_hi:[1,0]
    v_lshlrev_b32 v102, 16, v147
    v_and_b32 v103, s65, v147
    v_pk_add_f32 v[112:113], v[112:113], v[102:103] neg_lo:[0,1] neg_hi:[0,1]
    buffer_store_dwordx4 v[144:147], v2, s[4:7], s66 offen offset:0 sc1
    v_lshlrev_b32 v100, 16, v148
    v_and_b32 v101, s65, v148
    v_pk_add_f32 v[100:101], v[100:101], v[112:113]
    v_cvt_pk_bf16_f32 v148, v100, v101
    v_pk_add_f32 v[112:113], v[100:101], v[96:97] op_sel_hi:[1,0]
    v_lshlrev_b32 v102, 16, v148
    v_and_b32 v103, s65, v148
    v_pk_add_f32 v[112:113], v[112:113], v[102:103] neg_lo:[0,1] neg_hi:[0,1]
    v_lshlrev_b32 v100, 16, v149
    v_and_b32 v101, s65, v149
    v_pk_add_f32 v[100:101], v[100:101], v[112:113]
    v_cvt_pk_bf16_f32 v149, v100, v101
    v_pk_add_f32 v[112:113], v[100:101], v[96:97] op_sel_hi:[1,0]
    v_lshlrev_b32 v102, 16, v149
    v_and_b32 v103, s65, v149
    v_pk_add_f32 v[112:113], v[112:113], v[102:103] neg_lo:[0,1] neg_hi:[0,1]
    v_lshlrev_b32 v100, 16, v150
    v_and_b32 v101, s65, v150
    v_pk_add_f32 v[100:101], v[100:101], v[112:113]
    v_cvt_pk_bf16_f32 v150, v100, v101
    v_pk_add_f32 v[112:113], v[100:101], v[96:97] op_sel_hi:[1,0]
    v_lshlrev_b32 v102, 16, v150
    v_and_b32 v103, s65, v150
    v_pk_add_f32 v[112:113], v[112:113], v[102:103] neg_lo:[0,1] neg_hi:[0,1]
    v_lshlrev_b32 v100, 16, v151
    v_and_b32 v101, s65, v151
    v_pk_add_f32 v[100:101], v[100:101], v[112:113]
    v_cvt_pk_bf16_f32 v151, v100, v101
    v_pk_add_f32 v[112:113], v[100:101], v[96:97] op_sel_hi:[1,0]
    v_lshlrev_b32 v102, 16, v151
    v_and_b32 v103, s65, v151
    v_pk_add_f32 v[112:113], v[112:113], v[102:103] neg_lo:[0,1] neg_hi:[0,1]
    buffer_store_dwordx4 v[148:151], v2, s[4:7], s66 offen offset:2048 sc1
    s_add_u32 s66, s66, 4096
    v_lshlrev_b32 v100, 16, v152
    v_and_b32 v101, s65, v152
    v_pk_add_f32 v[100:101], v[100:101], v[112:113]
    v_cvt_pk_bf16_f32 v152, v100, v101
    v_pk_add_f32 v[112:113], v[100:101], v[96:97] op_sel_hi:[1,0]
    v_lshlrev_b32 v102, 16, v152
    v_and_b32 v103, s65, v152
    v_pk_add_f32 v[112:113], v[112:113], v[102:103] neg_lo:[0,1] neg_hi:[0,1]
    v_lshlrev_b32 v100, 16, v153
    v_and_b32 v101, s65, v153
    v_pk_add_f32 v[100:101], v[100:101], v[112:113]
    v_cvt_pk_bf16_f32 v153, v100, v101
    v_pk_add_f32 v[112:113], v[100:101], v[96:97] op_sel_hi:[1,0]
    v_lshlrev_b32 v102, 16, v153
    v_and_b32 v103, s65, v153
    v_pk_add_f32 v[112:113], v[112:113], v[102:103] neg_lo:[0,1] neg_hi:[0,1]
    v_lshlrev_b32 v100, 16, v154
    v_and_b32 v101, s65, v154
    v_pk_add_f32 v[100:101], v[100:101], v[112:113]
    v_cvt_pk_bf16_f32 v154, v100, v101
    v_pk_add_f32 v[112:113], v[100:101], v[96:97] op_sel_hi:[1,0]
    v_lshlrev_b32 v102, 16, v154
    v_and_b32 v103, s65, v154
    v_pk_add_f32 v[112:113], v[112:113], v[102:103] neg_lo:[0,1] neg_hi:[0,1]
    v_lshlrev_b32 v100, 16, v155
    v_and_b32 v101, s65, v155
    v_pk_add_f32 v[100:101], v[100:101], v[112:113]
    v_cvt_pk_bf16_f32 v155, v100, v101
    v_pk_add_f32 v[112:113], v[100:101], v[96:97] op_sel_hi:[1,0]
    v_lshlrev_b32 v102, 16, v155
    v_and_b32 v103, s65, v155
    v_pk_add_f32 v[112:113], v[112:113], v[102:103] neg_lo:[0,1] neg_hi:[0,1]
    buffer_store_dwordx4 v[152:155], v2, s[4:7], s66 offen offset:0 sc1
    v_lshlrev_b32 v100, 16, v156
    v_and_b32 v101, s65, v156
    v_pk_add_f32 v[100:101], v[100:101], v[112:113]
    v_cvt_pk_bf16_f32 v156, v100, v101
    v_pk_add_f32 v[112:113], v[100:101], v[96:97] op_sel_hi:[1,0]
    v_lshlrev_b32 v102, 16, v156
    v_and_b32 v103, s65, v156
    v_pk_add_f32 v[112:113], v[112:113], v[102:103] neg_lo:[0,1] neg_hi:[0,1]
    v_lshlrev_b32 v100, 16, v157
    v_and_b32 v101, s65, v157
    v_pk_add_f32 v[100:101], v[100:101], v[112:113]
    v_cvt_pk_bf16_f32 v157, v100, v101
    v_pk_add_f32 v[112:113], v[100:101], v[96:97] op_sel_hi:[1,0]
    v_lshlrev_b32 v102, 16, v157
    v_and_b32 v103, s65, v157
    v_pk_add_f32 v[112:113], v[112:113], v[102:103] neg_lo:[0,1] neg_hi:[0,1]
    v_lshlrev_b32 v100, 16, v158
    v_and_b32 v101, s65, v158
    v_pk_add_f32 v[100:101], v[100:101], v[112:113]
    v_cvt_pk_bf16_f32 v158, v100, v101
    v_pk_add_f32 v[112:113], v[100:101], v[96:97] op_sel_hi:[1,0]
    v_lshlrev_b32 v102, 16, v158
    v_and_b32 v103, s65, v158
    v_pk_add_f32 v[112:113], v[112:113], v[102:103] neg_lo:[0,1] neg_hi:[0,1]
    v_lshlrev_b32 v100, 16, v159
    v_and_b32 v101, s65, v159
    v_pk_add_f32 v[100:101], v[100:101], v[112:113]
    v_cvt_pk_bf16_f32 v159, v100, v101
    v_pk_add_f32 v[112:113], v[100:101], v[96:97] op_sel_hi:[1,0]
    v_lshlrev_b32 v102, 16, v159
    v_and_b32 v103, s65, v159
    v_pk_add_f32 v[112:113], v[112:113], v[102:103] neg_lo:[0,1] neg_hi:[0,1]
    buffer_store_dwordx4 v[156:159], v2, s[4:7], s66 offen offset:2048 sc1
    s_add_u32 s66, s66, 4096
    v_lshlrev_b32 v100, 16, v160
    v_and_b32 v101, s65, v160
    v_pk_add_f32 v[100:101], v[100:101], v[112:113]
    v_cvt_pk_bf16_f32 v160, v100, v101
    v_pk_add_f32 v[112:113], v[100:101], v[96:97] op_sel_hi:[1,0]
    v_lshlrev_b32 v102, 16, v160
    v_and_b32 v103, s65, v160
    v_pk_add_f32 v[112:113], v[112:113], v[102:103] neg_lo:[0,1] neg_hi:[0,1]
    v_lshlrev_b32 v100, 16, v161
    v_and_b32 v101, s65, v161
    v_pk_add_f32 v[100:101], v[100:101], v[112:113]
    v_cvt_pk_bf16_f32 v161, v100, v101
    v_pk_add_f32 v[112:113], v[100:101], v[96:97] op_sel_hi:[1,0]
    v_lshlrev_b32 v102, 16, v161
    v_and_b32 v103, s65, v161
    v_pk_add_f32 v[112:113], v[112:113], v[102:103] neg_lo:[0,1] neg_hi:[0,1]
    v_lshlrev_b32 v100, 16, v162
    v_and_b32 v101, s65, v162
    v_pk_add_f32 v[100:101], v[100:101], v[112:113]
    v_cvt_pk_bf16_f32 v162, v100, v101
    v_pk_add_f32 v[112:113], v[100:101], v[96:97] op_sel_hi:[1,0]
    v_lshlrev_b32 v102, 16, v162
    v_and_b32 v103, s65, v162
    v_pk_add_f32 v[112:113], v[112:113], v[102:103] neg_lo:[0,1] neg_hi:[0,1]
    v_lshlrev_b32 v100, 16, v163
    v_and_b32 v101, s65, v163
    v_pk_add_f32 v[100:101], v[100:101], v[112:113]
    v_cvt_pk_bf16_f32 v163, v100, v101
    v_pk_add_f32 v[112:113], v[100:101], v[96:97] op_sel_hi:[1,0]
    v_lshlrev_b32 v102, 16, v163
    v_and_b32 v103, s65, v163
    v_pk_add_f32 v[112:113], v[112:113], v[102:103] neg_lo:[0,1] neg_hi:[0,1]
    buffer_store_dwordx4 v[160:163], v2, s[4:7], s66 offen offset:0 sc1
    v_lshlrev_b32 v100, 16, v164
    v_and_b32 v101, s65, v164
    v_pk_add_f32 v[100:101], v[100:101], v[112:113]
    v_cvt_pk_bf16_f32 v164, v100, v101
    v_pk_add_f32 v[112:113], v[100:101], v[96:97] op_sel_hi:[1,0]
    v_lshlrev_b32 v102, 16, v164
    v_and_b32 v103, s65, v164
    v_pk_add_f32 v[112:113], v[112:113], v[102:103] neg_lo:[0,1] neg_hi:[0,1]
    v_lshlrev_b32 v100, 16, v165
    v_and_b32 v101, s65, v165
    v_pk_add_f32 v[100:101], v[100:101], v[112:113]
    v_cvt_pk_bf16_f32 v165, v100, v101
    v_pk_add_f32 v[112:113], v[100:101], v[96:97] op_sel_hi:[1,0]
    v_lshlrev_b32 v102, 16, v165
    v_and_b32 v103, s65, v165
    v_pk_add_f32 v[112:113], v[112:113], v[102:103] neg_lo:[0,1] neg_hi:[0,1]
    v_lshlrev_b32 v100, 16, v166
    v_and_b32 v101, s65, v166
    v_pk_add_f32 v[100:101], v[100:101], v[112:113]
    v_cvt_pk_bf16_f32 v166, v100, v101
    v_pk_add_f32 v[112:113], v[100:101], v[96:97] op_sel_hi:[1,0]
    v_lshlrev_b32 v102, 16, v166
    v_and_b32 v103, s65, v166
    v_pk_add_f32 v[112:113], v[112:113], v[102:103] neg_lo:[0,1] neg_hi:[0,1]
    v_lshlrev_b32 v100, 16, v167
    v_and_b32 v101, s65, v167
    v_pk_add_f32 v[100:101], v[100:101], v[112:113]
    v_cvt_pk_bf16_f32 v167, v100, v101
    v_pk_add_f32 v[112:113], v[100:101], v[96:97] op_sel_hi:[1,0]
    v_lshlrev_b32 v102, 16, v167
    v_and_b32 v103, s65, v167
    v_pk_add_f32 v[112:113], v[112:113], v[102:103] neg_lo:[0,1] neg_hi:[0,1]
    buffer_store_dwordx4 v[164:167], v2, s[4:7], s66 offen offset:2048 sc1
    s_add_u32 s66, s66, 4096
    v_lshlrev_b32 v100, 16, v168
    v_and_b32 v101, s65, v168
    v_pk_add_f32 v[100:101], v[100:101], v[112:113]
    v_cvt_pk_bf16_f32 v168, v100, v101
    v_pk_add_f32 v[112:113], v[100:101], v[96:97] op_sel_hi:[1,0]
    v_lshlrev_b32 v102, 16, v168
    v_and_b32 v103, s65, v168
    v_pk_add_f32 v[112:113], v[112:113], v[102:103] neg_lo:[0,1] neg_hi:[0,1]
    v_lshlrev_b32 v100, 16, v169
    v_and_b32 v101, s65, v169
    v_pk_add_f32 v[100:101], v[100:101], v[112:113]
    v_cvt_pk_bf16_f32 v169, v100, v101
    v_pk_add_f32 v[112:113], v[100:101], v[96:97] op_sel_hi:[1,0]
    v_lshlrev_b32 v102, 16, v169
    v_and_b32 v103, s65, v169
    v_pk_add_f32 v[112:113], v[112:113], v[102:103] neg_lo:[0,1] neg_hi:[0,1]
    v_lshlrev_b32 v100, 16, v170
    v_and_b32 v101, s65, v170
    v_pk_add_f32 v[100:101], v[100:101], v[112:113]
    v_cvt_pk_bf16_f32 v170, v100, v101
    v_pk_add_f32 v[112:113], v[100:101], v[96:97] op_sel_hi:[1,0]
    v_lshlrev_b32 v102, 16, v170
    v_and_b32 v103, s65, v170
    v_pk_add_f32 v[112:113], v[112:113], v[102:103] neg_lo:[0,1] neg_hi:[0,1]
    v_lshlrev_b32 v100, 16, v171
    v_and_b32 v101, s65, v171
    v_pk_add_f32 v[100:101], v[100:101], v[112:113]
    v_cvt_pk_bf16_f32 v171, v100, v101
    v_pk_add_f32 v[112:113], v[100:101], v[96:97] op_sel_hi:[1,0]
    v_lshlrev_b32 v102, 16, v171
    v_and_b32 v103, s65, v171
    v_pk_add_f32 v[112:113], v[112:113], v[102:103] neg_lo:[0,1] neg_hi:[0,1]
    buffer_store_dwordx4 v[168:171], v2, s[4:7], s66 offen offset:0 sc1
    v_lshlrev_b32 v100, 16, v172
    v_and_b32 v101, s65, v172
    v_pk_add_f32 v[100:101], v[100:101], v[112:113]
    v_cvt_pk_bf16_f32 v172, v100, v101
    v_pk_add_f32 v[112:113], v[100:101], v[96:97] op_sel_hi:[1,0]
    v_lshlrev_b32 v102, 16, v172
    v_and_b32 v103, s65, v172
    v_pk_add_f32 v[112:113], v[112:113], v[102:103] neg_lo:[0,1] neg_hi:[0,1]
    v_lshlrev_b32 v100, 16, v173
    v_and_b32 v101, s65, v173
    v_pk_add_f32 v[100:101], v[100:101], v[112:113]
    v_cvt_pk_bf16_f32 v173, v100, v101
    v_pk_add_f32 v[112:113], v[100:101], v[96:97] op_sel_hi:[1,0]
    v_lshlrev_b32 v102, 16, v173
    v_and_b32 v103, s65, v173
    v_pk_add_f32 v[112:113], v[112:113], v[102:103] neg_lo:[0,1] neg_hi:[0,1]
    v_lshlrev_b32 v100, 16, v174
    v_and_b32 v101, s65, v174
    v_pk_add_f32 v[100:101], v[100:101], v[112:113]
    v_cvt_pk_bf16_f32 v174, v100, v101
    v_pk_add_f32 v[112:113], v[100:101], v[96:97] op_sel_hi:[1,0]
    v_lshlrev_b32 v102, 16, v174
    v_and_b32 v103, s65, v174
    v_pk_add_f32 v[112:113], v[112:113], v[102:103] neg_lo:[0,1] neg_hi:[0,1]
    v_lshlrev_b32 v100, 16, v175
    v_and_b32 v101, s65, v175
    v_pk_add_f32 v[100:101], v[100:101], v[112:113]
    v_cvt_pk_bf16_f32 v175, v100, v101
    v_pk_add_f32 v[112:113], v[100:101], v[96:97] op_sel_hi:[1,0]
    v_lshlrev_b32 v102, 16, v175
    v_and_b32 v103, s65, v175
    v_pk_add_f32 v[112:113], v[112:113], v[102:103] neg_lo:[0,1] neg_hi:[0,1]
    buffer_store_dwordx4 v[172:175], v2, s[4:7], s66 offen offset:2048 sc1
    s_add_u32 s66, s66, 4096
    v_lshlrev_b32 v100, 16, v176
    v_and_b32 v101, s65, v176
    v_pk_add_f32 v[100:101], v[100:101], v[112:113]
    v_cvt_pk_bf16_f32 v176, v100, v101
    v_pk_add_f32 v[112:113], v[100:101], v[96:97] op_sel_hi:[1,0]
    v_lshlrev_b32 v102, 16, v176
    v_and_b32 v103, s65, v176
    v_pk_add_f32 v[112:113], v[112:113], v[102:103] neg_lo:[0,1] neg_hi:[0,1]
    v_lshlrev_b32 v100, 16, v177
    v_and_b32 v101, s65, v177
    v_pk_add_f32 v[100:101], v[100:101], v[112:113]
    v_cvt_pk_bf16_f32 v177, v100, v101
    v_pk_add_f32 v[112:113], v[100:101], v[96:97] op_sel_hi:[1,0]
    v_lshlrev_b32 v102, 16, v177
    v_and_b32 v103, s65, v177
    v_pk_add_f32 v[112:113], v[112:113], v[102:103] neg_lo:[0,1] neg_hi:[0,1]
    v_lshlrev_b32 v100, 16, v178
    v_and_b32 v101, s65, v178
    v_pk_add_f32 v[100:101], v[100:101], v[112:113]
    v_cvt_pk_bf16_f32 v178, v100, v101
    v_pk_add_f32 v[112:113], v[100:101], v[96:97] op_sel_hi:[1,0]
    v_lshlrev_b32 v102, 16, v178
    v_and_b32 v103, s65, v178
    v_pk_add_f32 v[112:113], v[112:113], v[102:103] neg_lo:[0,1] neg_hi:[0,1]
    v_lshlrev_b32 v100, 16, v179
    v_and_b32 v101, s65, v179
    v_pk_add_f32 v[100:101], v[100:101], v[112:113]
    v_cvt_pk_bf16_f32 v179, v100, v101
    v_pk_add_f32 v[112:113], v[100:101], v[96:97] op_sel_hi:[1,0]
    v_lshlrev_b32 v102, 16, v179
    v_and_b32 v103, s65, v179
    v_pk_add_f32 v[112:113], v[112:113], v[102:103] neg_lo:[0,1] neg_hi:[0,1]
    buffer_store_dwordx4 v[176:179], v2, s[4:7], s66 offen offset:0 sc1
    v_lshlrev_b32 v100, 16, v180
    v_and_b32 v101, s65, v180
    v_pk_add_f32 v[100:101], v[100:101], v[112:113]
    v_cvt_pk_bf16_f32 v180, v100, v101
    v_pk_add_f32 v[112:113], v[100:101], v[96:97] op_sel_hi:[1,0]
    v_lshlrev_b32 v102, 16, v180
    v_and_b32 v103, s65, v180
    v_pk_add_f32 v[112:113], v[112:113], v[102:103] neg_lo:[0,1] neg_hi:[0,1]
    v_lshlrev_b32 v100, 16, v181
    v_and_b32 v101, s65, v181
    v_pk_add_f32 v[100:101], v[100:101], v[112:113]
    v_cvt_pk_bf16_f32 v181, v100, v101
    v_pk_add_f32 v[112:113], v[100:101], v[96:97] op_sel_hi:[1,0]
    v_lshlrev_b32 v102, 16, v181
    v_and_b32 v103, s65, v181
    v_pk_add_f32 v[112:113], v[112:113], v[102:103] neg_lo:[0,1] neg_hi:[0,1]
    v_lshlrev_b32 v100, 16, v182
    v_and_b32 v101, s65, v182
    v_pk_add_f32 v[100:101], v[100:101], v[112:113]
    v_cvt_pk_bf16_f32 v182, v100, v101
    v_pk_add_f32 v[112:113], v[100:101], v[96:97] op_sel_hi:[1,0]
    v_lshlrev_b32 v102, 16, v182
    v_and_b32 v103, s65, v182
    v_pk_add_f32 v[112:113], v[112:113], v[102:103] neg_lo:[0,1] neg_hi:[0,1]
    v_lshlrev_b32 v100, 16, v183
    v_and_b32 v101, s65, v183
    v_pk_add_f32 v[100:101], v[100:101], v[112:113]
    v_cvt_pk_bf16_f32 v183, v100, v101
    v_pk_add_f32 v[112:113], v[100:101], v[96:97] op_sel_hi:[1,0]
    v_lshlrev_b32 v102, 16, v183
    v_and_b32 v103, s65, v183
    v_pk_add_f32 v[112:113], v[112:113], v[102:103] neg_lo:[0,1] neg_hi:[0,1]
    buffer_store_dwordx4 v[180:183], v2, s[4:7], s66 offen offset:2048 sc1
    s_add_u32 s66, s66, 4096
    v_lshlrev_b32 v100, 16, v184
    v_and_b32 v101, s65, v184
    v_pk_add_f32 v[100:101], v[100:101], v[112:113]
    v_cvt_pk_bf16_f32 v184, v100, v101
    v_pk_add_f32 v[112:113], v[100:101], v[96:97] op_sel_hi:[1,0]
    v_lshlrev_b32 v102, 16, v184
    v_and_b32 v103, s65, v184
    v_pk_add_f32 v[112:113], v[112:113], v[102:103] neg_lo:[0,1] neg_hi:[0,1]
    v_lshlrev_b32 v100, 16, v185
    v_and_b32 v101, s65, v185
    v_pk_add_f32 v[100:101], v[100:101], v[112:113]
    v_cvt_pk_bf16_f32 v185, v100, v101
    v_pk_add_f32 v[112:113], v[100:101], v[96:97] op_sel_hi:[1,0]
    v_lshlrev_b32 v102, 16, v185
    v_and_b32 v103, s65, v185
    v_pk_add_f32 v[112:113], v[112:113], v[102:103] neg_lo:[0,1] neg_hi:[0,1]
    v_lshlrev_b32 v100, 16, v186
    v_and_b32 v101, s65, v186
    v_pk_add_f32 v[100:101], v[100:101], v[112:113]
    v_cvt_pk_bf16_f32 v186, v100, v101
    v_pk_add_f32 v[112:113], v[100:101], v[96:97] op_sel_hi:[1,0]
    v_lshlrev_b32 v102, 16, v186
    v_and_b32 v103, s65, v186
    v_pk_add_f32 v[112:113], v[112:113], v[102:103] neg_lo:[0,1] neg_hi:[0,1]
    v_lshlrev_b32 v100, 16, v187
    v_and_b32 v101, s65, v187
    v_pk_add_f32 v[100:101], v[100:101], v[112:113]
    v_cvt_pk_bf16_f32 v187, v100, v101
    v_pk_add_f32 v[112:113], v[100:101], v[96:97] op_sel_hi:[1,0]
    v_lshlrev_b32 v102, 16, v187
    v_and_b32 v103, s65, v187
    v_pk_add_f32 v[112:113], v[112:113], v[102:103] neg_lo:[0,1] neg_hi:[0,1]
    buffer_store_dwordx4 v[184:187], v2, s[4:7], s66 offen offset:0 sc1
    v_lshlrev_b32 v100, 16, v188
    v_and_b32 v101, s65, v188
    v_pk_add_f32 v[100:101], v[100:101], v[112:113]
    v_cvt_pk_bf16_f32 v188, v100, v101
    v_pk_add_f32 v[112:113], v[100:101], v[96:97] op_sel_hi:[1,0]
    v_lshlrev_b32 v102, 16, v188
    v_and_b32 v103, s65, v188
    v_pk_add_f32 v[112:113], v[112:113], v[102:103] neg_lo:[0,1] neg_hi:[0,1]
    v_lshlrev_b32 v100, 16, v189
    v_and_b32 v101, s65, v189
    v_pk_add_f32 v[100:101], v[100:101], v[112:113]
    v_cvt_pk_bf16_f32 v189, v100, v101
    v_pk_add_f32 v[112:113], v[100:101], v[96:97] op_sel_hi:[1,0]
    v_lshlrev_b32 v102, 16, v189
    v_and_b32 v103, s65, v189
    v_pk_add_f32 v[112:113], v[112:113], v[102:103] neg_lo:[0,1] neg_hi:[0,1]
    v_lshlrev_b32 v100, 16, v190
    v_and_b32 v101, s65, v190
    v_pk_add_f32 v[100:101], v[100:101], v[112:113]
    v_cvt_pk_bf16_f32 v190, v100, v101
    v_pk_add_f32 v[112:113], v[100:101], v[96:97] op_sel_hi:[1,0]
    v_lshlrev_b32 v102, 16, v190
    v_and_b32 v103, s65, v190
    v_pk_add_f32 v[112:113], v[112:113], v[102:103] neg_lo:[0,1] neg_hi:[0,1]
    v_lshlrev_b32 v100, 16, v191
    v_and_b32 v101, s65, v191
    v_pk_add_f32 v[100:101], v[100:101], v[112:113]
    v_cvt_pk_bf16_f32 v191, v100, v101
    v_pk_add_f32 v[112:113], v[100:101], v[96:97] op_sel_hi:[1,0]
    v_lshlrev_b32 v102, 16, v191
    v_and_b32 v103, s65, v191
    v_pk_add_f32 v[112:113], v[112:113], v[102:103] neg_lo:[0,1] neg_hi:[0,1]
    buffer_store_dwordx4 v[188:191], v2, s[4:7], s66 offen offset:2048 sc1
    s_add_u32 s66, s66, 4096
    s_waitcnt vmcnt(5)
    v_cmp_eq_u32 vcc, 0, v60
    s_cbranch_vccnz L_slow_63
L_ok_65:
    s_barrier
    s_cmp_lg_u32 s3, 0
    s_cbranch_scc1 L_w0_66
    s_mov_b64 exec, 1
    buffer_store_dword v17, v97, s[4:7], s71 offen offset:32 sc1
    s_mov_b64 exec, -1
L_w0_66:
    v_lshlrev_b32 v100, 16, v192
    v_and_b32 v101, s65, v192
    v_pk_add_f32 v[100:101], v[100:101], v[112:113]
    v_cvt_pk_bf16_f32 v192, v100, v101
    v_pk_add_f32 v[112:113], v[100:101], v[96:97] op_sel_hi:[1,0]
    v_lshlrev_b32 v102, 16, v192
    v_and_b32 v103, s65, v192
    v_pk_add_f32 v[112:113], v[112:113], v[102:103] neg_lo:[0,1] neg_hi:[0,1]
    v_lshlrev_b32 v100, 16, v193
    v_and_b32 v101, s65, v193
    v_pk_add_f32 v[100:101], v[100:101], v[112:113]
    v_cvt_pk_bf16_f32 v193, v100, v101
    v_pk_add_f32 v[112:113], v[100:101], v[96:97] op_sel_hi:[1,0]
    v_lshlrev_b32 v102, 16, v193
    v_and_b32 v103, s65, v193
    v_pk_add_f32 v[112:113], v[112:113], v[102:103] neg_lo:[0,1] neg_hi:[0,1]
    v_lshlrev_b32 v100, 16, v194
    v_and_b32 v101, s65, v194
    v_pk_add_f32 v[100:101], v[100:101], v[112:113]
    v_cvt_pk_bf16_f32 v194, v100, v101
    v_pk_add_f32 v[112:113], v[100:101], v[96:97] op_sel_hi:[1,0]
    v_lshlrev_b32 v102, 16, v194
    v_and_b32 v103, s65, v194
    v_pk_add_f32 v[112:113], v[112:113], v[102:103] neg_lo:[0,1] neg_hi:[0,1]
    v_lshlrev_b32 v100, 16, v195
    v_and_b32 v101, s65, v195
    v_pk_add_f32 v[100:101], v[100:101], v[112:113]
    v_cvt_pk_bf16_f32 v195, v100, v101
    v_pk_add_f32 v[112:113], v[100:101], v[96:97] op_sel_hi:[1,0]
    v_lshlrev_b32 v102, 16, v195
    v_and_b32 v103, s65, v195
    v_pk_add_f32 v[112:113], v[112:113], v[102:103] neg_lo:[0,1] neg_hi:[0,1]
    buffer_store_dwordx4 v[192:195], v2, s[4:7], s66 offen offset:0 sc1
    v_lshlrev_b32 v100, 16, v196
    v_and_b32 v101, s65, v196
    v_pk_add_f32 v[100:101], v[100:101], v[112:113]
    v_cvt_pk_bf16_f32 v196, v100, v101
    v_pk_add_f32 v[112:113], v[100:101], v[96:97] op_sel_hi:[1,0]
    v_lshlrev_b32 v102, 16, v196
    v_and_b32 v103, s65, v196
    v_pk_add_f32 v[112:113], v[112:113], v[102:103] neg_lo:[0,1] neg_hi:[0,1]
    v_lshlrev_b32 v100, 16, v197
    v_and_b32 v101, s65, v197
    v_pk_add_f32 v[100:101], v[100:101], v[112:113]
    v_cvt_pk_bf16_f32 v197, v100, v101
    v_pk_add_f32 v[112:113], v[100:101], v[96:97] op_sel_hi:[1,0]
    v_lshlrev_b32 v102, 16, v197
    v_and_b32 v103, s65, v197
    v_pk_add_f32 v[112:113], v[112:113], v[102:103] neg_lo:[0,1] neg_hi:[0,1]
    v_lshlrev_b32 v100, 16, v198
    v_and_b32 v101, s65, v198
    v_pk_add_f32 v[100:101], v[100:101], v[112:113]
    v_cvt_pk_bf16_f32 v198, v100, v101
    v_pk_add_f32 v[112:113], v[100:101], v[96:97] op_sel_hi:[1,0]
    v_lshlrev_b32 v102, 16, v198
    v_and_b32 v103, s65, v198
    v_pk_add_f32 v[112:113], v[112:113], v[102:103] neg_lo:[0,1] neg_hi:[0,1]
    v_lshlrev_b32 v100, 16, v199
    v_and_b32 v101, s65, v199
    v_pk_add_f32 v[100:101], v[100:101], v[112:113]
    v_cvt_pk_bf16_f32 v199, v100, v101
    buffer_store_dwordx4 v[196:199], v2, s[4:7], s66 offen offset:2048 sc1
    s_add_u32 s66, s66, 4096
    s_waitcnt vmcnt(0)
    s_barrier
    s_cmp_lg_u32 s3, 0
    s_cbranch_scc1 L_w0_67
    s_mov_b64 exec, 1
    buffer_store_dword v17, v97, s[4:7], s71 offen offset:0 sc1
    s_mov_b64 exec, -1
L_w0_67:
    ds_read_b64_tr_b16 v[200:201], v108 offset:0
    ds_read_b64_tr_b16 v[202:203], v108 offset:1024
    ds_read_b64_tr_b16 v[204:205], v109 offset:0
    ds_read_b64_tr_b16 v[206:207], v109 offset:1024
    ds_read_b64_tr_b16 v[208:209], v108 offset:2048
    ds_read_b64_tr_b16 v[210:211], v108 offset:3072
    ds_read_b64_tr_b16 v[212:213], v109 offset:2048
    ds_read_b64_tr_b16 v[214:215], v109 offset:3072
    ds_read_b64_tr_b16 v[216:217], v108 offset:4096
    ds_read_b64_tr_b16 v[218:219], v108 offset:5120
    ds_read_b64_tr_b16 v[220:221], v109 offset:4096
    ds_read_b64_tr_b16 v[222:223], v109 offset:5120
    ds_read_b64_tr_b16 v[224:225], v108 offset:6144
    ds_read_b64_tr_b16 v[226:227], v108 offset:7168
    s_waitcnt lgkmcnt(12)
    buffer_store_dwordx4 v[200:203], v2, s[4:7], s67 offen offset:0 sc1
    s_waitcnt lgkmcnt(10)
    buffer_store_dwordx4 v[204:207], v2, s[4:7], s67 offen offset:1024 sc1
    s_waitcnt lgkmcnt(8)
    buffer_store_dwordx4 v[208:211], v2, s[4:7], s67 offen offset:2048 sc1
    s_waitcnt lgkmcnt(6)
    buffer_store_dwordx4 v[212:215], v2, s[4:7], s67 offen offset:3072 sc1
    s_add_u32 s67, s67, 4096
    s_waitcnt lgkmcnt(4)
    buffer_store_dwordx4 v[216:219], v2, s[4:7], s67 offen offset:0 sc1
    s_waitcnt lgkmcnt(2)
    buffer_store_dwordx4 v[220:223], v2, s[4:7], s67 offen offset:1024 sc1
    s_waitcnt lgkmcnt(0)
    buffer_store_dwordx4 v[224:227], v2, s[4:7], s67 offen offset:2048 sc1
    s_waitcnt vmcnt(0)
    s_barrier
    s_cmp_lg_u32 s3, 0
    s_cbranch_scc1 L_w0_68
    s_mov_b64 exec, 1
    buffer_store_dword v17, v97, s[4:7], s71 offen offset:64 sc1
    s_mov_b64 exec, -1
L_w0_68:
L_end2:
    s_endpgm
L_slow_63:
    s_mov_b32 s81, 0
L_poll_64:
    buffer_load_dword v60, v61, s[24:27], 0 offen offset:192 sc1
    s_add_u32 s81, s81, 1
    s_waitcnt vmcnt(0)
    v_cmp_eq_u32 vcc, 0, v60
    s_cmp_gt_u32 s81, 65536
    s_cbranch_scc1 L_ok_65
    s_cbranch_vccnz L_poll_64
    s_branch L_ok_65
.p2align 4
.type L_table,@object
L_table:
.long 0x4e404e4,0x4e404e4,0x4e204e2,0x4e204e2
.long 0x4e104e1,0x4e104e1,0x4e004e0,0x4e004e0
.long 0x4df04df,0x4df04df,0x4de04de,0x4de04de
.long 0x4dd04dd,0x4dd04dd,0x4dc04dc,0x4dc04dc
.long 0x4db04db,0x4db04db,0x4da04da,0x4da04da
.long 0x4d904d9,0x4d904d9,0x4d804d8,0x4d804d8
.long 0x4d704d7,0x4d704d7,0x4d604d6,0x4d604d6
.long 0x4d504d5,0x4d504d5,0x4d404d4,0x4d404d4
.long 0x4d304d3,0x4d304d3,0x4d204d2,0x4d204d2
.long 0x4d104d1,0x4d104d1,0x4d004d0,0x4d004d0
.long 0x4cf04cf,0x4cf04cf,0x4ce04ce,0x4ce04ce
.long 0x4cd04cd,0x4cd04cd,0x4cc04cc,0x4cc04cc
.long 0x4cb04cb,0x4cb04cb,0x4ca04ca,0x4ca04ca
.long 0x4c904c9,0x4c904c9,0x4c804c8,0x4c804c8
.long 0x4c704c7,0x4c704c7,0x4c604c6,0x4c604c6
.long 0x4c504c5,0x4c504c5,0x4c404c4,0x4c404c4
.long 0x4c304c3,0x4c304c3,0x4c104c1,0x4c104c1
.long 0x4c004c0,0x4c004c0,0x4bf04bf,0x4bf04bf
.long 0x4be04be,0x4be04be,0x4bd04bd,0x4bd04bd
.long 0x4bc04bc,0x4bc04bc,0x4bb04bb,0x4bb04bb
.long 0x4ba04ba,0x4ba04ba,0x4b904b9,0x4b904b9
.long 0x4b804b8,0x4b804b8,0x4b704b7,0x4b704b7
.long 0x4b604b6,0x4b604b6,0x4b504b5,0x4b504b5
.long 0x4b404b4,0x4b404b4,0x4b304b3,0x4b304b3
.long 0x4b204b2,0x4b204b2,0x4b104b1,0x4b104b1
.long 0x4b004b0,0x4b004b0,0x4af04af,0x4af04af
.long 0x4ae04ae,0x4ae04ae,0x4ad04ad,0x4ad04ad
.long 0x4ac04ac,0x4ac04ac,0x4ab04ab,0x4ab04ab
.long 0x4aa04aa,0x4aa04aa,0x4a904a9,0x4a904a9
.long 0x4a804a8,0x4a804a8,0x4a704a7,0x4a704a7
.long 0x4a604a6,0x4a604a6,0x4a504a5,0x4a504a5
.long 0x4a404a4,0x4a404a4,0x4a304a3,0x4a304a3
.long 0x4a204a2,0x4a204a2,0x4a004a0,0x4a004a0
.long 0x49f049f,0x49f049f,0x49e049e,0x49e049e
.long 0x49d049d,0x49d049d,0x49c049c,0x49c049c
.long 0x49b049b,0x49b049b,0x49a049a,0x49a049a
.long 0x4990499,0x4990499,0x4980498,0x4980498
.long 0x4970497,0x4970497,0x4960496,0x4960496
.long 0x4950495,0x4950495,0x4940494,0x4940494
.long 0x4930493,0x4930493,0x4920492,0x4920492
.long 0x4910491,0x4910491,0x4900490,0x4900490
.long 0x48f048f,0x48f048f,0x48e048e,0x48e048e
.long 0x48d048d,0x48d048d,0x48c048c,0x48c048c
.long 0x48b048b,0x48b048b,0x48a048a,0x48a048a
.long 0x4890489,0x4890489,0x4880488,0x4880488
.long 0x4870487,0x4870487,0x4860486,0x4860486
.long 0x4850485,0x4850485,0x4840484,0x4840484
.long 0x4830483,0x4830483,0x4820482,0x4820482
.long 0x4810481,0x4810481,0x47f047f,0x47f047f
.long 0x47e047e,0x47e047e,0x47d047d,0x47d047d
.long 0x47c047c,0x47c047c,0x47b047b,0x47b047b
.long 0x47a047a,0x47a047a,0x4790479,0x4790479
.long 0x4780478,0x4780478,0x4770477,0x4770477
.long 0x4760476,0x4760476,0x4750475,0x4750475
.long 0x4740474,0x4740474,0x4730473,0x4730473
.long 0x4720472,0x4720472,0x4710471,0x4710471
.long 0x4700470,0x4700470,0x46f046f,0x46f046f
.long 0x46e046e,0x46e046e,0x46d046d,0x46d046d
.long 0x46c046c,0x46c046c,0x46b046b,0x46b046b
.long 0x46a046a,0x46a046a,0x4690469,0x4690469
.long 0x4680468,0x4680468,0x4670467,0x4670467
.long 0x4660466,0x4660466,0x4650465,0x4650465
.long 0x4640464,0x4640464,0x4630463,0x4630463
.long 0x4620462,0x4620462,0x4610461,0x4610461
.long 0x4600460,0x20e020e,0x1ed020e,0x1ed01ed
.long 0x1ec01ec,0x20c020c,0x1eb020c,0x1eb01eb
.long 0x1ea01ea,0x20a020a,0x1e9020a,0x1e901e9
.long 0x1e801e8,0x2080208,0x1e70208,0x1e701e7
.long 0x1e601e6,0x2060206,0x1e50206,0x1e501e5
.long 0x1e401e4,0x2040204,0x1e30204,0x1e301e3
.long 0x1e201e2,0x2020202,0x1e10202,0x1e101e1
.long 0x1e001e0,0x2000200,0x1df0200,0x1df01df
.long 0x1de01de,0x1fe01fe,0x1dd01fe,0x1dd01dd
.long 0x1dc01dc,0x1fc01fc,0x1db01fc,0x1db01db
.long 0x1da01da,0x1fa01fa,0x1d901fa,0x1d901d9
.long 0x1d801d8,0x1f801f8,0x1d701f8,0x1d701d7
.long 0x1d601d6,0x1f601f6,0x1d501f6,0x1d501d5
.long 0x1d401d4,0x1f401f4,0x1d301f4,0x1d301d3
.long 0x1d201d2,0x1f201f2,0x1d101f2,0x1d101d1
.long 0x1d001d0,0x1f001f0,0x1cf01f0,0x1cf01cf
.long 0x1ce01ce,0x1cc01cc,0x1ab01cc,0x1ab01ab
.long 0x1aa01aa,0x1ca01ca,0x1a901ca,0x1a901a9
.long 0x1a801a8,0x1c801c8,0x1a701c8,0x1a701a7
.long 0x1a601a6,0x1c601c6,0x1a501c6,0x1a501a5
.long 0x1a401a4,0x1c401c4,0x1a301c4,0x1a301a3
.long 0x1a201a2,0x1c201c2,0x1a101c2,0x1a101a1
.long 0x1a001a0,0x1c001c0,0x19f01c0,0x19f019f
.long 0x19e019e,0x1be01be,0x19d01be,0x19d019d
.long 0x19c019c,0x1bc01bc,0x19b01bc,0x19b019b
.long 0x19a019a,0x1ba01ba,0x19901ba,0x1990199
.long 0x1980198,0x1b801b8,0x19701b8,0x1970197
.long 0x1960196,0x1b601b6,0x19501b6,0x1950195
.long 0x1940194,0x1b401b4,0x19301b4,0x1930193
.long 0x1920192,0x1b201b2,0x19101b2,0x1910191
.long 0x1900190,0x1b001b0,0x18f01b0,0x18f018f
.long 0x18e018e,0x1ae01ae,0x18d01ae,0x18d018d
.long 0x18a018c,0x1690169,0x1480169,0x1270127
.long 0x1880126,0x1670167,0x1460167,0x1250125
.long 0x1860124,0x1650165,0x1440165,0x1230123
.long 0x1840122,0x1630163,0x1420163,0x1210121
.long 0x1820120,0x1610161,0x1400161,0x11f011f
.long 0x180011e,0x15f015f,0x13e015f,0x11d011d
.long 0x17e011c,0x15d015d,0x13c015d,0x11b011b
.long 0x17c011a,0x15b015b,0x13a015b,0x1190119
.long 0x17a0118,0x1590159,0x1380159,0x1170117
.long 0x1780116,0x1570157,0x1360157,0x1150115
.long 0x1760114,0x1550155,0x1340155,0x1130113
.long 0x1740112,0x1530153,0x1320153,0x1110111
.long 0x1720110,0x1510151,0x1300151,0x10f010f
.long 0x170010e,0x14f014f,0x12e014f,0x10d010d
.long 0x16e010c,0x14d014d,0x12c014d,0x10b010b
.long 0x16c010a,0x14b014b,0x12a014b,0x1090109
.long 0xe50106,0xa300c4,0x610082,0x1f0040
.long 0xe30104,0xa100c2,0x5f0080,0x1d003e
.long 0xe10102,0x9f00c0,0x5d007e,0x1b003c
.long 0xdf0100,0x9d00be,0x5b007c,0x19003a
.long 0xdd00fe,0x9b00bc,0x59007a,0x170038
.long 0xdb00fc,0x9900ba,0x570078,0x150036
.long 0xd900fa,0x9700b8,0x550076,0x130034
.long 0xd700f8,0x9500b6,0x530074,0x110032
.long 0xd500f6,0x9300b4,0x510072,0xf0030
.long 0xd300f4,0x9100b2,0x4f0070,0xd002e
.long 0xd100f2,0x8f00b0,0x4d006e,0xb002c
.long 0xcf00f0,0x8d00ae,0x4b006c,0x9002a
.long 0xcd00ee,0x8b00ac,0x49006a,0x70028
.long 0xcb00ec,0x8900aa,0x470068,0x50026
.long 0xc900ea,0x8700a8,0x450066,0x30024
.long 0xc700e8,0x8500a6,0x430064,0x10022
.long 0x4e204e2,0x4e104e2,0x4e104e1,0x4e104e1
.long 0x4e004e0,0x4df04e0,0x4df04df,0x4df04df
.long 0x4de04de,0x4dd04de,0x4dd04dd,0x4dd04dd
.long 0x4dc04dc,0x4db04dc,0x4db04db,0x4db04db
.long 0x4da04da,0x4d904da,0x4d904d9,0x4d904d9
.long 0x4d804d8,0x4d704d8,0x4d704d7,0x4d704d7
.long 0x4d604d6,0x4d504d6,0x4d504d5,0x4d504d5
.long 0x4d404d4,0x4d304d4,0x4d304d3,0x4d304d3
.long 0x4d204d2,0x4d104d2,0x4d104d1,0x4d104d1
.long 0x4d004d0,0x4cf04d0,0x4cf04cf,0x4cf04cf
.long 0x4ce04ce,0x4cd04ce,0x4cd04cd,0x4cd04cd
.long 0x4cc04cc,0x4cb04cc,0x4cb04cb,0x4cb04cb
.long 0x4ca04ca,0x4c904ca,0x4c904c9,0x4c904c9
.long 0x4c804c8,0x4c704c8,0x4c704c7,0x4c704c7
.long 0x4c604c6,0x4c504c6,0x4c504c5,0x4c504c5
.long 0x4c404c4,0x4c304c4,0x4c304c3,0x4c304c3
.long 0x4c104c1,0x4c004c1,0x4c004c0,0x4c004c0
.long 0x4bf04bf,0x4be04bf,0x4be04be,0x4be04be
.long 0x4bd04bd,0x4bc04bd,0x4bc04bc,0x4bc04bc
.long 0x4bb04bb,0x4ba04bb,0x4ba04ba,0x4ba04ba
.long 0x4b904b9,0x4b804b9,0x4b804b8,0x4b804b8
.long 0x4b704b7,0x4b604b7,0x4b604b6,0x4b604b6
.long 0x4b504b5,0x4b404b5,0x4b404b4,0x4b404b4
.long 0x4b304b3,0x4b204b3,0x4b204b2,0x4b204b2
.long 0x4b104b1,0x4b004b1,0x4b004b0,0x4b004b0
.long 0x4af04af,0x4ae04af,0x4ae04ae,0x4ae04ae
.long 0x4ad04ad,0x4ac04ad,0x4ac04ac,0x4ac04ac
.long 0x4ab04ab,0x4aa04ab,0x4aa04aa,0x4aa04aa
.long 0x4a904a9,0x4a804a9,0x4a804a8,0x4a804a8
.long 0x4a704a7,0x4a604a7,0x4a604a6,0x4a604a6
.long 0x4a504a5,0x4a404a5,0x4a404a4,0x4a404a4
.long 0x4a304a3,0x4a204a3,0x4a204a2,0x4a204a2
.long 0x4a004a0,0x49f04a0,0x49f049f,0x49f049f
.long 0x49e049e,0x49d049e,0x49d049d,0x49d049d
.long 0x49c049c,0x49b049c,0x49b049b,0x49b049b
.long 0x49a049a,0x499049a,0x4990499,0x4990499
.long 0x4980498,0x4970498,0x4970497,0x4970497
.long 0x4960496,0x4950496,0x4950495,0x4950495
.long 0x4940494,0x4930494,0x4930493,0x4930493
.long 0x4920492,0x4910492,0x4910491,0x4910491
.long 0x4900490,0x48f0490,0x48f048f,0x48f048f
.long 0x48e048e,0x48d048e,0x48d048d,0x48d048d
.long 0x48c048c,0x48b048c,0x48b048b,0x48b048b
.long 0x48a048a,0x489048a,0x4890489,0x4890489
.long 0x4880488,0x4870488,0x4870487,0x4870487
.long 0x4860486,0x4850486,0x4850485,0x4850485
.long 0x4840484,0x4830484,0x4830483,0x4830483
.long 0x4820482,0x4810482,0x4810481,0x4810481
.long 0x47f047f,0x47e047f,0x47e047e,0x47e047e
.long 0x47d047d,0x47c047d,0x47c047c,0x47c047c
.long 0x47b047b,0x47a047b,0x47a047a,0x47a047a
.long 0x4790479,0x4780479,0x4780478,0x4780478
.long 0x4770477,0x4760477,0x4760476,0x4760476
.long 0x4750475,0x4740475,0x4740474,0x4740474
.long 0x4730473,0x4720473,0x4720472,0x4720472
.long 0x4710471,0x4700471,0x4700470,0x4700470
.long 0x46f046f,0x46e046f,0x46e046e,0x46e046e
.long 0x46d046d,0x46c046d,0x46c046c,0x46c046c
.long 0x46b046b,0x46a046b,0x46a046a,0x46a046a
.long 0x4690469,0x4680469,0x4680468,0x4680468
.long 0x4670467,0x4660467,0x4660466,0x4660466
.long 0x4650465,0x4640465,0x4640464,0x4640464
.long 0x4630463,0x4620463,0x4620462,0x4620462
.long 0x4610461,0x4600461,0x4600460,0x4600460
.long 0x1ed01ed,0x20d020d,0x1ec020d,0x1ec01ec
.long 0x1eb01eb,0x20b020b,0x1ea020b,0x1ea01ea
.long 0x1e901e9,0x2090209,0x1e80209,0x1e801e8
.long 0x1e701e7,0x2070207,0x1e60207,0x1e601e6
.long 0x1e501e5,0x2050205,0x1e40205,0x1e401e4
.long 0x1e301e3,0x2030203,0x1e20203,0x1e201e2
.long 0x1e101e1,0x2010201,0x1e00201,0x1e001e0
.long 0x1df01df,0x1ff01ff,0x1de01ff,0x1de01de
.long 0x1dd01dd,0x1fd01fd,0x1dc01fd,0x1dc01dc
.long 0x1db01db,0x1fb01fb,0x1da01fb,0x1da01da
.long 0x1d901d9,0x1f901f9,0x1d801f9,0x1d801d8
.long 0x1d701d7,0x1f701f7,0x1d601f7,0x1d601d6
.long 0x1d501d5,0x1f501f5,0x1d401f5,0x1d401d4
.long 0x1d301d3,0x1f301f3,0x1d201f3,0x1d201d2
.long 0x1d101d1,0x1f101f1,0x1d001f1,0x1d001d0
.long 0x1cf01cf,0x1ef01ef,0x1ce01ef,0x1ce01ce
.long 0x1ab01ab,0x1cb01cb,0x1aa01cb,0x1aa01aa
.long 0x1a901a9,0x1c901c9,0x1a801c9,0x1a801a8
.long 0x1a701a7,0x1c701c7,0x1a601c7,0x1a601a6
.long 0x1a501a5,0x1c501c5,0x1a401c5,0x1a401a4
.long 0x1a301a3,0x1c301c3,0x1a201c3,0x1a201a2
.long 0x1a101a1,0x1c101c1,0x1a001c1,0x1a001a0
.long 0x19f019f,0x1bf01bf,0x19e01bf,0x19e019e
.long 0x19d019d,0x1bd01bd,0x19c01bd,0x19c019c
.long 0x19b019b,0x1bb01bb,0x19a01bb,0x19a019a
.long 0x1990199,0x1b901b9,0x19801b9,0x1980198
.long 0x1970197,0x1b701b7,0x19601b7,0x1960196
.long 0x1950195,0x1b501b5,0x19401b5,0x1940194
.long 0x1930193,0x1b301b3,0x19201b3,0x1920192
.long 0x1910191,0x1b101b1,0x19001b1,0x1900190
.long 0x18f018f,0x1af01af,0x18e01af,0x18e018e
.long 0x18d018d,0x1ad01ad,0x18c01ad,0x18c018c
.long 0x1890127,0x1680168,0x1470168,0x1260126
.long 0x1870125,0x1660166,0x1450166,0x1240124
.long 0x1850123,0x1640164,0x1430164,0x1220122
.long 0x1830121,0x1620162,0x1410162,0x1200120
.long 0x181011f,0x1600160,0x13f0160,0x11e011e
.long 0x17f011d,0x15e015e,0x13d015e,0x11c011c
.long 0x17d011b,0x15c015c,0x13b015c,0x11a011a
.long 0x17b0119,0x15a015a,0x139015a,0x1180118
.long 0x1790117,0x1580158,0x1370158,0x1160116
.long 0x1770115,0x1560156,0x1350156,0x1140114
.long 0x1750113,0x1540154,0x1330154,0x1120112
.long 0x1730111,0x1520152,0x1310152,0x1100110
.long 0x171010f,0x1500150,0x12f0150,0x10e010e
.long 0x16f010d,0x14e014e,0x12d014e,0x10c010c
.long 0x16d010b,0x14c014c,0x12b014c,0x10a010a
.long 0x16b0109,0x14a014a,0x129014a,0x1080108
.long 0xe40105,0xa200c3,0x600081,0x1e003f
.long 0xe20103,0xa000c1,0x5e007f,0x1c003d
.long 0xe00101,0x9e00bf,0x5c007d,0x1a003b
.long 0xde00ff,0x9c00bd,0x5a007b,0x180039
.long 0xdc00fd,0x9a00bb,0x580079,0x160037
.long 0xda00fb,0x9800b9,0x560077,0x140035
.long 0xd800f9,0x9600b7,0x540075,0x120033
.long 0xd600f7,0x9400b5,0x520073,0x100031
.long 0xd400f5,0x9200b3,0x500071,0xe002f
.long 0xd200f3,0x9000b1,0x4e006f,0xc002d
.long 0xd000f1,0x8e00af,0x4c006d,0xa002b
.long 0xce00ef,0x8c00ad,0x4a006b,0x80029
.long 0xcc00ed,0x8a00ab,0x480069,0x60027
.long 0xca00eb,0x8800a9,0x460067,0x40025
.long 0xc800e9,0x8600a7,0x440065,0x20023
.long 0xc600e7,0x8400a5,0x420063,0x21
.long 0x4e1,0x0,0x0,0x0
.long 0x4df,0x0,0x0,0x0
.long 0x4dd,0x0,0x0,0x0
.long 0x4db,0x0,0x0,0x0
.long 0x4d9,0x0,0x0,0x0
.long 0x4d7,0x0,0x0,0x0
.long 0x4d5,0x0,0x0,0x0
.long 0x4d3,0x0,0x0,0x0
.long 0x4d1,0x0,0x0,0x0
.long 0x4cf,0x0,0x0,0x0
.long 0x4cd,0x0,0x0,0x0
.long 0x4cb,0x0,0x0,0x0
.long 0x4c9,0x0,0x0,0x0
.long 0x4c7,0x0,0x0,0x0
.long 0x4c5,0x0,0x0,0x0
.long 0x4c3,0x0,0x0,0x0
.long 0x4c0,0x0,0x0,0x0
.long 0x4be,0x0,0x0,0x0
.long 0x4bc,0x0,0x0,0x0
.long 0x4ba,0x0,0x0,0x0
.long 0x4b8,0x0,0x0,0x0
.long 0x4b6,0x0,0x0,0x0
.long 0x4b4,0x0,0x0,0x0
.long 0x4b2,0x0,0x0,0x0
.long 0x4b0,0x0,0x0,0x0
.long 0x4ae,0x0,0x0,0x0
.long 0x4ac,0x0,0x0,0x0
.long 0x4aa,0x0,0x0,0x0
.long 0x4a8,0x0,0x0,0x0
.long 0x4a6,0x0,0x0,0x0
.long 0x4a4,0x0,0x0,0x0
.long 0x4a2,0x0,0x0,0x0
.long 0x49f,0x0,0x0,0x0
.long 0x49d,0x0,0x0,0x0
.long 0x49b,0x0,0x0,0x0
.long 0x499,0x0,0x0,0x0
.long 0x497,0x0,0x0,0x0
.long 0x495,0x0,0x0,0x0
.long 0x493,0x0,0x0,0x0
.long 0x491,0x0,0x0,0x0
.long 0x48f,0x0,0x0,0x0
.long 0x48d,0x0,0x0,0x0
.long 0x48b,0x0,0x0,0x0
.long 0x489,0x0,0x0,0x0
.long 0x487,0x0,0x0,0x0
.long 0x485,0x0,0x0,0x0
.long 0x483,0x0,0x0,0x0
.long 0x481,0x0,0x0,0x0
.long 0x47e,0x0,0x0,0x0
.long 0x47c,0x0,0x0,0x0
.long 0x47a,0x0,0x0,0x0
.long 0x478,0x0,0x0,0x0
.long 0x476,0x0,0x0,0x0
.long 0x474,0x0,0x0,0x0
.long 0x472,0x0,0x0,0x0
.long 0x470,0x0,0x0,0x0
.long 0x46e,0x0,0x0,0x0
.long 0x46c,0x0,0x0,0x0
.long 0x46a,0x0,0x0,0x0
.long 0x468,0x0,0x0,0x0
.long 0x466,0x0,0x0,0x0
.long 0x464,0x0,0x0,0x0
.long 0x462,0x0,0x0,0x0
.long 0x460,0x0,0x0,0x0
.long 0x1ec,0x0,0x0,0x0
.long 0x1ea,0x0,0x0,0x0
.long 0x1e8,0x0,0x0,0x0
.long 0x1e6,0x0,0x0,0x0
.long 0x1e4,0x0,0x0,0x0
.long 0x1e2,0x0,0x0,0x0
.long 0x1e0,0x0,0x0,0x0
.long 0x1de,0x0,0x0,0x0
.long 0x1dc,0x0,0x0,0x0
.long 0x1da,0x0,0x0,0x0
.long 0x1d8,0x0,0x0,0x0
.long 0x1d6,0x0,0x0,0x0
.long 0x1d4,0x0,0x0,0x0
.long 0x1d2,0x0,0x0,0x0
.long 0x1d0,0x0,0x0,0x0
.long 0x1ce,0x0,0x0,0x0
.long 0x1aa,0x0,0x0,0x0
.long 0x1a8,0x0,0x0,0x0
.long 0x1a6,0x0,0x0,0x0
.long 0x1a4,0x0,0x0,0x0
.long 0x1a2,0x0,0x0,0x0
.long 0x1a0,0x0,0x0,0x0
.long 0x19e,0x0,0x0,0x0
.long 0x19c,0x0,0x0,0x0
.long 0x19a,0x0,0x0,0x0
.long 0x198,0x0,0x0,0x0
.long 0x196,0x0,0x0,0x0
.long 0x194,0x0,0x0,0x0
.long 0x192,0x0,0x0,0x0
.long 0x190,0x0,0x0,0x0
.long 0x18e,0x0,0x0,0x0
.long 0x18c,0x0,0x0,0x0
.long 0x126,0x0,0x0,0x0
.long 0x124,0x0,0x0,0x0
.long 0x122,0x0,0x0,0x0
.long 0x120,0x0,0x0,0x0
.long 0x11e,0x0,0x0,0x0
.long 0x11c,0x0,0x0,0x0
.long 0x11a,0x0,0x0,0x0
.long 0x118,0x0,0x0,0x0
.long 0x116,0x0,0x0,0x0
.long 0x114,0x0,0x0,0x0
.long 0x112,0x0,0x0,0x0
.long 0x110,0x0,0x0,0x0
.long 0x10e,0x0,0x0,0x0
.long 0x10c,0x0,0x0,0x0
.long 0x10a,0x0,0x0,0x0
.long 0x106,0x0,0x0,0x0
.long 0x104,0x0,0x0,0x0
.long 0x102,0x0,0x0,0x0
.long 0x100,0x0,0x0,0x0
.long 0xfe,0x0,0x0,0x0
.long 0xfc,0x0,0x0,0x0
.long 0xfa,0x0,0x0,0x0
.long 0xf8,0x0,0x0,0x0
.long 0xf6,0x0,0x0,0x0
.long 0xf4,0x0,0x0,0x0
.long 0xf2,0x0,0x0,0x0
.long 0xf0,0x0,0x0,0x0
.long 0xee,0x0,0x0,0x0
.long 0xec,0x0,0x0,0x0
.long 0xea,0x0,0x0,0x0
.long 0xe8,0x0,0x0,0x0
.long 0x448,0x0,0x0,0x0
L_table_end:
.section .rodata,"a"
.p2align 6
.amdhsa_kernel interleave_layers__ssm_conv_s4__dense_activation_relu__prompt_kernel
  .amdhsa_next_free_vgpr 512
  .amdhsa_next_free_sgpr 102
  .amdhsa_accum_offset 256
  .amdhsa_group_segment_fixed_size 0
  .amdhsa_kernarg_size 120
  .amdhsa_user_sgpr_count 2
  .amdhsa_user_sgpr_kernarg_segment_ptr 1
  .amdhsa_system_sgpr_workgroup_id_x 1
.end_amdhsa_kernel
```
